```python
import torch

def _softmax(x, axis=-1):
    return torch.softmax(x, dim=axis)

def _gelu(x):
    return torch.nn.functional.gelu(x, approximate='tanh')

def _silu(x):
    return torch.nn.functional.silu(x)

def _sigmoid(x):
    return torch.sigmoid(x)

def _layernorm(x, axis=-1, eps=1e-05):
    m = x.mean(dim=axis, keepdim=True)
    v = x.var(dim=axis, keepdim=True, unbiased=False)
    return (x - m) / torch.sqrt(v + eps)

def _scatter_add(tgt, idx, src, axis=0):
    return tgt.clone().index_add_(axis, idx, src)

def _segment_sum(src, seg, n):
    out = torch.zeros((n,) + src.shape[1:], dtype=src.dtype)
    return out.index_add_(0, seg, src)

def _pad(x, pw):
    flat = tuple((v for pair in reversed(pw) for v in pair))
    return torch.nn.functional.pad(x, flat)
kernel_name = 'gated_mix__memory_aug_recurrent_mem_tr__dense_activation_silu__prompt'

def setup_inputs():

    _w = lambda a: (lambda t: t.to(torch.bfloat16) if t.is_floating_point() else t)(torch.as_tensor(a))

    def _A_setup():
        B, S, Dm = (1, 2048, 448)
        H, Dh = (16, 256)
        M, seg = (8, 32)
        seg = min(seg, S)
        S = S // seg * seg
        return {'x': _w((lambda *s: torch.randn(*s, dtype=torch.bfloat16) * 0.05)(B, S, Dm)), 'mem0': _w((lambda *s: torch.randn(*s, dtype=torch.bfloat16) * 0.4)(B, M, Dm)), 'Wq': _w((lambda *s: torch.randn(*s, dtype=torch.bfloat16) * 6.4)(Dm, H, Dh) * Dm ** (-0.5)), 'Wk': _w((lambda *s: torch.randn(*s, dtype=torch.bfloat16) * 6.4)(Dm, H, Dh) * Dm ** (-0.5)), 'Wv': _w((lambda *s: torch.randn(*s, dtype=torch.bfloat16) * 0.4)(Dm, H, Dh) * Dm ** (-0.5)), 'Wo': _w((lambda *s: torch.randn(*s, dtype=torch.bfloat16) * 0.4)(H, Dh, Dm) * (H * Dh) ** (-0.5)), 'seg_len': seg}
    _A_in = _A_setup()

    def _B_setup():
        B, S, D, F = (1, 2048, 448, 1792)
        return {'x': _w((lambda *s: torch.randn(*s, dtype=torch.bfloat16) * 0.05)(B, S, D)), 'w1': _w((lambda *s: torch.randn(*s, dtype=torch.bfloat16) * 3.2)(D, F) * D ** (-0.5)), 'w2': _w((lambda *s: torch.randn(*s, dtype=torch.bfloat16) * 0.2)(F, D) * F ** (-0.5))}
    _B_in = _B_setup()
    return {'A_x': _A_in['x'], 'A_mem0': _A_in['mem0'], 'A_Wq': _A_in['Wq'], 'A_Wk': _A_in['Wk'], 'A_Wv': _A_in['Wv'], 'A_Wo': _A_in['Wo'], 'A_seg_len': _A_in['seg_len'], 'B_x': _B_in['x'], 'B_w1': _B_in['w1'], 'B_w2': _B_in['w2'], 'gate_w': _w((lambda *s: torch.randn(*s, dtype=torch.bfloat16) * 0.05)(448) * 16.0)}

def reference(A_x, A_mem0, A_Wq, A_Wk, A_Wv, A_Wo, A_seg_len, B_x, B_w1, B_w2, gate_w):

    def _A_ref(x, mem0, Wq, Wk, Wv, Wo, seg_len):
        B, S, Dm = x.shape
        H, Dh = (Wq.shape[1], Wq.shape[2])
        M = mem0.shape[1]
        scale = Dh ** (-0.5)
        n_seg = S // seg_len
        L = M + seg_len
        idx = torch.arange(L)
        mask = (idx[:, None] < M) | (idx[:, None] >= idx[None, :])
        mem = mem0
        outs = []
        for s in range(n_seg):
            xs = x[:, s * seg_len:(s + 1) * seg_len, :].clone()
            h = torch.concatenate([mem, xs], axis=1)
            q = torch.einsum('btd,dhe->bhte', h, Wq)
            k = torch.einsum('btd,dhe->bhte', h, Wk)
            v = torch.einsum('btd,dhe->bhte', h, Wv)
            scores = torch.einsum('bhqe,bhke->bhqk', q, k) * scale
            scores = torch.where(mask[None, None], scores, -1000000000.0)
            p = _softmax(scores, axis=-1)
            o = torch.einsum('bhqk,bhke->bhqe', p, v)
            o = torch.einsum('bhte,hed->btd', o, Wo)
            mem = o[:, :M, :].clone()
            outs.append(o[:, M:, :])
        return torch.concatenate(outs, axis=1)

    def _B_ref(x, w1, w2):
        h = torch.einsum('bsd,df->bsf', x, w1)
        h = _silu(h)
        out = torch.einsum('bsf,fd->bsd', h, w2)
        return out
    x = A_x
    g = _sigmoid((x * gate_w).sum(-1, keepdims=True))
    a = _A_ref(x, A_mem0, A_Wq, A_Wk, A_Wv, A_Wo, A_seg_len)
    b = _B_ref(x, B_w1, B_w2)
    return g * a + (1 - g) * b
```

```asm
; @launch grid=(256,1,1) block=(256,1,1) lds=163840
.amdgcn_target "amdgcn-amd-amdhsa--gfx950"
.text
.globl gated_mix__memory_aug_recurrent_mem_tr__dense_activation_silu__prompt_kernel
.p2align 8
.type gated_mix__memory_aug_recurrent_mem_tr__dense_activation_silu__prompt_kernel,@function
gated_mix__memory_aug_recurrent_mem_tr__dense_activation_silu__prompt_kernel:
    s_cmp_ge_u32 s2, 256
    s_cbranch_scc1 L_bail
    s_load_dwordx2 s[8:9], s[0:1], 104
    s_load_dwordx2 s[96:97], s[0:1], 96
    s_load_dwordx8 s[24:31], s[0:1], 16
    v_lshrrev_b32 v1, 6, v0
    v_and_b32 v0, 63, v0
    s_add_u32 s38, s2, 5
    s_and_b32 s38, s38, 7
    s_lshl_b32 s38, s38, 2
    s_lshr_b32 s38, 0x76543210, s38
    s_and_b32 s38, s38, 7
    s_lshr_b32 s3, s2, 3
    v_readfirstlane_b32 s4, v1
    v_and_b32 v1, 15, v0
    v_lshrrev_b32 v2, 4, v0
    s_waitcnt lgkmcnt(0)
    s_lshl_b32 s70, s3, 3
    s_add_u32 s70, s70, s38
    s_mov_b32 s44, -1
    s_mov_b32 s45, -1
    s_mov_b32 s46, -1
    s_cmp_lg_u32 s38, 0
    s_cbranch_scc1 L_tok0
    s_cmp_lg_u32 s3, 30
    s_cbranch_scc1 L_noinit
    s_load_dwordx2 s[34:35], s[0:1], 8
    s_add_u32 s22, s8, 42205184
    s_addc_u32 s23, s9, 0
    s_mul_i32 s36, s4, 112
    s_waitcnt lgkmcnt(0)
    v_min_u32 v6, 63, v0
    v_add3_u32 v6, v6, s36, 0
    v_and_b32 v7, 7, v6
    v_mul_u32_u24 v7, 896, v7
    v_lshrrev_b32 v10, 5, v6
    v_lshl_add_u32 v7, v10, 6, v7
    v_bfe_u32 v10, v6, 3, 1
    v_lshl_add_u32 v7, v10, 5, v7
    v_bfe_u32 v10, v6, 4, 1
    v_lshl_add_u32 v7, v10, 3, v7
    global_load_dwordx2 v[12:13], v7, s[34:35]
    global_load_dwordx2 v[14:15], v7, s[34:35] offset:16
    v_lshlrev_b32 v6, 4, v6
    s_waitcnt vmcnt(0)
    v_cmp_eq_u32 vcc, 4290772927, v12
    s_nop 1
    v_cndmask_b32 v12, v12, -1, vcc
    v_cmp_eq_u32 vcc, 4290772927, v13
    s_nop 1
    v_cndmask_b32 v13, v13, -1, vcc
    v_cmp_eq_u32 vcc, 4290772927, v14
    s_nop 1
    v_cndmask_b32 v14, v14, -1, vcc
    v_cmp_eq_u32 vcc, 4290772927, v15
    s_nop 1
    v_cndmask_b32 v15, v15, -1, vcc
    global_store_dwordx4 v6, v[12:15], s[22:23] sc1
    v_min_u32 v6, 47, v0
    v_add3_u32 v6, v6, s36, 64
    v_and_b32 v7, 7, v6
    v_mul_u32_u24 v7, 896, v7
    v_lshrrev_b32 v10, 5, v6
    v_lshl_add_u32 v7, v10, 6, v7
    v_bfe_u32 v10, v6, 3, 1
    v_lshl_add_u32 v7, v10, 5, v7
    v_bfe_u32 v10, v6, 4, 1
    v_lshl_add_u32 v7, v10, 3, v7
    global_load_dwordx2 v[12:13], v7, s[34:35]
    global_load_dwordx2 v[14:15], v7, s[34:35] offset:16
    v_lshlrev_b32 v6, 4, v6
    s_waitcnt vmcnt(0)
    v_cmp_eq_u32 vcc, 4290772927, v12
    s_nop 1
    v_cndmask_b32 v12, v12, -1, vcc
    v_cmp_eq_u32 vcc, 4290772927, v13
    s_nop 1
    v_cndmask_b32 v13, v13, -1, vcc
    v_cmp_eq_u32 vcc, 4290772927, v14
    s_nop 1
    v_cndmask_b32 v14, v14, -1, vcc
    v_cmp_eq_u32 vcc, 4290772927, v15
    s_nop 1
    v_cndmask_b32 v15, v15, -1, vcc
    global_store_dwordx4 v6, v[12:15], s[22:23] sc1
L_noinit:
    s_cmp_ge_u32 s3, 16
    s_cbranch_scc1 L_jobs
    s_add_u32 s45, s3, 208
    s_branch L_jobs
L_bail:
    s_endpgm
L_tok0:
    s_sub_u32 s39, s38, 1
    s_lshl_b32 s44, s39, 5
    s_add_u32 s44, s44, s3
    s_cmp_lg_u32 s44, 223
    s_cbranch_scc1 L_noinit2
    v_mov_b32 v8, 0
    v_mov_b32 v9, 0
    v_mov_b32 v10, 0
    v_mov_b32 v11, 0
    s_lshl_b32 s22, s4, 12
    v_lshl_add_u32 v6, v0, 4, s22
    s_add_u32 s22, s8, 43962368
    s_addc_u32 s23, s9, 0
    global_store_dwordx4 v6, v[8:11], s[22:23] offset:0 sc1
    global_store_dwordx4 v6, v[8:11], s[22:23] offset:1024 sc1
    global_store_dwordx4 v6, v[8:11], s[22:23] offset:2048 sc1
    global_store_dwordx4 v6, v[8:11], s[22:23] offset:3072 sc1
    s_lshl_b32 s20, s4, 14
    v_lshl_add_u32 v7, v0, 7, s20
    s_add_u32 s22, s8, 43986944
    s_addc_u32 s23, s9, 0
    s_add_u32 s20, s22, 8192
    s_addc_u32 s21, s23, 0
    global_store_dwordx4 v7, v[8:11], s[22:23] sc1
    global_store_dwordx4 v7, v[8:11], s[20:21] sc1
    s_lshl_b32 s22, s4, 11
    v_lshrrev_b32 v6, 2, v0
    v_lshl_add_u32 v6, v6, 7, s22
    v_and_b32 v9, 3, v0
    v_lshl_add_u32 v6, v9, 3, v6
    v_cmp_eq_u32 vcc, 3, v9
    s_nop 1
    v_cndmask_b32 v9, 0, 1, vcc
    s_add_u32 s22, s8, 43978752
    s_addc_u32 s23, s9, 0
    global_store_dwordx2 v6, v[8:9], s[22:23] sc1
    s_waitcnt vmcnt(0)
    s_barrier
    v_mov_b32 v6, 0
    v_mov_b32 v7, 1
    global_store_dword v6, v7, s[96:97] offset:192 sc1
L_noinit2:
    s_min_u32 s40, s44, 128
    s_add_u32 s40, s40, 7
    s_lshr_b32 s40, s40, 3
    s_sub_u32 s45, s44, s40
    s_cmp_ge_u32 s44, 128
    s_cbranch_scc1 L_jobs
    s_and_b32 s39, s44, 7
    s_cselect_b32 s45, s45, -1
L_jobs:
    s_mov_b32 s32, 0
    s_mov_b32 s33, 0
    v_lshlrev_b32 v28, 4, v0
    v_lshrrev_b32 v3, 5, v0
    v_and_b32 v4, 31, v0
    s_lshl_b32 s20, s4, 4
    s_lshl_b32 s18, s4, 13
    v_add_u32 v5, 0, v3
    v_lshlrev_b32 v6, 2, v5
    v_xor_b32 v6, v6, v4
    v_xor_b32 v6, 0, v6
    v_add3_u32 v5, s20, v5, 0
    v_lshlrev_b32 v5, 13, v5
    v_lshl_add_u32 v8, v6, 4, v5
    v_add_u32 v5, 2, v3
    v_lshlrev_b32 v6, 2, v5
    v_xor_b32 v6, v6, v4
    v_xor_b32 v6, 0, v6
    v_add3_u32 v5, s20, v5, 0
    v_lshlrev_b32 v5, 13, v5
    v_lshl_add_u32 v9, v6, 4, v5
    v_add_u32 v5, 0, v3
    v_lshlrev_b32 v6, 2, v5
    v_xor_b32 v6, v6, v4
    v_xor_b32 v6, 2, v6
    v_add3_u32 v5, s20, v5, 8
    v_lshlrev_b32 v5, 13, v5
    v_lshl_add_u32 v10, v6, 4, v5
    v_add_u32 v5, 2, v3
    v_lshlrev_b32 v6, 2, v5
    v_xor_b32 v6, v6, v4
    v_xor_b32 v6, 2, v6
    v_add3_u32 v5, s20, v5, 8
    v_lshlrev_b32 v5, 13, v5
    v_lshl_add_u32 v11, v6, 4, v5
    v_and_b32 v5, 3, v1
    v_lshrrev_b32 v6, 2, v1
    v_lshl_add_u32 v36, v6, 3, v5
    v_lshlrev_b32 v36, 9, v36
    v_lshlrev_b32 v5, 2, v5
    v_bfe_u32 v6, v1, 2, 1
    v_lshl_add_u32 v5, v6, 1, v5
    s_and_b32 s21, s4, 1
    s_lshl_b32 s21, s21, 14
    s_add_u32 s21, s21, 131072
    v_add_u32 v6, s21, v36
    v_add_u32 v7, 0, v2
    v_xor_b32 v7, v7, v5
    v_lshlrev_b32 v32, 4, v7
    v_add_u32 v20, v32, v6
    v_add_u32 v7, 4, v2
    v_xor_b32 v7, v7, v5
    v_lshlrev_b32 v33, 4, v7
    v_add_u32 v21, v33, v6
    v_add_u32 v7, 8, v2
    v_xor_b32 v7, v7, v5
    v_lshlrev_b32 v34, 4, v7
    v_add_u32 v22, v34, v6
    v_add_u32 v7, 12, v2
    v_xor_b32 v7, v7, v5
    v_lshlrev_b32 v35, 4, v7
    v_add_u32 v23, v35, v6
    s_cmp_lt_i32 s44, 0
    s_cbranch_scc1 L_pj_onlya
    s_lshl_b32 s22, s44, 11
    s_lshl_b32 s23, s4, 9
    s_add_u32 s22, s22, s23
    v_lshl_add_u32 v30, v0, 3, s22
    v_mov_b32 v6, 4290772927
    v_mov_b32 v7, 4290772927
    s_add_u32 s20, s8, 42778624
    s_addc_u32 s21, s9, 0
    global_store_dwordx2 v30, v[6:7], s[20:21] sc1
    s_mul_i32 s16, s44, 4682
    s_lshr_b32 s16, s16, 16
    s_mul_i32 s20, s16, 14
    s_sub_u32 s17, s44, s20
    s_cmp_ge_u32 s17, 7
    s_cselect_b32 s19, 1, 0
    s_mul_i32 s20, s19, 7
    s_sub_u32 s17, s17, s20
    s_lshl_b32 s20, s19, 11
    s_lshl_b32 s21, s16, 7
    s_add_u32 s20, s20, s21
    s_lshl_b32 s21, s17, 2
    s_add_u32 s33, s20, s21
    s_lshl_b32 s20, s17, 19
    s_lshl_b32 s21, s16, 9
    s_add_u32 s20, s20, s21
    s_add_u32 s10, s28, s20
    s_addc_u32 s11, s29, 0
    s_mul_i32 s20, s16, 401408
    s_lshr_b32 s22, s4, 1
    s_lshl_b32 s23, s19, 3
    s_add_u32 s22, s22, s23
    s_mul_i32 s22, s22, 14
    s_and_b32 s23, s4, 1
    s_add_u32 s22, s22, s23
    s_lshl_b32 s23, s17, 1
    s_add_u32 s22, s22, s23
    s_lshl_b32 s22, s22, 11
    s_add_u32 s20, s20, s22
    s_add_u32 s14, s8, 6422528
    s_addc_u32 s15, s9, 0
    s_add_u32 s14, s14, s20
    s_addc_u32 s15, s15, 0
    s_mul_i32 s21, s16, 229376
    s_mul_i32 s22, s4, 57344
    s_add_u32 s21, s21, s22
    s_lshl_b32 s22, s19, 9
    s_add_u32 s21, s21, s22
    s_add_u32 s12, s30, s21
    s_addc_u32 s13, s31, 0
    v_lshrrev_b32 v5, 3, v0
    v_and_b32 v6, 7, v0
    v_bfe_u32 v7, v0, 4, 1
    v_lshlrev_b32 v7, 1, v7
    v_xor_b32 v6, v6, v7
    v_mul_u32_u24 v5, 896, v5
    v_lshl_add_u32 v12, v6, 4, v5
    v_xor_b32 v6, 4, v6
    v_lshl_add_u32 v13, v6, 4, v5
    v_add_u32 v13, 7168, v13
    v_bfe_u32 v5, v0, 2, 2
    v_lshl_add_u32 v6, v2, 3, v5
    v_lshlrev_b32 v6, 7, v6
    v_and_b32 v7, 1, v0
    v_lshl_add_u32 v6, v7, 3, v6
    v_and_b32 v5, 2, v5
    v_and_b32 v7, 1, v2
    v_lshl_add_u32 v5, v7, 2, v5
    v_bfe_u32 v7, v0, 1, 1
    v_xor_b32 v5, v5, v7
    s_lshr_b32 s21, s4, 1
    s_lshl_b32 s21, s21, 2
    v_xor_b32 v5, s21, v5
    v_lshl_add_u32 v16, v5, 4, v6
    v_xor_b32 v5, 2, v5
    v_lshl_add_u32 v17, v5, 4, v6
    s_add_u32 s22, s10, 32768
    s_addc_u32 s23, s11, 0
    s_add_u32 m0, s18, 131072
    s_nop 0
    global_load_lds_dwordx4 v8, s[10:11] nt
    s_add_u32 m0, s18, 132096
    s_nop 0
    global_load_lds_dwordx4 v9, s[10:11] nt
    s_add_u32 m0, s18, 133120
    s_nop 0
    global_load_lds_dwordx4 v8, s[22:23] nt
    s_add_u32 m0, s18, 134144
    s_nop 0
    global_load_lds_dwordx4 v9, s[22:23] nt
    s_add_u32 m0, s18, 135168
    s_nop 0
    global_load_lds_dwordx4 v10, s[10:11] nt
    s_add_u32 m0, s18, 136192
    s_nop 0
    global_load_lds_dwordx4 v11, s[10:11] nt
    s_add_u32 m0, s18, 137216
    s_nop 0
    global_load_lds_dwordx4 v10, s[22:23] nt
    s_add_u32 m0, s18, 138240
    s_nop 0
    global_load_lds_dwordx4 v11, s[22:23] nt
    s_mov_b64 s[22:23], s[12:13]
    s_add_u32 m0, s18, 0
    s_nop 0
    global_load_lds_dwordx4 v12, s[22:23] nt
    s_add_u32 m0, s18, 1024
    s_nop 0
    global_load_lds_dwordx4 v13, s[22:23] nt
    s_add_u32 s22, s22, 14336
    s_addc_u32 s23, s23, 0
    s_add_u32 m0, s18, 2048
    s_nop 0
    global_load_lds_dwordx4 v12, s[22:23] nt
    s_add_u32 m0, s18, 3072
    s_nop 0
    global_load_lds_dwordx4 v13, s[22:23] nt
    s_add_u32 s22, s22, 14336
    s_addc_u32 s23, s23, 0
    s_add_u32 m0, s18, 4096
    s_nop 0
    global_load_lds_dwordx4 v12, s[22:23] nt
    s_add_u32 m0, s18, 5120
    s_nop 0
    global_load_lds_dwordx4 v13, s[22:23] nt
    s_add_u32 s22, s22, 14336
    s_addc_u32 s23, s23, 0
    s_add_u32 m0, s18, 6144
    s_nop 0
    global_load_lds_dwordx4 v12, s[22:23] nt
    s_add_u32 m0, s18, 7168
    s_nop 0
    global_load_lds_dwordx4 v13, s[22:23] nt
    s_add_u32 s12, s12, 128
    s_addc_u32 s13, s13, 0
    s_mov_b64 s[22:23], s[12:13]
    s_add_u32 m0, s18, 32768
    s_nop 0
    global_load_lds_dwordx4 v12, s[22:23] nt
    s_add_u32 m0, s18, 33792
    s_nop 0
    global_load_lds_dwordx4 v13, s[22:23] nt
    s_add_u32 s22, s22, 14336
    s_addc_u32 s23, s23, 0
    s_add_u32 m0, s18, 34816
    s_nop 0
    global_load_lds_dwordx4 v12, s[22:23] nt
    s_add_u32 m0, s18, 35840
    s_nop 0
    global_load_lds_dwordx4 v13, s[22:23] nt
    s_add_u32 s22, s22, 14336
    s_addc_u32 s23, s23, 0
    s_add_u32 m0, s18, 36864
    s_nop 0
    global_load_lds_dwordx4 v12, s[22:23] nt
    s_add_u32 m0, s18, 37888
    s_nop 0
    global_load_lds_dwordx4 v13, s[22:23] nt
    s_add_u32 s22, s22, 14336
    s_addc_u32 s23, s23, 0
    s_add_u32 m0, s18, 38912
    s_nop 0
    global_load_lds_dwordx4 v12, s[22:23] nt
    s_add_u32 m0, s18, 39936
    s_nop 0
    global_load_lds_dwordx4 v13, s[22:23] nt
    s_add_u32 s12, s12, 128
    s_addc_u32 s13, s13, 0
    s_mov_b64 s[22:23], s[12:13]
    s_add_u32 m0, s18, 65536
    s_nop 0
    global_load_lds_dwordx4 v12, s[22:23] nt
    s_add_u32 m0, s18, 66560
    s_nop 0
    global_load_lds_dwordx4 v13, s[22:23] nt
    s_add_u32 s22, s22, 14336
    s_addc_u32 s23, s23, 0
    s_add_u32 m0, s18, 67584
    s_nop 0
    global_load_lds_dwordx4 v12, s[22:23] nt
    s_add_u32 m0, s18, 68608
    s_nop 0
    global_load_lds_dwordx4 v13, s[22:23] nt
    s_add_u32 s22, s22, 14336
    s_addc_u32 s23, s23, 0
    s_add_u32 m0, s18, 69632
    s_nop 0
    global_load_lds_dwordx4 v12, s[22:23] nt
    s_add_u32 m0, s18, 70656
    s_nop 0
    global_load_lds_dwordx4 v13, s[22:23] nt
    s_add_u32 s22, s22, 14336
    s_addc_u32 s23, s23, 0
    s_add_u32 m0, s18, 71680
    s_nop 0
    global_load_lds_dwordx4 v12, s[22:23] nt
    s_add_u32 m0, s18, 72704
    s_nop 0
    global_load_lds_dwordx4 v13, s[22:23] nt
    s_add_u32 s12, s12, 128
    s_addc_u32 s13, s13, 0
    v_mov_b32 v38, 0
    global_load_dword v37, v38, s[96:97] offset:192 sc1
    s_cmp_lg_u32 s19, 0
    s_cbranch_scc1 L_pj_nv1
    s_mov_b64 s[22:23], s[12:13]
    s_add_u32 m0, s18, 98304
    s_nop 0
    global_load_lds_dwordx4 v12, s[22:23] nt
    s_add_u32 m0, s18, 99328
    s_nop 0
    global_load_lds_dwordx4 v13, s[22:23] nt
    s_add_u32 s22, s22, 14336
    s_addc_u32 s23, s23, 0
    s_add_u32 m0, s18, 100352
    s_nop 0
    global_load_lds_dwordx4 v12, s[22:23] nt
    s_add_u32 m0, s18, 101376
    s_nop 0
    global_load_lds_dwordx4 v13, s[22:23] nt
    s_add_u32 s22, s22, 14336
    s_addc_u32 s23, s23, 0
    s_add_u32 m0, s18, 102400
    s_nop 0
    global_load_lds_dwordx4 v12, s[22:23] nt
    s_add_u32 m0, s18, 103424
    s_nop 0
    global_load_lds_dwordx4 v13, s[22:23] nt
    s_add_u32 s22, s22, 14336
    s_addc_u32 s23, s23, 0
    s_add_u32 m0, s18, 104448
    s_nop 0
    global_load_lds_dwordx4 v12, s[22:23] nt
    s_add_u32 m0, s18, 105472
    s_nop 0
    global_load_lds_dwordx4 v13, s[22:23] nt
L_pj_nv1:
    s_waitcnt vmcnt(25)
    s_barrier
    ds_read_b128 v[64:67], v20 offset:0
    ds_read_b128 v[68:71], v21 offset:0
    ds_read_b128 v[72:75], v22 offset:0
    ds_read_b128 v[76:79], v23 offset:0
    ds_read_b128 v[80:83], v20 offset:256
    ds_read_b128 v[84:87], v21 offset:256
    ds_read_b128 v[88:91], v22 offset:256
    ds_read_b128 v[92:95], v23 offset:256
    s_waitcnt lgkmcnt(0)
    ds_read_b128 v[96:99], v20 offset:2048
    ds_read_b128 v[100:103], v21 offset:2048
    ds_read_b128 v[104:107], v22 offset:2048
    ds_read_b128 v[108:111], v23 offset:2048
    ds_read_b128 v[112:115], v20 offset:2304
    ds_read_b128 v[116:119], v21 offset:2304
    ds_read_b128 v[120:123], v22 offset:2304
    ds_read_b128 v[124:127], v23 offset:2304
    s_waitcnt lgkmcnt(0)
    v_add_u32 v24, 0, v16
    v_add_u32 v25, 0, v17
    s_waitcnt vmcnt(17)
    s_barrier
    ds_read_b64_tr_b16 v[128:129], v24 offset:0
    ds_read_b64_tr_b16 v[130:131], v24 offset:512
    ds_read_b64_tr_b16 v[132:133], v25 offset:0
    ds_read_b64_tr_b16 v[134:135], v25 offset:512
    ds_read_b64_tr_b16 v[136:137], v24 offset:4096
    ds_read_b64_tr_b16 v[138:139], v24 offset:4608
    ds_read_b64_tr_b16 v[140:141], v25 offset:4096
    ds_read_b64_tr_b16 v[142:143], v25 offset:4608
    s_waitcnt lgkmcnt(6)
    v_mfma_f32_16x16x32_bf16 v[160:163], v[64:67], v[128:131], 0
    ds_read_b64_tr_b16 v[144:145], v24 offset:8192
    ds_read_b64_tr_b16 v[146:147], v24 offset:8704
    ds_read_b64_tr_b16 v[148:149], v25 offset:8192
    ds_read_b64_tr_b16 v[150:151], v25 offset:8704
    v_mfma_f32_16x16x32_bf16 v[168:171], v[96:99], v[128:131], 0
    s_waitcnt lgkmcnt(8)
    v_mfma_f32_16x16x32_bf16 v[164:167], v[64:67], v[132:135], 0
    v_mfma_f32_16x16x32_bf16 v[172:175], v[96:99], v[132:135], 0
    s_waitcnt lgkmcnt(6)
    v_mfma_f32_16x16x32_bf16 v[160:163], v[68:71], v[136:139], v[160:163]
    ds_read_b64_tr_b16 v[128:129], v24 offset:12288
    ds_read_b64_tr_b16 v[130:131], v24 offset:12800
    ds_read_b64_tr_b16 v[132:133], v25 offset:12288
    ds_read_b64_tr_b16 v[134:135], v25 offset:12800
    v_mfma_f32_16x16x32_bf16 v[168:171], v[100:103], v[136:139], v[168:171]
    s_waitcnt lgkmcnt(8)
    v_mfma_f32_16x16x32_bf16 v[164:167], v[68:71], v[140:143], v[164:167]
    v_mfma_f32_16x16x32_bf16 v[172:175], v[100:103], v[140:143], v[172:175]
    s_waitcnt lgkmcnt(6)
    v_mfma_f32_16x16x32_bf16 v[160:163], v[72:75], v[144:147], v[160:163]
    ds_read_b64_tr_b16 v[136:137], v24 offset:16384
    ds_read_b64_tr_b16 v[138:139], v24 offset:16896
    ds_read_b64_tr_b16 v[140:141], v25 offset:16384
    ds_read_b64_tr_b16 v[142:143], v25 offset:16896
    v_mfma_f32_16x16x32_bf16 v[168:171], v[104:107], v[144:147], v[168:171]
    s_waitcnt lgkmcnt(8)
    v_mfma_f32_16x16x32_bf16 v[164:167], v[72:75], v[148:151], v[164:167]
    v_mfma_f32_16x16x32_bf16 v[172:175], v[104:107], v[148:151], v[172:175]
    s_waitcnt lgkmcnt(6)
    v_mfma_f32_16x16x32_bf16 v[160:163], v[76:79], v[128:131], v[160:163]
    ds_read_b64_tr_b16 v[144:145], v24 offset:20480
    ds_read_b64_tr_b16 v[146:147], v24 offset:20992
    ds_read_b64_tr_b16 v[148:149], v25 offset:20480
    ds_read_b64_tr_b16 v[150:151], v25 offset:20992
    v_mfma_f32_16x16x32_bf16 v[168:171], v[108:111], v[128:131], v[168:171]
    s_waitcnt lgkmcnt(8)
    v_mfma_f32_16x16x32_bf16 v[164:167], v[76:79], v[132:135], v[164:167]
    v_mfma_f32_16x16x32_bf16 v[172:175], v[108:111], v[132:135], v[172:175]
    s_waitcnt lgkmcnt(6)
    v_mfma_f32_16x16x32_bf16 v[160:163], v[80:83], v[136:139], v[160:163]
    ds_read_b64_tr_b16 v[128:129], v24 offset:24576
    ds_read_b64_tr_b16 v[130:131], v24 offset:25088
    ds_read_b64_tr_b16 v[132:133], v25 offset:24576
    ds_read_b64_tr_b16 v[134:135], v25 offset:25088
    v_mfma_f32_16x16x32_bf16 v[168:171], v[112:115], v[136:139], v[168:171]
    s_waitcnt lgkmcnt(8)
    v_mfma_f32_16x16x32_bf16 v[164:167], v[80:83], v[140:143], v[164:167]
    v_mfma_f32_16x16x32_bf16 v[172:175], v[112:115], v[140:143], v[172:175]
    s_waitcnt lgkmcnt(6)
    v_mfma_f32_16x16x32_bf16 v[160:163], v[84:87], v[144:147], v[160:163]
    ds_read_b64_tr_b16 v[136:137], v24 offset:28672
    ds_read_b64_tr_b16 v[138:139], v24 offset:29184
    ds_read_b64_tr_b16 v[140:141], v25 offset:28672
    ds_read_b64_tr_b16 v[142:143], v25 offset:29184
    v_mfma_f32_16x16x32_bf16 v[168:171], v[116:119], v[144:147], v[168:171]
    s_waitcnt lgkmcnt(8)
    v_mfma_f32_16x16x32_bf16 v[164:167], v[84:87], v[148:151], v[164:167]
    v_mfma_f32_16x16x32_bf16 v[172:175], v[116:119], v[148:151], v[172:175]
    s_waitcnt lgkmcnt(6)
    v_mfma_f32_16x16x32_bf16 v[160:163], v[88:91], v[128:131], v[160:163]
    v_mfma_f32_16x16x32_bf16 v[168:171], v[120:123], v[128:131], v[168:171]
    s_waitcnt lgkmcnt(4)
    v_mfma_f32_16x16x32_bf16 v[164:167], v[88:91], v[132:135], v[164:167]
    v_mfma_f32_16x16x32_bf16 v[172:175], v[120:123], v[132:135], v[172:175]
    s_waitcnt lgkmcnt(2)
    v_mfma_f32_16x16x32_bf16 v[160:163], v[92:95], v[136:139], v[160:163]
    v_mfma_f32_16x16x32_bf16 v[168:171], v[124:127], v[136:139], v[168:171]
    s_waitcnt lgkmcnt(0)
    v_mfma_f32_16x16x32_bf16 v[164:167], v[92:95], v[140:143], v[164:167]
    v_mfma_f32_16x16x32_bf16 v[172:175], v[124:127], v[140:143], v[172:175]
    v_cvt_pk_bf16_f32 v176, v160, v161
    s_nop 1
    v_cvt_pk_bf16_f32 v177, v164, v165
    v_cvt_pk_bf16_f32 v178, v162, v163
    v_cvt_pk_bf16_f32 v179, v166, v167
    v_cvt_pk_bf16_f32 v180, v168, v169
    v_cvt_pk_bf16_f32 v181, v172, v173
    v_cvt_pk_bf16_f32 v182, v170, v171
    v_cvt_pk_bf16_f32 v183, v174, v175
    global_store_dwordx4 v28, v[176:179], s[14:15] sc1
    global_store_dwordx4 v28, v[180:183], s[14:15] offset:1024 sc1
    s_add_u32 s14, s14, 57344
    s_addc_u32 s15, s15, 0
    v_add_u32 v24, 32768, v16
    v_add_u32 v25, 32768, v17
    s_waitcnt vmcnt(11)
    s_barrier
    ds_read_b64_tr_b16 v[128:129], v24 offset:0
    ds_read_b64_tr_b16 v[130:131], v24 offset:512
    ds_read_b64_tr_b16 v[132:133], v25 offset:0
    ds_read_b64_tr_b16 v[134:135], v25 offset:512
    ds_read_b64_tr_b16 v[136:137], v24 offset:4096
    ds_read_b64_tr_b16 v[138:139], v24 offset:4608
    ds_read_b64_tr_b16 v[140:141], v25 offset:4096
    ds_read_b64_tr_b16 v[142:143], v25 offset:4608
    s_waitcnt lgkmcnt(6)
    v_mfma_f32_16x16x32_bf16 v[160:163], v[64:67], v[128:131], 0
    ds_read_b64_tr_b16 v[144:145], v24 offset:8192
    ds_read_b64_tr_b16 v[146:147], v24 offset:8704
    ds_read_b64_tr_b16 v[148:149], v25 offset:8192
    ds_read_b64_tr_b16 v[150:151], v25 offset:8704
    v_mfma_f32_16x16x32_bf16 v[168:171], v[96:99], v[128:131], 0
    s_waitcnt lgkmcnt(8)
    v_mfma_f32_16x16x32_bf16 v[164:167], v[64:67], v[132:135], 0
    v_mfma_f32_16x16x32_bf16 v[172:175], v[96:99], v[132:135], 0
    s_waitcnt lgkmcnt(6)
    v_mfma_f32_16x16x32_bf16 v[160:163], v[68:71], v[136:139], v[160:163]
    ds_read_b64_tr_b16 v[128:129], v24 offset:12288
    ds_read_b64_tr_b16 v[130:131], v24 offset:12800
    ds_read_b64_tr_b16 v[132:133], v25 offset:12288
    ds_read_b64_tr_b16 v[134:135], v25 offset:12800
    v_mfma_f32_16x16x32_bf16 v[168:171], v[100:103], v[136:139], v[168:171]
    s_waitcnt lgkmcnt(8)
    v_mfma_f32_16x16x32_bf16 v[164:167], v[68:71], v[140:143], v[164:167]
    v_mfma_f32_16x16x32_bf16 v[172:175], v[100:103], v[140:143], v[172:175]
    s_waitcnt lgkmcnt(6)
    v_mfma_f32_16x16x32_bf16 v[160:163], v[72:75], v[144:147], v[160:163]
    ds_read_b64_tr_b16 v[136:137], v24 offset:16384
    ds_read_b64_tr_b16 v[138:139], v24 offset:16896
    ds_read_b64_tr_b16 v[140:141], v25 offset:16384
    ds_read_b64_tr_b16 v[142:143], v25 offset:16896
    v_mfma_f32_16x16x32_bf16 v[168:171], v[104:107], v[144:147], v[168:171]
    s_waitcnt lgkmcnt(8)
    v_mfma_f32_16x16x32_bf16 v[164:167], v[72:75], v[148:151], v[164:167]
    v_mfma_f32_16x16x32_bf16 v[172:175], v[104:107], v[148:151], v[172:175]
    s_waitcnt lgkmcnt(6)
    v_mfma_f32_16x16x32_bf16 v[160:163], v[76:79], v[128:131], v[160:163]
    ds_read_b64_tr_b16 v[144:145], v24 offset:20480
    ds_read_b64_tr_b16 v[146:147], v24 offset:20992
    ds_read_b64_tr_b16 v[148:149], v25 offset:20480
    ds_read_b64_tr_b16 v[150:151], v25 offset:20992
    v_mfma_f32_16x16x32_bf16 v[168:171], v[108:111], v[128:131], v[168:171]
    s_waitcnt lgkmcnt(8)
    v_mfma_f32_16x16x32_bf16 v[164:167], v[76:79], v[132:135], v[164:167]
    v_mfma_f32_16x16x32_bf16 v[172:175], v[108:111], v[132:135], v[172:175]
    s_waitcnt lgkmcnt(6)
    v_mfma_f32_16x16x32_bf16 v[160:163], v[80:83], v[136:139], v[160:163]
    ds_read_b64_tr_b16 v[128:129], v24 offset:24576
    ds_read_b64_tr_b16 v[130:131], v24 offset:25088
    ds_read_b64_tr_b16 v[132:133], v25 offset:24576
    ds_read_b64_tr_b16 v[134:135], v25 offset:25088
    v_mfma_f32_16x16x32_bf16 v[168:171], v[112:115], v[136:139], v[168:171]
    s_waitcnt lgkmcnt(8)
    v_mfma_f32_16x16x32_bf16 v[164:167], v[80:83], v[140:143], v[164:167]
    v_mfma_f32_16x16x32_bf16 v[172:175], v[112:115], v[140:143], v[172:175]
    s_waitcnt lgkmcnt(6)
    v_mfma_f32_16x16x32_bf16 v[160:163], v[84:87], v[144:147], v[160:163]
    ds_read_b64_tr_b16 v[136:137], v24 offset:28672
    ds_read_b64_tr_b16 v[138:139], v24 offset:29184
    ds_read_b64_tr_b16 v[140:141], v25 offset:28672
    ds_read_b64_tr_b16 v[142:143], v25 offset:29184
    v_mfma_f32_16x16x32_bf16 v[168:171], v[116:119], v[144:147], v[168:171]
    s_waitcnt lgkmcnt(8)
    v_mfma_f32_16x16x32_bf16 v[164:167], v[84:87], v[148:151], v[164:167]
    v_mfma_f32_16x16x32_bf16 v[172:175], v[116:119], v[148:151], v[172:175]
    s_waitcnt lgkmcnt(6)
    v_mfma_f32_16x16x32_bf16 v[160:163], v[88:91], v[128:131], v[160:163]
    v_mfma_f32_16x16x32_bf16 v[168:171], v[120:123], v[128:131], v[168:171]
    s_waitcnt lgkmcnt(4)
    v_mfma_f32_16x16x32_bf16 v[164:167], v[88:91], v[132:135], v[164:167]
    v_mfma_f32_16x16x32_bf16 v[172:175], v[120:123], v[132:135], v[172:175]
    s_waitcnt lgkmcnt(2)
    v_mfma_f32_16x16x32_bf16 v[160:163], v[92:95], v[136:139], v[160:163]
    v_mfma_f32_16x16x32_bf16 v[168:171], v[124:127], v[136:139], v[168:171]
    s_waitcnt lgkmcnt(0)
    v_mfma_f32_16x16x32_bf16 v[164:167], v[92:95], v[140:143], v[164:167]
    v_mfma_f32_16x16x32_bf16 v[172:175], v[124:127], v[140:143], v[172:175]
    v_cvt_pk_bf16_f32 v184, v160, v161
    s_nop 1
    v_cvt_pk_bf16_f32 v185, v164, v165
    v_cvt_pk_bf16_f32 v186, v162, v163
    v_cvt_pk_bf16_f32 v187, v166, v167
    v_cvt_pk_bf16_f32 v188, v168, v169
    v_cvt_pk_bf16_f32 v189, v172, v173
    v_cvt_pk_bf16_f32 v190, v170, v171
    v_cvt_pk_bf16_f32 v191, v174, v175
    global_store_dwordx4 v28, v[184:187], s[14:15] sc1
    global_store_dwordx4 v28, v[188:191], s[14:15] offset:1024 sc1
    s_add_u32 s14, s14, 57344
    s_addc_u32 s15, s15, 0
    v_add_u32 v24, 65536, v16
    v_add_u32 v25, 65536, v17
    s_waitcnt vmcnt(5)
    s_barrier
    ds_read_b64_tr_b16 v[128:129], v24 offset:0
    ds_read_b64_tr_b16 v[130:131], v24 offset:512
    ds_read_b64_tr_b16 v[132:133], v25 offset:0
    ds_read_b64_tr_b16 v[134:135], v25 offset:512
    ds_read_b64_tr_b16 v[136:137], v24 offset:4096
    ds_read_b64_tr_b16 v[138:139], v24 offset:4608
    ds_read_b64_tr_b16 v[140:141], v25 offset:4096
    ds_read_b64_tr_b16 v[142:143], v25 offset:4608
    s_waitcnt lgkmcnt(6)
    v_mfma_f32_16x16x32_bf16 v[160:163], v[64:67], v[128:131], 0
    ds_read_b64_tr_b16 v[144:145], v24 offset:8192
    ds_read_b64_tr_b16 v[146:147], v24 offset:8704
    ds_read_b64_tr_b16 v[148:149], v25 offset:8192
    ds_read_b64_tr_b16 v[150:151], v25 offset:8704
    v_mfma_f32_16x16x32_bf16 v[168:171], v[96:99], v[128:131], 0
    s_waitcnt lgkmcnt(8)
    v_mfma_f32_16x16x32_bf16 v[164:167], v[64:67], v[132:135], 0
    v_mfma_f32_16x16x32_bf16 v[172:175], v[96:99], v[132:135], 0
    s_waitcnt lgkmcnt(6)
    v_mfma_f32_16x16x32_bf16 v[160:163], v[68:71], v[136:139], v[160:163]
    ds_read_b64_tr_b16 v[128:129], v24 offset:12288
    ds_read_b64_tr_b16 v[130:131], v24 offset:12800
    ds_read_b64_tr_b16 v[132:133], v25 offset:12288
    ds_read_b64_tr_b16 v[134:135], v25 offset:12800
    v_mfma_f32_16x16x32_bf16 v[168:171], v[100:103], v[136:139], v[168:171]
    s_waitcnt lgkmcnt(8)
    v_mfma_f32_16x16x32_bf16 v[164:167], v[68:71], v[140:143], v[164:167]
    v_mfma_f32_16x16x32_bf16 v[172:175], v[100:103], v[140:143], v[172:175]
    s_waitcnt lgkmcnt(6)
    v_mfma_f32_16x16x32_bf16 v[160:163], v[72:75], v[144:147], v[160:163]
    ds_read_b64_tr_b16 v[136:137], v24 offset:16384
    ds_read_b64_tr_b16 v[138:139], v24 offset:16896
    ds_read_b64_tr_b16 v[140:141], v25 offset:16384
    ds_read_b64_tr_b16 v[142:143], v25 offset:16896
    v_mfma_f32_16x16x32_bf16 v[168:171], v[104:107], v[144:147], v[168:171]
    s_waitcnt lgkmcnt(8)
    v_mfma_f32_16x16x32_bf16 v[164:167], v[72:75], v[148:151], v[164:167]
    v_mfma_f32_16x16x32_bf16 v[172:175], v[104:107], v[148:151], v[172:175]
    s_waitcnt lgkmcnt(6)
    v_mfma_f32_16x16x32_bf16 v[160:163], v[76:79], v[128:131], v[160:163]
    ds_read_b64_tr_b16 v[144:145], v24 offset:20480
    ds_read_b64_tr_b16 v[146:147], v24 offset:20992
    ds_read_b64_tr_b16 v[148:149], v25 offset:20480
    ds_read_b64_tr_b16 v[150:151], v25 offset:20992
    v_mfma_f32_16x16x32_bf16 v[168:171], v[108:111], v[128:131], v[168:171]
    s_waitcnt lgkmcnt(8)
    v_mfma_f32_16x16x32_bf16 v[164:167], v[76:79], v[132:135], v[164:167]
    v_mfma_f32_16x16x32_bf16 v[172:175], v[108:111], v[132:135], v[172:175]
    s_waitcnt lgkmcnt(6)
    v_mfma_f32_16x16x32_bf16 v[160:163], v[80:83], v[136:139], v[160:163]
    ds_read_b64_tr_b16 v[128:129], v24 offset:24576
    ds_read_b64_tr_b16 v[130:131], v24 offset:25088
    ds_read_b64_tr_b16 v[132:133], v25 offset:24576
    ds_read_b64_tr_b16 v[134:135], v25 offset:25088
    v_mfma_f32_16x16x32_bf16 v[168:171], v[112:115], v[136:139], v[168:171]
    s_waitcnt lgkmcnt(8)
    v_mfma_f32_16x16x32_bf16 v[164:167], v[80:83], v[140:143], v[164:167]
    v_mfma_f32_16x16x32_bf16 v[172:175], v[112:115], v[140:143], v[172:175]
    s_waitcnt lgkmcnt(6)
    v_mfma_f32_16x16x32_bf16 v[160:163], v[84:87], v[144:147], v[160:163]
    ds_read_b64_tr_b16 v[136:137], v24 offset:28672
    ds_read_b64_tr_b16 v[138:139], v24 offset:29184
    ds_read_b64_tr_b16 v[140:141], v25 offset:28672
    ds_read_b64_tr_b16 v[142:143], v25 offset:29184
    v_mfma_f32_16x16x32_bf16 v[168:171], v[116:119], v[144:147], v[168:171]
    s_waitcnt lgkmcnt(8)
    v_mfma_f32_16x16x32_bf16 v[164:167], v[84:87], v[148:151], v[164:167]
    v_mfma_f32_16x16x32_bf16 v[172:175], v[116:119], v[148:151], v[172:175]
    s_waitcnt lgkmcnt(6)
    v_mfma_f32_16x16x32_bf16 v[160:163], v[88:91], v[128:131], v[160:163]
    v_mfma_f32_16x16x32_bf16 v[168:171], v[120:123], v[128:131], v[168:171]
    s_waitcnt lgkmcnt(4)
    v_mfma_f32_16x16x32_bf16 v[164:167], v[88:91], v[132:135], v[164:167]
    v_mfma_f32_16x16x32_bf16 v[172:175], v[120:123], v[132:135], v[172:175]
    s_waitcnt lgkmcnt(2)
    v_mfma_f32_16x16x32_bf16 v[160:163], v[92:95], v[136:139], v[160:163]
    v_mfma_f32_16x16x32_bf16 v[168:171], v[124:127], v[136:139], v[168:171]
    s_waitcnt lgkmcnt(0)
    v_mfma_f32_16x16x32_bf16 v[164:167], v[92:95], v[140:143], v[164:167]
    v_mfma_f32_16x16x32_bf16 v[172:175], v[124:127], v[140:143], v[172:175]
    v_cvt_pk_bf16_f32 v176, v160, v161
    s_nop 1
    v_cvt_pk_bf16_f32 v177, v164, v165
    v_cvt_pk_bf16_f32 v178, v162, v163
    v_cvt_pk_bf16_f32 v179, v166, v167
    v_cvt_pk_bf16_f32 v180, v168, v169
    v_cvt_pk_bf16_f32 v181, v172, v173
    v_cvt_pk_bf16_f32 v182, v170, v171
    v_cvt_pk_bf16_f32 v183, v174, v175
    global_store_dwordx4 v28, v[176:179], s[14:15] sc1
    global_store_dwordx4 v28, v[180:183], s[14:15] offset:1024 sc1
    s_add_u32 s14, s14, 57344
    s_addc_u32 s15, s15, 0
    v_add_u32 v24, 98304, v16
    v_add_u32 v25, 98304, v17
    s_waitcnt vmcnt(6)
    s_barrier
    s_cmp_lg_u32 s19, 0
    s_cbranch_scc1 L_pj_done1
    ds_read_b64_tr_b16 v[128:129], v24 offset:0
    ds_read_b64_tr_b16 v[130:131], v24 offset:512
    ds_read_b64_tr_b16 v[132:133], v25 offset:0
    ds_read_b64_tr_b16 v[134:135], v25 offset:512
    ds_read_b64_tr_b16 v[136:137], v24 offset:4096
    ds_read_b64_tr_b16 v[138:139], v24 offset:4608
    ds_read_b64_tr_b16 v[140:141], v25 offset:4096
    ds_read_b64_tr_b16 v[142:143], v25 offset:4608
    s_waitcnt lgkmcnt(6)
    v_mfma_f32_16x16x32_bf16 v[160:163], v[64:67], v[128:131], 0
    ds_read_b64_tr_b16 v[144:145], v24 offset:8192
    ds_read_b64_tr_b16 v[146:147], v24 offset:8704
    ds_read_b64_tr_b16 v[148:149], v25 offset:8192
    ds_read_b64_tr_b16 v[150:151], v25 offset:8704
    v_mfma_f32_16x16x32_bf16 v[168:171], v[96:99], v[128:131], 0
    s_waitcnt lgkmcnt(8)
    v_mfma_f32_16x16x32_bf16 v[164:167], v[64:67], v[132:135], 0
    v_mfma_f32_16x16x32_bf16 v[172:175], v[96:99], v[132:135], 0
    s_waitcnt lgkmcnt(6)
    v_mfma_f32_16x16x32_bf16 v[160:163], v[68:71], v[136:139], v[160:163]
    ds_read_b64_tr_b16 v[128:129], v24 offset:12288
    ds_read_b64_tr_b16 v[130:131], v24 offset:12800
    ds_read_b64_tr_b16 v[132:133], v25 offset:12288
    ds_read_b64_tr_b16 v[134:135], v25 offset:12800
    v_mfma_f32_16x16x32_bf16 v[168:171], v[100:103], v[136:139], v[168:171]
    s_waitcnt lgkmcnt(8)
    v_mfma_f32_16x16x32_bf16 v[164:167], v[68:71], v[140:143], v[164:167]
    v_mfma_f32_16x16x32_bf16 v[172:175], v[100:103], v[140:143], v[172:175]
    s_waitcnt lgkmcnt(6)
    v_mfma_f32_16x16x32_bf16 v[160:163], v[72:75], v[144:147], v[160:163]
    ds_read_b64_tr_b16 v[136:137], v24 offset:16384
    ds_read_b64_tr_b16 v[138:139], v24 offset:16896
    ds_read_b64_tr_b16 v[140:141], v25 offset:16384
    ds_read_b64_tr_b16 v[142:143], v25 offset:16896
    v_mfma_f32_16x16x32_bf16 v[168:171], v[104:107], v[144:147], v[168:171]
    s_waitcnt lgkmcnt(8)
    v_mfma_f32_16x16x32_bf16 v[164:167], v[72:75], v[148:151], v[164:167]
    v_mfma_f32_16x16x32_bf16 v[172:175], v[104:107], v[148:151], v[172:175]
    s_waitcnt lgkmcnt(6)
    v_mfma_f32_16x16x32_bf16 v[160:163], v[76:79], v[128:131], v[160:163]
    ds_read_b64_tr_b16 v[144:145], v24 offset:20480
    ds_read_b64_tr_b16 v[146:147], v24 offset:20992
    ds_read_b64_tr_b16 v[148:149], v25 offset:20480
    ds_read_b64_tr_b16 v[150:151], v25 offset:20992
    v_mfma_f32_16x16x32_bf16 v[168:171], v[108:111], v[128:131], v[168:171]
    s_waitcnt lgkmcnt(8)
    v_mfma_f32_16x16x32_bf16 v[164:167], v[76:79], v[132:135], v[164:167]
    v_mfma_f32_16x16x32_bf16 v[172:175], v[108:111], v[132:135], v[172:175]
    s_waitcnt lgkmcnt(6)
    v_mfma_f32_16x16x32_bf16 v[160:163], v[80:83], v[136:139], v[160:163]
    ds_read_b64_tr_b16 v[128:129], v24 offset:24576
    ds_read_b64_tr_b16 v[130:131], v24 offset:25088
    ds_read_b64_tr_b16 v[132:133], v25 offset:24576
    ds_read_b64_tr_b16 v[134:135], v25 offset:25088
    v_mfma_f32_16x16x32_bf16 v[168:171], v[112:115], v[136:139], v[168:171]
    s_waitcnt lgkmcnt(8)
    v_mfma_f32_16x16x32_bf16 v[164:167], v[80:83], v[140:143], v[164:167]
    v_mfma_f32_16x16x32_bf16 v[172:175], v[112:115], v[140:143], v[172:175]
    s_waitcnt lgkmcnt(6)
    v_mfma_f32_16x16x32_bf16 v[160:163], v[84:87], v[144:147], v[160:163]
    ds_read_b64_tr_b16 v[136:137], v24 offset:28672
    ds_read_b64_tr_b16 v[138:139], v24 offset:29184
    ds_read_b64_tr_b16 v[140:141], v25 offset:28672
    ds_read_b64_tr_b16 v[142:143], v25 offset:29184
    v_mfma_f32_16x16x32_bf16 v[168:171], v[116:119], v[144:147], v[168:171]
    s_waitcnt lgkmcnt(8)
    v_mfma_f32_16x16x32_bf16 v[164:167], v[84:87], v[148:151], v[164:167]
    v_mfma_f32_16x16x32_bf16 v[172:175], v[116:119], v[148:151], v[172:175]
    s_waitcnt lgkmcnt(6)
    v_mfma_f32_16x16x32_bf16 v[160:163], v[88:91], v[128:131], v[160:163]
    v_mfma_f32_16x16x32_bf16 v[168:171], v[120:123], v[128:131], v[168:171]
    s_waitcnt lgkmcnt(4)
    v_mfma_f32_16x16x32_bf16 v[164:167], v[88:91], v[132:135], v[164:167]
    v_mfma_f32_16x16x32_bf16 v[172:175], v[120:123], v[132:135], v[172:175]
    s_waitcnt lgkmcnt(2)
    v_mfma_f32_16x16x32_bf16 v[160:163], v[92:95], v[136:139], v[160:163]
    v_mfma_f32_16x16x32_bf16 v[168:171], v[124:127], v[136:139], v[168:171]
    s_waitcnt lgkmcnt(0)
    v_mfma_f32_16x16x32_bf16 v[164:167], v[92:95], v[140:143], v[164:167]
    v_mfma_f32_16x16x32_bf16 v[172:175], v[124:127], v[140:143], v[172:175]
    v_cvt_pk_bf16_f32 v184, v160, v161
    s_nop 1
    v_cvt_pk_bf16_f32 v185, v164, v165
    v_cvt_pk_bf16_f32 v186, v162, v163
    v_cvt_pk_bf16_f32 v187, v166, v167
    v_cvt_pk_bf16_f32 v188, v168, v169
    v_cvt_pk_bf16_f32 v189, v172, v173
    v_cvt_pk_bf16_f32 v190, v170, v171
    v_cvt_pk_bf16_f32 v191, v174, v175
    global_store_dwordx4 v28, v[184:187], s[14:15] sc1
    global_store_dwordx4 v28, v[188:191], s[14:15] offset:1024 sc1
    s_add_u32 s14, s14, 57344
    s_addc_u32 s15, s15, 0
L_pj_done1:
    v_cmp_eq_u32 vcc, 0, v37
    s_cbranch_vccz L_pj_iok
    v_mov_b32 v30, 0
    s_mov_b32 s42, 0
L_pj_i1_rp:
    global_load_dword v31, v30, s[96:97] offset:192 sc1
    s_add_u32 s42, s42, 1
    s_cmp_gt_u32 s42, 1048576
    s_cbranch_scc1 L_bail
    s_waitcnt vmcnt(0)
    v_cmp_eq_u32 vcc, 0, v31
    s_cbranch_vccz L_pj_i1_rb
    s_sleep 2
    s_branch L_pj_i1_rp
L_pj_i1_rb:
L_pj_iok:
    s_cmp_ge_i32 s45, 0
    s_cbranch_scc1 L_pj_both
    s_waitcnt vmcnt(0)
    s_barrier
    s_cmp_lg_u32 s4, 0
    s_cbranch_scc1 L_pj_nfx
    v_mov_b32 v30, s33
    v_mov_b32 v31, 1
    s_add_u32 s20, s8, 43982848
    s_addc_u32 s21, s9, 0
    global_store_dword v30, v31, s[20:21] sc1
L_pj_nfx:
    s_branch L_pj_end
L_pj_onlya:
    v_mov_b32 v30, 0
    s_mov_b32 s42, 0
L_pj_i0_rp:
    global_load_dword v31, v30, s[96:97] offset:192 sc1
    s_add_u32 s42, s42, 1
    s_cmp_gt_u32 s42, 1048576
    s_cbranch_scc1 L_bail
    s_waitcnt vmcnt(0)
    v_cmp_eq_u32 vcc, 0, v31
    s_cbranch_vccz L_pj_i0_rb
    s_sleep 2
    s_branch L_pj_i0_rp
L_pj_i0_rb:
    s_cmp_lt_i32 s45, 0
    s_cbranch_scc1 L_pj_end
L_pj_both:
    s_mul_i32 s16, s45, 4682
    s_lshr_b32 s16, s16, 16
    s_mul_i32 s20, s16, 14
    s_sub_u32 s17, s45, s20
    s_cmp_ge_u32 s17, 7
    s_cselect_b32 s19, 1, 0
    s_mul_i32 s20, s19, 7
    s_sub_u32 s17, s17, s20
    s_lshl_b32 s20, s19, 11
    s_lshl_b32 s21, s16, 7
    s_add_u32 s20, s20, s21
    s_lshl_b32 s21, s17, 2
    s_add_u32 s32, s20, s21
    s_lshl_b32 s20, s17, 19
    s_lshl_b32 s21, s16, 9
    s_add_u32 s20, s20, s21
    s_add_u32 s10, s24, s20
    s_addc_u32 s11, s25, 0
    s_mul_i32 s20, s16, 401408
    s_lshr_b32 s22, s4, 1
    s_lshl_b32 s23, s19, 3
    s_add_u32 s22, s22, s23
    s_mul_i32 s22, s22, 14
    s_and_b32 s23, s4, 1
    s_add_u32 s22, s22, s23
    s_lshl_b32 s23, s17, 1
    s_add_u32 s22, s22, s23
    s_lshl_b32 s22, s22, 11
    s_add_u32 s20, s20, s22
    s_add_u32 s14, s8, 0
    s_addc_u32 s15, s9, 0
    s_add_u32 s14, s14, s20
    s_addc_u32 s15, s15, 0
    s_lshl_b32 s22, s19, 21
    s_add_u32 s21, s21, s22
    s_add_u32 s12, s26, s21
    s_addc_u32 s13, s27, 0
    s_lshr_b32 s21, s4, 1
    s_lshl_b32 s21, s21, 5
    v_bfe_u32 v5, v1, 2, 1
    v_lshlrev_b32 v5, 4, v5
    v_lshrrev_b32 v6, 3, v1
    v_lshl_add_u32 v5, v6, 2, v5
    v_and_b32 v6, 3, v1
    v_add3_u32 v5, v5, v6, s21
    v_lshlrev_b32 v5, 9, v5
    s_and_b32 s21, s4, 1
    s_lshl_b32 s21, s21, 5
    v_add_u32 v16, v32, v5
    v_add_u32 v17, v33, v5
    v_add_u32 v18, v34, v5
    v_add_u32 v19, v35, v5
    v_xor_b32 v12, s21, v8
    v_xor_b32 v12, 0, v12
    v_xor_b32 v13, s21, v9
    v_xor_b32 v13, 0, v13
    v_xor_b32 v14, s21, v10
    v_xor_b32 v14, 32, v14
    v_xor_b32 v15, s21, v11
    v_xor_b32 v15, 32, v15
    s_add_u32 s22, s10, 32768
    s_addc_u32 s23, s11, 0
    s_add_u32 m0, s18, 131072
    s_nop 0
    global_load_lds_dwordx4 v8, s[10:11] nt
    s_add_u32 m0, s18, 132096
    s_nop 0
    global_load_lds_dwordx4 v9, s[10:11] nt
    s_add_u32 m0, s18, 133120
    s_nop 0
    global_load_lds_dwordx4 v8, s[22:23] nt
    s_add_u32 m0, s18, 134144
    s_nop 0
    global_load_lds_dwordx4 v9, s[22:23] nt
    s_add_u32 m0, s18, 135168
    s_nop 0
    global_load_lds_dwordx4 v10, s[10:11] nt
    s_add_u32 m0, s18, 136192
    s_nop 0
    global_load_lds_dwordx4 v11, s[10:11] nt
    s_add_u32 m0, s18, 137216
    s_nop 0
    global_load_lds_dwordx4 v10, s[22:23] nt
    s_add_u32 m0, s18, 138240
    s_nop 0
    global_load_lds_dwordx4 v11, s[22:23] nt
    s_cmp_lt_i32 s44, 0
    s_cbranch_scc1 L_pj_nob
    s_waitcnt vmcnt(8)
    s_barrier
    s_cmp_lg_u32 s4, 0
    s_cbranch_scc1 L_pj_nfy
    v_mov_b32 v30, s33
    v_mov_b32 v31, 1
    s_add_u32 s20, s8, 43982848
    s_addc_u32 s21, s9, 0
    global_store_dword v30, v31, s[20:21] sc1
L_pj_nfy:
L_pj_nob:
    s_add_u32 s22, s12, 32768
    s_addc_u32 s23, s13, 0
    s_add_u32 m0, s18, 0
    s_nop 0
    global_load_lds_dwordx4 v12, s[12:13] nt
    s_add_u32 m0, s18, 1024
    s_nop 0
    global_load_lds_dwordx4 v13, s[12:13] nt
    s_add_u32 m0, s18, 2048
    s_nop 0
    global_load_lds_dwordx4 v12, s[22:23] nt
    s_add_u32 m0, s18, 3072
    s_nop 0
    global_load_lds_dwordx4 v13, s[22:23] nt
    s_add_u32 m0, s18, 4096
    s_nop 0
    global_load_lds_dwordx4 v14, s[12:13] nt
    s_add_u32 m0, s18, 5120
    s_nop 0
    global_load_lds_dwordx4 v15, s[12:13] nt
    s_add_u32 m0, s18, 6144
    s_nop 0
    global_load_lds_dwordx4 v14, s[22:23] nt
    s_add_u32 m0, s18, 7168
    s_nop 0
    global_load_lds_dwordx4 v15, s[22:23] nt
    s_add_u32 s12, s12, 524288
    s_addc_u32 s13, s13, 0
    s_add_u32 s22, s12, 32768
    s_addc_u32 s23, s13, 0
    s_add_u32 m0, s18, 32768
    s_nop 0
    global_load_lds_dwordx4 v12, s[12:13] nt
    s_add_u32 m0, s18, 33792
    s_nop 0
    global_load_lds_dwordx4 v13, s[12:13] nt
    s_add_u32 m0, s18, 34816
    s_nop 0
    global_load_lds_dwordx4 v12, s[22:23] nt
    s_add_u32 m0, s18, 35840
    s_nop 0
    global_load_lds_dwordx4 v13, s[22:23] nt
    s_add_u32 m0, s18, 36864
    s_nop 0
    global_load_lds_dwordx4 v14, s[12:13] nt
    s_add_u32 m0, s18, 37888
    s_nop 0
    global_load_lds_dwordx4 v15, s[12:13] nt
    s_add_u32 m0, s18, 38912
    s_nop 0
    global_load_lds_dwordx4 v14, s[22:23] nt
    s_add_u32 m0, s18, 39936
    s_nop 0
    global_load_lds_dwordx4 v15, s[22:23] nt
    s_add_u32 s12, s12, 524288
    s_addc_u32 s13, s13, 0
    s_add_u32 s22, s12, 32768
    s_addc_u32 s23, s13, 0
    s_add_u32 m0, s18, 65536
    s_nop 0
    global_load_lds_dwordx4 v12, s[12:13] nt
    s_add_u32 m0, s18, 66560
    s_nop 0
    global_load_lds_dwordx4 v13, s[12:13] nt
    s_add_u32 m0, s18, 67584
    s_nop 0
    global_load_lds_dwordx4 v12, s[22:23] nt
    s_add_u32 m0, s18, 68608
    s_nop 0
    global_load_lds_dwordx4 v13, s[22:23] nt
    s_add_u32 m0, s18, 69632
    s_nop 0
    global_load_lds_dwordx4 v14, s[12:13] nt
    s_add_u32 m0, s18, 70656
    s_nop 0
    global_load_lds_dwordx4 v15, s[12:13] nt
    s_add_u32 m0, s18, 71680
    s_nop 0
    global_load_lds_dwordx4 v14, s[22:23] nt
    s_add_u32 m0, s18, 72704
    s_nop 0
    global_load_lds_dwordx4 v15, s[22:23] nt
    s_add_u32 s12, s12, 524288
    s_addc_u32 s13, s13, 0
    s_cmp_lg_u32 s19, 0
    s_cbranch_scc1 L_pj_nv0
    s_add_u32 s22, s12, 32768
    s_addc_u32 s23, s13, 0
    s_add_u32 m0, s18, 98304
    s_nop 0
    global_load_lds_dwordx4 v12, s[12:13] nt
    s_add_u32 m0, s18, 99328
    s_nop 0
    global_load_lds_dwordx4 v13, s[12:13] nt
    s_add_u32 m0, s18, 100352
    s_nop 0
    global_load_lds_dwordx4 v12, s[22:23] nt
    s_add_u32 m0, s18, 101376
    s_nop 0
    global_load_lds_dwordx4 v13, s[22:23] nt
    s_add_u32 m0, s18, 102400
    s_nop 0
    global_load_lds_dwordx4 v14, s[12:13] nt
    s_add_u32 m0, s18, 103424
    s_nop 0
    global_load_lds_dwordx4 v15, s[12:13] nt
    s_add_u32 m0, s18, 104448
    s_nop 0
    global_load_lds_dwordx4 v14, s[22:23] nt
    s_add_u32 m0, s18, 105472
    s_nop 0
    global_load_lds_dwordx4 v15, s[22:23] nt
L_pj_nv0:
    s_waitcnt vmcnt(24)
    s_barrier
    ds_read_b128 v[64:67], v20 offset:0
    ds_read_b128 v[68:71], v21 offset:0
    ds_read_b128 v[72:75], v22 offset:0
    ds_read_b128 v[76:79], v23 offset:0
    ds_read_b128 v[80:83], v20 offset:256
    ds_read_b128 v[84:87], v21 offset:256
    ds_read_b128 v[88:91], v22 offset:256
    ds_read_b128 v[92:95], v23 offset:256
    s_waitcnt lgkmcnt(0)
    ds_read_b128 v[96:99], v20 offset:2048
    ds_read_b128 v[100:103], v21 offset:2048
    ds_read_b128 v[104:107], v22 offset:2048
    ds_read_b128 v[108:111], v23 offset:2048
    ds_read_b128 v[112:115], v20 offset:2304
    ds_read_b128 v[116:119], v21 offset:2304
    ds_read_b128 v[120:123], v22 offset:2304
    ds_read_b128 v[124:127], v23 offset:2304
    s_waitcnt lgkmcnt(0)
    v_add_u32 v24, 0, v16
    v_add_u32 v25, 0, v17
    v_add_u32 v26, 0, v18
    v_add_u32 v27, 0, v19
    s_waitcnt vmcnt(16)
    s_barrier
    ds_read_b128 v[128:131], v24 offset:0
    ds_read_b128 v[132:135], v24 offset:4096
    ds_read_b128 v[136:139], v25 offset:0
    ds_read_b128 v[140:143], v25 offset:4096
    s_waitcnt lgkmcnt(3)
    v_mfma_f32_16x16x32_bf16 v[160:163], v[64:67], v[128:131], 0
    ds_read_b128 v[144:147], v26 offset:0
    ds_read_b128 v[148:151], v26 offset:4096
    v_mfma_f32_16x16x32_bf16 v[168:171], v[96:99], v[128:131], 0
    s_waitcnt lgkmcnt(4)
    v_mfma_f32_16x16x32_bf16 v[164:167], v[64:67], v[132:135], 0
    v_mfma_f32_16x16x32_bf16 v[172:175], v[96:99], v[132:135], 0
    s_waitcnt lgkmcnt(3)
    v_mfma_f32_16x16x32_bf16 v[160:163], v[68:71], v[136:139], v[160:163]
    ds_read_b128 v[128:131], v27 offset:0
    ds_read_b128 v[132:135], v27 offset:4096
    v_mfma_f32_16x16x32_bf16 v[168:171], v[100:103], v[136:139], v[168:171]
    s_waitcnt lgkmcnt(4)
    v_mfma_f32_16x16x32_bf16 v[164:167], v[68:71], v[140:143], v[164:167]
    v_mfma_f32_16x16x32_bf16 v[172:175], v[100:103], v[140:143], v[172:175]
    s_waitcnt lgkmcnt(3)
    v_mfma_f32_16x16x32_bf16 v[160:163], v[72:75], v[144:147], v[160:163]
    ds_read_b128 v[136:139], v24 offset:256
    ds_read_b128 v[140:143], v24 offset:4352
    v_mfma_f32_16x16x32_bf16 v[168:171], v[104:107], v[144:147], v[168:171]
    s_waitcnt lgkmcnt(4)
    v_mfma_f32_16x16x32_bf16 v[164:167], v[72:75], v[148:151], v[164:167]
    v_mfma_f32_16x16x32_bf16 v[172:175], v[104:107], v[148:151], v[172:175]
    s_waitcnt lgkmcnt(3)
    v_mfma_f32_16x16x32_bf16 v[160:163], v[76:79], v[128:131], v[160:163]
    ds_read_b128 v[144:147], v25 offset:256
    ds_read_b128 v[148:151], v25 offset:4352
    v_mfma_f32_16x16x32_bf16 v[168:171], v[108:111], v[128:131], v[168:171]
    s_waitcnt lgkmcnt(4)
    v_mfma_f32_16x16x32_bf16 v[164:167], v[76:79], v[132:135], v[164:167]
    v_mfma_f32_16x16x32_bf16 v[172:175], v[108:111], v[132:135], v[172:175]
    s_waitcnt lgkmcnt(3)
    v_mfma_f32_16x16x32_bf16 v[160:163], v[80:83], v[136:139], v[160:163]
    ds_read_b128 v[128:131], v26 offset:256
    ds_read_b128 v[132:135], v26 offset:4352
    v_mfma_f32_16x16x32_bf16 v[168:171], v[112:115], v[136:139], v[168:171]
    s_waitcnt lgkmcnt(4)
    v_mfma_f32_16x16x32_bf16 v[164:167], v[80:83], v[140:143], v[164:167]
    v_mfma_f32_16x16x32_bf16 v[172:175], v[112:115], v[140:143], v[172:175]
    s_waitcnt lgkmcnt(3)
    v_mfma_f32_16x16x32_bf16 v[160:163], v[84:87], v[144:147], v[160:163]
    ds_read_b128 v[136:139], v27 offset:256
    ds_read_b128 v[140:143], v27 offset:4352
    v_mfma_f32_16x16x32_bf16 v[168:171], v[116:119], v[144:147], v[168:171]
    s_waitcnt lgkmcnt(4)
    v_mfma_f32_16x16x32_bf16 v[164:167], v[84:87], v[148:151], v[164:167]
    v_mfma_f32_16x16x32_bf16 v[172:175], v[116:119], v[148:151], v[172:175]
    s_waitcnt lgkmcnt(3)
    v_mfma_f32_16x16x32_bf16 v[160:163], v[88:91], v[128:131], v[160:163]
    v_mfma_f32_16x16x32_bf16 v[168:171], v[120:123], v[128:131], v[168:171]
    s_waitcnt lgkmcnt(2)
    v_mfma_f32_16x16x32_bf16 v[164:167], v[88:91], v[132:135], v[164:167]
    v_mfma_f32_16x16x32_bf16 v[172:175], v[120:123], v[132:135], v[172:175]
    s_waitcnt lgkmcnt(1)
    v_mfma_f32_16x16x32_bf16 v[160:163], v[92:95], v[136:139], v[160:163]
    v_mfma_f32_16x16x32_bf16 v[168:171], v[124:127], v[136:139], v[168:171]
    s_waitcnt lgkmcnt(0)
    v_mfma_f32_16x16x32_bf16 v[164:167], v[92:95], v[140:143], v[164:167]
    v_mfma_f32_16x16x32_bf16 v[172:175], v[124:127], v[140:143], v[172:175]
    v_mul_f32 v160, 0x3db8aa3b, v160
    v_mul_f32 v161, 0x3db8aa3b, v161
    v_mul_f32 v162, 0x3db8aa3b, v162
    v_mul_f32 v163, 0x3db8aa3b, v163
    v_mul_f32 v164, 0x3db8aa3b, v164
    v_mul_f32 v165, 0x3db8aa3b, v165
    v_mul_f32 v166, 0x3db8aa3b, v166
    v_mul_f32 v167, 0x3db8aa3b, v167
    v_mul_f32 v168, 0x3db8aa3b, v168
    v_mul_f32 v169, 0x3db8aa3b, v169
    v_mul_f32 v170, 0x3db8aa3b, v170
    v_mul_f32 v171, 0x3db8aa3b, v171
    v_mul_f32 v172, 0x3db8aa3b, v172
    v_mul_f32 v173, 0x3db8aa3b, v173
    v_mul_f32 v174, 0x3db8aa3b, v174
    v_mul_f32 v175, 0x3db8aa3b, v175
    v_cvt_pk_bf16_f32 v176, v160, v161
    v_cvt_pk_bf16_f32 v177, v164, v165
    v_cvt_pk_bf16_f32 v178, v162, v163
    v_cvt_pk_bf16_f32 v179, v166, v167
    v_cvt_pk_bf16_f32 v180, v168, v169
    v_cvt_pk_bf16_f32 v181, v172, v173
    v_cvt_pk_bf16_f32 v182, v170, v171
    v_cvt_pk_bf16_f32 v183, v174, v175
    global_store_dwordx4 v28, v[176:179], s[14:15] sc1
    global_store_dwordx4 v28, v[180:183], s[14:15] offset:1024 sc1
    s_add_u32 s14, s14, 57344
    s_addc_u32 s15, s15, 0
    v_add_u32 v24, 32768, v16
    v_add_u32 v25, 32768, v17
    v_add_u32 v26, 32768, v18
    v_add_u32 v27, 32768, v19
    s_waitcnt vmcnt(10)
    s_barrier
    ds_read_b128 v[128:131], v24 offset:0
    ds_read_b128 v[132:135], v24 offset:4096
    ds_read_b128 v[136:139], v25 offset:0
    ds_read_b128 v[140:143], v25 offset:4096
    s_waitcnt lgkmcnt(3)
    v_mfma_f32_16x16x32_bf16 v[160:163], v[64:67], v[128:131], 0
    ds_read_b128 v[144:147], v26 offset:0
    ds_read_b128 v[148:151], v26 offset:4096
    v_mfma_f32_16x16x32_bf16 v[168:171], v[96:99], v[128:131], 0
    s_waitcnt lgkmcnt(4)
    v_mfma_f32_16x16x32_bf16 v[164:167], v[64:67], v[132:135], 0
    v_mfma_f32_16x16x32_bf16 v[172:175], v[96:99], v[132:135], 0
    s_waitcnt lgkmcnt(3)
    v_mfma_f32_16x16x32_bf16 v[160:163], v[68:71], v[136:139], v[160:163]
    ds_read_b128 v[128:131], v27 offset:0
    ds_read_b128 v[132:135], v27 offset:4096
    v_mfma_f32_16x16x32_bf16 v[168:171], v[100:103], v[136:139], v[168:171]
    s_waitcnt lgkmcnt(4)
    v_mfma_f32_16x16x32_bf16 v[164:167], v[68:71], v[140:143], v[164:167]
    v_mfma_f32_16x16x32_bf16 v[172:175], v[100:103], v[140:143], v[172:175]
    s_waitcnt lgkmcnt(3)
    v_mfma_f32_16x16x32_bf16 v[160:163], v[72:75], v[144:147], v[160:163]
    ds_read_b128 v[136:139], v24 offset:256
    ds_read_b128 v[140:143], v24 offset:4352
    v_mfma_f32_16x16x32_bf16 v[168:171], v[104:107], v[144:147], v[168:171]
    s_waitcnt lgkmcnt(4)
    v_mfma_f32_16x16x32_bf16 v[164:167], v[72:75], v[148:151], v[164:167]
    v_mfma_f32_16x16x32_bf16 v[172:175], v[104:107], v[148:151], v[172:175]
    s_waitcnt lgkmcnt(3)
    v_mfma_f32_16x16x32_bf16 v[160:163], v[76:79], v[128:131], v[160:163]
    ds_read_b128 v[144:147], v25 offset:256
    ds_read_b128 v[148:151], v25 offset:4352
    v_mfma_f32_16x16x32_bf16 v[168:171], v[108:111], v[128:131], v[168:171]
    s_waitcnt lgkmcnt(4)
    v_mfma_f32_16x16x32_bf16 v[164:167], v[76:79], v[132:135], v[164:167]
    v_mfma_f32_16x16x32_bf16 v[172:175], v[108:111], v[132:135], v[172:175]
    s_waitcnt lgkmcnt(3)
    v_mfma_f32_16x16x32_bf16 v[160:163], v[80:83], v[136:139], v[160:163]
    ds_read_b128 v[128:131], v26 offset:256
    ds_read_b128 v[132:135], v26 offset:4352
    v_mfma_f32_16x16x32_bf16 v[168:171], v[112:115], v[136:139], v[168:171]
    s_waitcnt lgkmcnt(4)
    v_mfma_f32_16x16x32_bf16 v[164:167], v[80:83], v[140:143], v[164:167]
    v_mfma_f32_16x16x32_bf16 v[172:175], v[112:115], v[140:143], v[172:175]
    s_waitcnt lgkmcnt(3)
    v_mfma_f32_16x16x32_bf16 v[160:163], v[84:87], v[144:147], v[160:163]
    ds_read_b128 v[136:139], v27 offset:256
    ds_read_b128 v[140:143], v27 offset:4352
    v_mfma_f32_16x16x32_bf16 v[168:171], v[116:119], v[144:147], v[168:171]
    s_waitcnt lgkmcnt(4)
    v_mfma_f32_16x16x32_bf16 v[164:167], v[84:87], v[148:151], v[164:167]
    v_mfma_f32_16x16x32_bf16 v[172:175], v[116:119], v[148:151], v[172:175]
    s_waitcnt lgkmcnt(3)
    v_mfma_f32_16x16x32_bf16 v[160:163], v[88:91], v[128:131], v[160:163]
    v_mfma_f32_16x16x32_bf16 v[168:171], v[120:123], v[128:131], v[168:171]
    s_waitcnt lgkmcnt(2)
    v_mfma_f32_16x16x32_bf16 v[164:167], v[88:91], v[132:135], v[164:167]
    v_mfma_f32_16x16x32_bf16 v[172:175], v[120:123], v[132:135], v[172:175]
    s_waitcnt lgkmcnt(1)
    v_mfma_f32_16x16x32_bf16 v[160:163], v[92:95], v[136:139], v[160:163]
    v_mfma_f32_16x16x32_bf16 v[168:171], v[124:127], v[136:139], v[168:171]
    s_waitcnt lgkmcnt(0)
    v_mfma_f32_16x16x32_bf16 v[164:167], v[92:95], v[140:143], v[164:167]
    v_mfma_f32_16x16x32_bf16 v[172:175], v[124:127], v[140:143], v[172:175]
    v_mul_f32 v160, 0x3db8aa3b, v160
    v_mul_f32 v161, 0x3db8aa3b, v161
    v_mul_f32 v162, 0x3db8aa3b, v162
    v_mul_f32 v163, 0x3db8aa3b, v163
    v_mul_f32 v164, 0x3db8aa3b, v164
    v_mul_f32 v165, 0x3db8aa3b, v165
    v_mul_f32 v166, 0x3db8aa3b, v166
    v_mul_f32 v167, 0x3db8aa3b, v167
    v_mul_f32 v168, 0x3db8aa3b, v168
    v_mul_f32 v169, 0x3db8aa3b, v169
    v_mul_f32 v170, 0x3db8aa3b, v170
    v_mul_f32 v171, 0x3db8aa3b, v171
    v_mul_f32 v172, 0x3db8aa3b, v172
    v_mul_f32 v173, 0x3db8aa3b, v173
    v_mul_f32 v174, 0x3db8aa3b, v174
    v_mul_f32 v175, 0x3db8aa3b, v175
    v_cvt_pk_bf16_f32 v184, v160, v161
    v_cvt_pk_bf16_f32 v185, v164, v165
    v_cvt_pk_bf16_f32 v186, v162, v163
    v_cvt_pk_bf16_f32 v187, v166, v167
    v_cvt_pk_bf16_f32 v188, v168, v169
    v_cvt_pk_bf16_f32 v189, v172, v173
    v_cvt_pk_bf16_f32 v190, v170, v171
    v_cvt_pk_bf16_f32 v191, v174, v175
    global_store_dwordx4 v28, v[184:187], s[14:15] sc1
    global_store_dwordx4 v28, v[188:191], s[14:15] offset:1024 sc1
    s_add_u32 s14, s14, 57344
    s_addc_u32 s15, s15, 0
    v_add_u32 v24, 65536, v16
    v_add_u32 v25, 65536, v17
    v_add_u32 v26, 65536, v18
    v_add_u32 v27, 65536, v19
    s_waitcnt vmcnt(4)
    s_barrier
    ds_read_b128 v[128:131], v24 offset:0
    ds_read_b128 v[132:135], v24 offset:4096
    ds_read_b128 v[136:139], v25 offset:0
    ds_read_b128 v[140:143], v25 offset:4096
    s_waitcnt lgkmcnt(3)
    v_mfma_f32_16x16x32_bf16 v[160:163], v[64:67], v[128:131], 0
    ds_read_b128 v[144:147], v26 offset:0
    ds_read_b128 v[148:151], v26 offset:4096
    v_mfma_f32_16x16x32_bf16 v[168:171], v[96:99], v[128:131], 0
    s_waitcnt lgkmcnt(4)
    v_mfma_f32_16x16x32_bf16 v[164:167], v[64:67], v[132:135], 0
    v_mfma_f32_16x16x32_bf16 v[172:175], v[96:99], v[132:135], 0
    s_waitcnt lgkmcnt(3)
    v_mfma_f32_16x16x32_bf16 v[160:163], v[68:71], v[136:139], v[160:163]
    ds_read_b128 v[128:131], v27 offset:0
    ds_read_b128 v[132:135], v27 offset:4096
    v_mfma_f32_16x16x32_bf16 v[168:171], v[100:103], v[136:139], v[168:171]
    s_waitcnt lgkmcnt(4)
    v_mfma_f32_16x16x32_bf16 v[164:167], v[68:71], v[140:143], v[164:167]
    v_mfma_f32_16x16x32_bf16 v[172:175], v[100:103], v[140:143], v[172:175]
    s_waitcnt lgkmcnt(3)
    v_mfma_f32_16x16x32_bf16 v[160:163], v[72:75], v[144:147], v[160:163]
    ds_read_b128 v[136:139], v24 offset:256
    ds_read_b128 v[140:143], v24 offset:4352
    v_mfma_f32_16x16x32_bf16 v[168:171], v[104:107], v[144:147], v[168:171]
    s_waitcnt lgkmcnt(4)
    v_mfma_f32_16x16x32_bf16 v[164:167], v[72:75], v[148:151], v[164:167]
    v_mfma_f32_16x16x32_bf16 v[172:175], v[104:107], v[148:151], v[172:175]
    s_waitcnt lgkmcnt(3)
    v_mfma_f32_16x16x32_bf16 v[160:163], v[76:79], v[128:131], v[160:163]
    ds_read_b128 v[144:147], v25 offset:256
    ds_read_b128 v[148:151], v25 offset:4352
    v_mfma_f32_16x16x32_bf16 v[168:171], v[108:111], v[128:131], v[168:171]
    s_waitcnt lgkmcnt(4)
    v_mfma_f32_16x16x32_bf16 v[164:167], v[76:79], v[132:135], v[164:167]
    v_mfma_f32_16x16x32_bf16 v[172:175], v[108:111], v[132:135], v[172:175]
    s_waitcnt lgkmcnt(3)
    v_mfma_f32_16x16x32_bf16 v[160:163], v[80:83], v[136:139], v[160:163]
    ds_read_b128 v[128:131], v26 offset:256
    ds_read_b128 v[132:135], v26 offset:4352
    v_mfma_f32_16x16x32_bf16 v[168:171], v[112:115], v[136:139], v[168:171]
    s_waitcnt lgkmcnt(4)
    v_mfma_f32_16x16x32_bf16 v[164:167], v[80:83], v[140:143], v[164:167]
    v_mfma_f32_16x16x32_bf16 v[172:175], v[112:115], v[140:143], v[172:175]
    s_waitcnt lgkmcnt(3)
    v_mfma_f32_16x16x32_bf16 v[160:163], v[84:87], v[144:147], v[160:163]
    ds_read_b128 v[136:139], v27 offset:256
    ds_read_b128 v[140:143], v27 offset:4352
    v_mfma_f32_16x16x32_bf16 v[168:171], v[116:119], v[144:147], v[168:171]
    s_waitcnt lgkmcnt(4)
    v_mfma_f32_16x16x32_bf16 v[164:167], v[84:87], v[148:151], v[164:167]
    v_mfma_f32_16x16x32_bf16 v[172:175], v[116:119], v[148:151], v[172:175]
    s_waitcnt lgkmcnt(3)
    v_mfma_f32_16x16x32_bf16 v[160:163], v[88:91], v[128:131], v[160:163]
    v_mfma_f32_16x16x32_bf16 v[168:171], v[120:123], v[128:131], v[168:171]
    s_waitcnt lgkmcnt(2)
    v_mfma_f32_16x16x32_bf16 v[164:167], v[88:91], v[132:135], v[164:167]
    v_mfma_f32_16x16x32_bf16 v[172:175], v[120:123], v[132:135], v[172:175]
    s_waitcnt lgkmcnt(1)
    v_mfma_f32_16x16x32_bf16 v[160:163], v[92:95], v[136:139], v[160:163]
    v_mfma_f32_16x16x32_bf16 v[168:171], v[124:127], v[136:139], v[168:171]
    s_waitcnt lgkmcnt(0)
    v_mfma_f32_16x16x32_bf16 v[164:167], v[92:95], v[140:143], v[164:167]
    v_mfma_f32_16x16x32_bf16 v[172:175], v[124:127], v[140:143], v[172:175]
    v_mul_f32 v160, 0x3db8aa3b, v160
    v_mul_f32 v161, 0x3db8aa3b, v161
    v_mul_f32 v162, 0x3db8aa3b, v162
    v_mul_f32 v163, 0x3db8aa3b, v163
    v_mul_f32 v164, 0x3db8aa3b, v164
    v_mul_f32 v165, 0x3db8aa3b, v165
    v_mul_f32 v166, 0x3db8aa3b, v166
    v_mul_f32 v167, 0x3db8aa3b, v167
    v_mul_f32 v168, 0x3db8aa3b, v168
    v_mul_f32 v169, 0x3db8aa3b, v169
    v_mul_f32 v170, 0x3db8aa3b, v170
    v_mul_f32 v171, 0x3db8aa3b, v171
    v_mul_f32 v172, 0x3db8aa3b, v172
    v_mul_f32 v173, 0x3db8aa3b, v173
    v_mul_f32 v174, 0x3db8aa3b, v174
    v_mul_f32 v175, 0x3db8aa3b, v175
    v_cvt_pk_bf16_f32 v176, v160, v161
    v_cvt_pk_bf16_f32 v177, v164, v165
    v_cvt_pk_bf16_f32 v178, v162, v163
    v_cvt_pk_bf16_f32 v179, v166, v167
    v_cvt_pk_bf16_f32 v180, v168, v169
    v_cvt_pk_bf16_f32 v181, v172, v173
    v_cvt_pk_bf16_f32 v182, v170, v171
    v_cvt_pk_bf16_f32 v183, v174, v175
    global_store_dwordx4 v28, v[176:179], s[14:15] sc1
    global_store_dwordx4 v28, v[180:183], s[14:15] offset:1024 sc1
    s_add_u32 s14, s14, 57344
    s_addc_u32 s15, s15, 0
    v_add_u32 v24, 98304, v16
    v_add_u32 v25, 98304, v17
    v_add_u32 v26, 98304, v18
    v_add_u32 v27, 98304, v19
    s_waitcnt vmcnt(6)
    s_barrier
    s_cmp_lg_u32 s19, 0
    s_cbranch_scc1 L_pj_done0
    ds_read_b128 v[128:131], v24 offset:0
    ds_read_b128 v[132:135], v24 offset:4096
    ds_read_b128 v[136:139], v25 offset:0
    ds_read_b128 v[140:143], v25 offset:4096
    s_waitcnt lgkmcnt(3)
    v_mfma_f32_16x16x32_bf16 v[160:163], v[64:67], v[128:131], 0
    ds_read_b128 v[144:147], v26 offset:0
    ds_read_b128 v[148:151], v26 offset:4096
    v_mfma_f32_16x16x32_bf16 v[168:171], v[96:99], v[128:131], 0
    s_waitcnt lgkmcnt(4)
    v_mfma_f32_16x16x32_bf16 v[164:167], v[64:67], v[132:135], 0
    v_mfma_f32_16x16x32_bf16 v[172:175], v[96:99], v[132:135], 0
    s_waitcnt lgkmcnt(3)
    v_mfma_f32_16x16x32_bf16 v[160:163], v[68:71], v[136:139], v[160:163]
    ds_read_b128 v[128:131], v27 offset:0
    ds_read_b128 v[132:135], v27 offset:4096
    v_mfma_f32_16x16x32_bf16 v[168:171], v[100:103], v[136:139], v[168:171]
    s_waitcnt lgkmcnt(4)
    v_mfma_f32_16x16x32_bf16 v[164:167], v[68:71], v[140:143], v[164:167]
    v_mfma_f32_16x16x32_bf16 v[172:175], v[100:103], v[140:143], v[172:175]
    s_waitcnt lgkmcnt(3)
    v_mfma_f32_16x16x32_bf16 v[160:163], v[72:75], v[144:147], v[160:163]
    ds_read_b128 v[136:139], v24 offset:256
    ds_read_b128 v[140:143], v24 offset:4352
    v_mfma_f32_16x16x32_bf16 v[168:171], v[104:107], v[144:147], v[168:171]
    s_waitcnt lgkmcnt(4)
    v_mfma_f32_16x16x32_bf16 v[164:167], v[72:75], v[148:151], v[164:167]
    v_mfma_f32_16x16x32_bf16 v[172:175], v[104:107], v[148:151], v[172:175]
    s_waitcnt lgkmcnt(3)
    v_mfma_f32_16x16x32_bf16 v[160:163], v[76:79], v[128:131], v[160:163]
    ds_read_b128 v[144:147], v25 offset:256
    ds_read_b128 v[148:151], v25 offset:4352
    v_mfma_f32_16x16x32_bf16 v[168:171], v[108:111], v[128:131], v[168:171]
    s_waitcnt lgkmcnt(4)
    v_mfma_f32_16x16x32_bf16 v[164:167], v[76:79], v[132:135], v[164:167]
    v_mfma_f32_16x16x32_bf16 v[172:175], v[108:111], v[132:135], v[172:175]
    s_waitcnt lgkmcnt(3)
    v_mfma_f32_16x16x32_bf16 v[160:163], v[80:83], v[136:139], v[160:163]
    ds_read_b128 v[128:131], v26 offset:256
    ds_read_b128 v[132:135], v26 offset:4352
    v_mfma_f32_16x16x32_bf16 v[168:171], v[112:115], v[136:139], v[168:171]
    s_waitcnt lgkmcnt(4)
    v_mfma_f32_16x16x32_bf16 v[164:167], v[80:83], v[140:143], v[164:167]
    v_mfma_f32_16x16x32_bf16 v[172:175], v[112:115], v[140:143], v[172:175]
    s_waitcnt lgkmcnt(3)
    v_mfma_f32_16x16x32_bf16 v[160:163], v[84:87], v[144:147], v[160:163]
    ds_read_b128 v[136:139], v27 offset:256
    ds_read_b128 v[140:143], v27 offset:4352
    v_mfma_f32_16x16x32_bf16 v[168:171], v[116:119], v[144:147], v[168:171]
    s_waitcnt lgkmcnt(4)
    v_mfma_f32_16x16x32_bf16 v[164:167], v[84:87], v[148:151], v[164:167]
    v_mfma_f32_16x16x32_bf16 v[172:175], v[116:119], v[148:151], v[172:175]
    s_waitcnt lgkmcnt(3)
    v_mfma_f32_16x16x32_bf16 v[160:163], v[88:91], v[128:131], v[160:163]
    v_mfma_f32_16x16x32_bf16 v[168:171], v[120:123], v[128:131], v[168:171]
    s_waitcnt lgkmcnt(2)
    v_mfma_f32_16x16x32_bf16 v[164:167], v[88:91], v[132:135], v[164:167]
    v_mfma_f32_16x16x32_bf16 v[172:175], v[120:123], v[132:135], v[172:175]
    s_waitcnt lgkmcnt(1)
    v_mfma_f32_16x16x32_bf16 v[160:163], v[92:95], v[136:139], v[160:163]
    v_mfma_f32_16x16x32_bf16 v[168:171], v[124:127], v[136:139], v[168:171]
    s_waitcnt lgkmcnt(0)
    v_mfma_f32_16x16x32_bf16 v[164:167], v[92:95], v[140:143], v[164:167]
    v_mfma_f32_16x16x32_bf16 v[172:175], v[124:127], v[140:143], v[172:175]
    v_mul_f32 v160, 0x3db8aa3b, v160
    v_mul_f32 v161, 0x3db8aa3b, v161
    v_mul_f32 v162, 0x3db8aa3b, v162
    v_mul_f32 v163, 0x3db8aa3b, v163
    v_mul_f32 v164, 0x3db8aa3b, v164
    v_mul_f32 v165, 0x3db8aa3b, v165
    v_mul_f32 v166, 0x3db8aa3b, v166
    v_mul_f32 v167, 0x3db8aa3b, v167
    v_mul_f32 v168, 0x3db8aa3b, v168
    v_mul_f32 v169, 0x3db8aa3b, v169
    v_mul_f32 v170, 0x3db8aa3b, v170
    v_mul_f32 v171, 0x3db8aa3b, v171
    v_mul_f32 v172, 0x3db8aa3b, v172
    v_mul_f32 v173, 0x3db8aa3b, v173
    v_mul_f32 v174, 0x3db8aa3b, v174
    v_mul_f32 v175, 0x3db8aa3b, v175
    v_cvt_pk_bf16_f32 v184, v160, v161
    v_cvt_pk_bf16_f32 v185, v164, v165
    v_cvt_pk_bf16_f32 v186, v162, v163
    v_cvt_pk_bf16_f32 v187, v166, v167
    v_cvt_pk_bf16_f32 v188, v168, v169
    v_cvt_pk_bf16_f32 v189, v172, v173
    v_cvt_pk_bf16_f32 v190, v170, v171
    v_cvt_pk_bf16_f32 v191, v174, v175
    global_store_dwordx4 v28, v[184:187], s[14:15] sc1
    global_store_dwordx4 v28, v[188:191], s[14:15] offset:1024 sc1
    s_add_u32 s14, s14, 57344
    s_addc_u32 s15, s15, 0
L_pj_done0:
    s_waitcnt vmcnt(0)
    s_barrier
    s_cmp_lg_u32 s4, 0
    s_cbranch_scc1 L_pj_nfz
    v_mov_b32 v30, s32
    v_mov_b32 v31, 1
    s_add_u32 s20, s8, 43978752
    s_addc_u32 s21, s9, 0
    global_store_dword v30, v31, s[20:21] sc1
L_pj_nfz:
L_pj_end:
    s_mov_b32 s40, s38
    s_cmp_lg_u32 s38, 0
    s_cbranch_scc1 L_tok
    s_cmp_lt_u32 s3, 16
    s_cbranch_scc1 L_score
    s_cmp_lt_u32 s3, 30
    s_cbranch_scc1 L_value
    s_cmp_eq_u32 s3, 30
    s_cbranch_scc1 L_helper
    s_branch L_spare
L_tok:
    s_cmp_lt_u32 s44, 128
    s_cbranch_scc1 L_tok2
    s_sub_u32 s40, s44, 128
    s_cmp_ge_u32 s40, 49
    s_cbranch_scc1 L_tok1
    s_mul_i32 s22, s40, 37
    s_lshr_b32 s22, s22, 8
    s_mul_i32 s41, s22, 7
    s_sub_u32 s3, s40, s41
    s_branch L_outs
L_tok1:
    s_sub_u32 s40, s40, 49
    s_cmp_ge_u32 s40, 14
    s_cbranch_scc1 L_bail
    s_and_b32 s22, s40, 1
    s_lshr_b32 s3, s40, 1
    s_branch L_ffn1
L_tok2:
    s_and_b32 s22, s44, 3
    s_lshr_b32 s3, s44, 3
    s_bitcmp1_b32 s44, 2
    s_cbranch_scc1 L_tokt
    s_branch L_tokv
L_score:
    s_load_dwordx2 s[10:11], s[0:1], 0
    s_mov_b32 s5, 0
    s_mov_b32 s6, 0
    s_mov_b32 s7, 4290772927
    s_mov_b32 s90, 0
    v_and_b32 v20, 15, v0
    v_lshrrev_b32 v21, 4, v0
    v_and_b32 v22, 7, v0
    v_mov_b32 v1, 0x4444
    v_mov_b32 v23, 0xeeee
    v_cmp_lt_u32 vcc, 7, v20
    s_nop 1
    v_cndmask_b32 v1, v1, v23, vcc
    s_mul_i32 s36, s4, 1792
    v_lshlrev_b32 v2, 4, v0
    v_add_u32 v2, s36, v2
    s_mov_b32 s38, -1
    s_mov_b32 s39, 0xffff
    v_min_u32 v24, 13, v0
    v_lshlrev_b32 v24, 7, v24
    v_add3_u32 v4, s36, v24, 64
    v_lshlrev_b32 v24, 7, v21
    v_lshl_add_u32 v24, v22, 4, v24
    s_and_b32 s27, s4, 1
    s_mul_i32 s28, s27, 3584
    v_mov_b32 v5, v24
    v_add_u32 v6, s28, v24
    s_lshr_b32 s28, s4, 1
    s_mul_i32 s28, s28, 7
    s_lshl_b32 s27, s27, 2
    s_add_u32 s27, s27, s28
    s_add_u32 s28, s28, 3
    s_lshl_b32 s40, s27, 9
    s_lshl_b32 s41, s28, 9
    v_add_u32 v7, s40, v24
    v_add_u32 v8, s41, v24
    s_lshl_b32 s40, s27, 6
    s_lshl_b32 s41, s28, 6
    v_lshrrev_b32 v24, 2, v0
    v_mul_u32_u24 v24, 896, v24
    v_lshrrev_b32 v25, 5, v0
    v_lshlrev_b32 v25, 1, v25
    v_and_b32 v26, 3, v0
    v_xor_b32 v25, v25, v26
    v_lshl_add_u32 v24, v25, 4, v24
    v_add_u32 v14, s40, v24
    v_add_u32 v15, s41, v24
    s_lshl_b32 s37, s4, 13
    s_add_u32 s37, s37, 65536
    v_lshrrev_b32 v24, 3, v20
    v_lshlrev_b32 v24, 1, v24
    v_xor_b32 v24, v24, v21
    v_lshl_add_u32 v24, v20, 2, v24
    v_lshl_add_u32 v3, v24, 4, s37
    s_mul_i32 s40, s4, 3072
    s_add_u32 s40, s40, 8192
    v_mul_u32_u24 v25, 192, v21
    v_lshl_add_u32 v25, v20, 3, v25
    v_add_u32 v9, s40, v25
    v_and_b32 v25, 1, v0
    v_mul_u32_u24 v25, 192, v25
    v_lshrrev_b32 v26, 2, v0
    v_lshl_add_u32 v25, v26, 3, v25
    v_add_u32 v10, s40, v25
    s_mul_i32 s40, s4, 1408
    s_add_u32 s40, s40, 20480
    v_mul_u32_u24 v25, 176, v22
    v_add_u32 v25, s40, v25
    v_mov_b32 v19, v25
    v_lshrrev_b32 v26, 3, v20
    v_and_b32 v27, 1, v21
    v_mul_u32_u24 v27, 704, v27
    v_lshrrev_b32 v28, 1, v21
    v_lshl_add_u32 v27, v28, 6, v27
    v_lshl_add_u32 v27, v20, 2, v27
    v_add3_u32 v11, s40, v27, 32
    v_and_b32 v27, 1, v21
    v_lshlrev_b32 v27, 4, v27
    v_lshrrev_b32 v28, 1, v21
    v_lshl_add_u32 v28, v28, 1, v26
    v_lshl_add_u32 v27, v28, 2, v27
    v_add_u32 v17, v25, v27
    v_lshrrev_b32 v25, 5, v0
    v_lshl_add_u32 v25, s4, 1, v25
    v_and_b32 v26, 31, v0
    v_min_u32 v26, 20, v26
    v_mul_u32_u24 v27, 176, v25
    v_lshl_add_u32 v27, v26, 3, v27
    v_add_u32 v12, 20480, v27
    s_lshr_b32 s40, s3, 2
    s_mul_i32 s40, s40, 2560
    s_and_b32 s41, s3, 1
    s_bfe_u32 s42, s3, 0x10001
    s_lshl_b32 s43, s41, 7
    s_lshl_b32 s46, s42, 5
    s_add_u32 s43, s43, s46
    s_add_u32 s43, s43, s40
    s_add_u32 s43, s43, 2048
    v_and_b32 v27, 1, v26
    v_lshlrev_b32 v27, 8, v27
    v_lshrrev_b32 v28, 1, v26
    v_lshl_add_u32 v27, v28, 6, v27
    v_lshl_add_u32 v27, v25, 2, v27
    v_add_u32 v27, s43, v27
    s_lshl_b32 s43, s42, 10
    s_lshl_b32 s46, s41, 9
    s_add_u32 s43, s43, s46
    s_add_u32 s43, s43, s40
    v_subrev_u32 v28, 4, v26
    v_lshrrev_b32 v29, 2, v28
    v_and_b32 v28, 3, v28
    v_lshlrev_b32 v28, 2, v28
    v_lshl_add_u32 v28, v29, 7, v28
    v_lshl_add_u32 v28, v25, 4, v28
    v_add_u32 v28, s43, v28
    v_cmp_gt_u32 vcc, 4, v26
    s_nop 1
    v_cndmask_b32 v13, v28, v27, vcc
    s_mul_i32 s40, s4, 6144
    s_add_u32 s40, s40, 26624
    v_lshl_add_u32 v16, v0, 4, s40
    s_mov_b32 s30, 0x000fffff
    s_mov_b32 s31, 0x000fffff
    s_mov_b32 s32, 0xff00ff00
    s_mov_b32 s33, 0xff00ff00
    s_mov_b32 s34, 0
    s_mov_b32 s35, -1
    v_mov_b32 v18, 4290772927
    s_add_u32 s16, s8, 43237376
    s_addc_u32 s17, s9, 0
    s_add_u32 s40, s16, 10240
    s_addc_u32 s41, s17, 0
    s_mov_b64 exec, s[30:31]
    global_store_dword v13, v18, s[16:17] sc1
    global_store_dword v13, v18, s[40:41] sc1
    s_mov_b64 exec, -1
    s_waitcnt lgkmcnt(0)
    s_getreg_b32 s75, hwreg(HW_REG_XCC_ID, 0, 4)
    s_add_u32 s75, s75, 1
    v_mov_b32 v32, s3
    v_mov_b32 v33, s75
    s_waitcnt vmcnt(0)
    s_barrier
    global_store_byte v32, v33, s[96:97] offset:224 sc1
    s_add_u32 s12, s10, 14336
    s_addc_u32 s13, s11, 0
    v_mov_b32 v26, 0xff800000
    v_mov_b32 v27, 0xff800000
    ds_write_b64 v19, v[26:27] offset:160
    s_add_u32 m0, s37, 0
    s_nop 0
    global_load_lds_dwordx4 v14, s[10:11] offset:0
    s_add_u32 m0, s37, 1024
    s_nop 0
    global_load_lds_dwordx4 v14, s[12:13] offset:0
    s_add_u32 m0, s37, 1984
    s_nop 0
    global_load_lds_dwordx4 v14, s[10:11] offset:64
    s_add_u32 m0, s37, 3008
    s_nop 0
    global_load_lds_dwordx4 v14, s[12:13] offset:64
    s_add_u32 m0, s37, 3968
    s_nop 0
    global_load_lds_dwordx4 v14, s[10:11] offset:128
    s_add_u32 m0, s37, 4992
    s_nop 0
    global_load_lds_dwordx4 v14, s[12:13] offset:128
    s_add_u32 m0, s37, 6144
    s_nop 0
    global_load_lds_dwordx4 v15, s[10:11]
    s_add_u32 m0, s37, 7168
    s_nop 0
    global_load_lds_dwordx4 v15, s[12:13]
    s_add_u32 s10, s10, 28672
    s_addc_u32 s11, s11, 0
    s_add_u32 s12, s12, 28672
    s_addc_u32 s13, s13, 0
    s_xor_b32 s37, s37, 0x8000
    s_add_u32 m0, s37, 0
    s_nop 0
    global_load_lds_dwordx4 v14, s[10:11] offset:0
    s_add_u32 m0, s37, 1024
    s_nop 0
    global_load_lds_dwordx4 v14, s[12:13] offset:0
    s_add_u32 m0, s37, 1984
    s_nop 0
    global_load_lds_dwordx4 v14, s[10:11] offset:64
    s_add_u32 m0, s37, 3008
    s_nop 0
    global_load_lds_dwordx4 v14, s[12:13] offset:64
    s_add_u32 m0, s37, 3968
    s_nop 0
    global_load_lds_dwordx4 v14, s[10:11] offset:128
    s_add_u32 m0, s37, 4992
    s_nop 0
    global_load_lds_dwordx4 v14, s[12:13] offset:128
    s_add_u32 m0, s37, 6144
    s_nop 0
    global_load_lds_dwordx4 v15, s[10:11]
    s_add_u32 m0, s37, 7168
    s_nop 0
    global_load_lds_dwordx4 v15, s[12:13]
    s_add_u32 s10, s10, 28672
    s_addc_u32 s11, s11, 0
    s_add_u32 s12, s12, 28672
    s_addc_u32 s13, s13, 0
    s_xor_b32 s37, s37, 0x8000
    s_mul_i32 s40, s3, 401408
    s_and_b32 s41, s4, 1
    s_mul_i32 s41, s41, 14336
    s_mul_i32 s42, s27, 28672
    s_mul_i32 s43, s28, 28672
    v_lshlrev_b32 v28, 4, v0
    v_add_u32 v108, s42, v28
    s_add_u32 s46, s43, s41
    v_add_u32 v109, s46, v28
    s_add_u32 s24, s8, 0
    s_addc_u32 s25, s9, 0
    s_add_u32 s24, s24, s40
    s_addc_u32 s25, s25, 0
    s_waitcnt vmcnt(0)
    ds_read_b128 v[20:23], v3 offset:0
    ds_read_b128 v[24:27], v3 offset:1024
    ds_read_b128 v[28:31], v3 offset:2048
    ds_read_b128 v[32:35], v3 offset:3072
    ds_read_b128 v[36:39], v3 offset:4096
    ds_read_b128 v[40:43], v3 offset:5120
    ds_read_b128 v[44:47], v3 offset:6144
    ds_read_b128 v[48:51], v3 offset:7168
    s_waitcnt lgkmcnt(6)
    v_mov_b32 v52, v20
    v_mov_b32 v53, v24
    v_mov_b32 v54, v21
    v_mov_b32 v55, v25
    v_mov_b32 v56, v22
    v_mov_b32 v57, v26
    v_mov_b32 v58, v23
    v_mov_b32 v59, v27
    s_waitcnt lgkmcnt(4)
    v_mov_b32 v60, v28
    v_mov_b32 v61, v32
    v_mov_b32 v62, v29
    v_mov_b32 v63, v33
    v_mov_b32 v64, v30
    v_mov_b32 v65, v34
    v_mov_b32 v66, v31
    v_mov_b32 v67, v35
    s_waitcnt lgkmcnt(2)
    v_mov_b32 v68, v36
    v_mov_b32 v69, v40
    v_mov_b32 v70, v37
    v_mov_b32 v71, v41
    v_mov_b32 v72, v38
    v_mov_b32 v73, v42
    v_mov_b32 v74, v39
    v_mov_b32 v75, v43
    s_waitcnt lgkmcnt(0)
    v_mov_b32 v76, v44
    v_mov_b32 v77, v48
    v_mov_b32 v78, v45
    v_mov_b32 v79, v49
    v_mov_b32 v80, v46
    v_mov_b32 v81, v50
    v_mov_b32 v82, v47
    v_mov_b32 v83, v51
    v_mov_b32 v120, 0
    v_mov_b32 v121, 0
    v_mov_b32 v122, 0
    v_mov_b32 v123, 0
    v_xor_b32 v3, 0x8000, v3
    v_mov_b32 v128, 0
    v_mov_b32 v129, 0
    v_mov_b32 v130, 0
    v_mov_b32 v131, 0
    v_mov_b32 v132, 0
    v_mov_b32 v133, 0
    v_mov_b32 v134, 0
    v_mov_b32 v135, 0
    v_mov_b32 v136, 0
    v_mov_b32 v137, 0
    v_mov_b32 v138, 0
    v_mov_b32 v139, 0
    v_mov_b32 v140, 0
    v_mov_b32 v141, 0
    v_mov_b32 v142, 0
    v_mov_b32 v143, 0
    s_add_u32 s18, s8, 43978752
    s_addc_u32 s19, s9, 0
    s_lshl_b32 s40, s3, 7
    v_bfe_u32 v110, v0, 3, 1
    v_lshl_add_u32 v110, v110, 11, s40
    v_and_b32 v111, 7, v0
    v_lshl_add_u32 v110, v111, 2, v110
    s_mov_b32 s46, 0x7f
L_sc_w:
    global_load_dword v111, v110, s[18:19] sc1
    s_add_u32 s6, s6, 1
    s_cmp_gt_u32 s6, 2097152
    s_cbranch_scc1 L_bail
    s_waitcnt vmcnt(0)
    v_cmp_ne_u32 vcc, 0, v111
    s_lshr_b32 s47, vcc_lo, 8
    s_and_b32 s47, s47, vcc_lo
    s_and_b32 s47, s47, s46
    s_andn2_b32 s46, s46, s47
    s_cmp_lg_u32 s47, 0
    s_cbranch_scc1 L_sc_wg
    s_sleep 2
    s_branch L_sc_w
L_sc_wg:
    s_bitcmp0_b32 s47, 0
    s_cbranch_scc1 L_sc_w0
    s_waitcnt vmcnt(48)
    s_add_u32 s40, s24, 0
    s_addc_u32 s41, s25, 0
    global_load_dwordx4 v[84:87], v108, s[40:41] offset:0 sc1
    global_load_dwordx4 v[88:91], v108, s[40:41] offset:1024 sc1
    s_add_u32 s40, s24, 28672
    s_addc_u32 s41, s25, 0
    global_load_dwordx4 v[92:95], v108, s[40:41] offset:0 sc1
    global_load_dwordx4 v[96:99], v108, s[40:41] offset:1024 sc1
    s_add_u32 s40, s24, 57344
    s_addc_u32 s41, s25, 0
    global_load_dwordx4 a[112:115], v108, s[40:41] offset:0 sc1
    global_load_dwordx4 a[116:119], v108, s[40:41] offset:1024 sc1
    s_add_u32 s40, s24, 2048
    s_addc_u32 s41, s25, 0
    global_load_dwordx4 v[100:103], v108, s[40:41] offset:0 sc1
    global_load_dwordx4 v[104:107], v108, s[40:41] offset:1024 sc1
    s_add_u32 s40, s24, 30720
    s_addc_u32 s41, s25, 0
    global_load_dwordx4 a[0:3], v108, s[40:41] offset:0 sc1
    global_load_dwordx4 a[4:7], v108, s[40:41] offset:1024 sc1
    s_add_u32 s40, s24, 59392
    s_addc_u32 s41, s25, 0
    global_load_dwordx4 a[144:147], v108, s[40:41] offset:0 sc1
    global_load_dwordx4 a[148:151], v108, s[40:41] offset:1024 sc1
L_sc_w0:
    s_bitcmp0_b32 s47, 1
    s_cbranch_scc1 L_sc_w1
    s_waitcnt vmcnt(48)
    s_add_u32 s40, s24, 4096
    s_addc_u32 s41, s25, 0
    global_load_dwordx4 a[16:19], v108, s[40:41] offset:0 sc1
    global_load_dwordx4 a[20:23], v108, s[40:41] offset:1024 sc1
    s_add_u32 s40, s24, 32768
    s_addc_u32 s41, s25, 0
    global_load_dwordx4 a[24:27], v108, s[40:41] offset:0 sc1
    global_load_dwordx4 a[28:31], v108, s[40:41] offset:1024 sc1
    s_add_u32 s40, s24, 61440
    s_addc_u32 s41, s25, 0
    global_load_dwordx4 a[176:179], v108, s[40:41] offset:0 sc1
    global_load_dwordx4 a[180:183], v108, s[40:41] offset:1024 sc1
    s_add_u32 s40, s24, 6144
    s_addc_u32 s41, s25, 0
    global_load_dwordx4 a[40:43], v108, s[40:41] offset:0 sc1
    global_load_dwordx4 a[44:47], v108, s[40:41] offset:1024 sc1
    s_add_u32 s40, s24, 34816
    s_addc_u32 s41, s25, 0
    global_load_dwordx4 a[48:51], v108, s[40:41] offset:0 sc1
    global_load_dwordx4 a[52:55], v108, s[40:41] offset:1024 sc1
    s_add_u32 s40, s24, 63488
    s_addc_u32 s41, s25, 0
    global_load_dwordx4 a[200:203], v108, s[40:41] offset:0 sc1
    global_load_dwordx4 a[204:207], v108, s[40:41] offset:1024 sc1
L_sc_w1:
    s_bitcmp0_b32 s47, 2
    s_cbranch_scc1 L_sc_w2
    s_waitcnt vmcnt(48)
    s_add_u32 s40, s24, 8192
    s_addc_u32 s41, s25, 0
    global_load_dwordx4 a[64:67], v108, s[40:41] offset:0 sc1
    global_load_dwordx4 a[68:71], v108, s[40:41] offset:1024 sc1
    s_add_u32 s40, s24, 36864
    s_addc_u32 s41, s25, 0
    global_load_dwordx4 a[72:75], v108, s[40:41] offset:0 sc1
    global_load_dwordx4 a[76:79], v108, s[40:41] offset:1024 sc1
    s_add_u32 s40, s24, 65536
    s_addc_u32 s41, s25, 0
    global_load_dwordx4 a[224:227], v108, s[40:41] offset:0 sc1
    global_load_dwordx4 a[228:231], v108, s[40:41] offset:1024 sc1
    s_add_u32 s40, s24, 10240
    s_addc_u32 s41, s25, 0
    global_load_dwordx4 a[88:91], v108, s[40:41] offset:0 sc1
    global_load_dwordx4 a[92:95], v108, s[40:41] offset:1024 sc1
    s_add_u32 s40, s24, 38912
    s_addc_u32 s41, s25, 0
    global_load_dwordx4 a[96:99], v108, s[40:41] offset:0 sc1
    global_load_dwordx4 a[100:103], v108, s[40:41] offset:1024 sc1
    s_add_u32 s40, s24, 67584
    s_addc_u32 s41, s25, 0
    global_load_dwordx4 a[248:251], v108, s[40:41] offset:0 sc1
    global_load_dwordx4 a[252:255], v108, s[40:41] offset:1024 sc1
L_sc_w2:
    s_bitcmp0_b32 s47, 3
    s_cbranch_scc1 L_sc_w3
    s_waitcnt vmcnt(48)
    s_add_u32 s40, s24, 12288
    s_addc_u32 s41, s25, 0
    global_load_dwordx4 a[120:123], v108, s[40:41] offset:0 sc1
    global_load_dwordx4 a[124:127], v108, s[40:41] offset:1024 sc1
    s_add_u32 s40, s24, 40960
    s_addc_u32 s41, s25, 0
    global_load_dwordx4 a[128:131], v108, s[40:41] offset:0 sc1
    global_load_dwordx4 a[132:135], v108, s[40:41] offset:1024 sc1
    s_add_u32 s40, s24, 69632
    s_addc_u32 s41, s25, 0
    global_load_dwordx4 v[160:163], v108, s[40:41] offset:0 sc1
    global_load_dwordx4 v[164:167], v108, s[40:41] offset:1024 sc1
    s_add_u32 s40, s24, 14336
    s_addc_u32 s41, s25, 0
    global_load_dwordx4 a[152:155], v108, s[40:41] offset:0 sc1
    global_load_dwordx4 a[156:159], v108, s[40:41] offset:1024 sc1
    s_add_u32 s40, s24, 43008
    s_addc_u32 s41, s25, 0
    global_load_dwordx4 a[160:163], v108, s[40:41] offset:0 sc1
    global_load_dwordx4 a[164:167], v108, s[40:41] offset:1024 sc1
    s_add_u32 s40, s24, 71680
    s_addc_u32 s41, s25, 0
    global_load_dwordx4 v[184:187], v108, s[40:41] offset:0 sc1
    global_load_dwordx4 v[188:191], v108, s[40:41] offset:1024 sc1
L_sc_w3:
    s_bitcmp0_b32 s47, 4
    s_cbranch_scc1 L_sc_w4
    s_waitcnt vmcnt(48)
    s_add_u32 s40, s24, 16384
    s_addc_u32 s41, s25, 0
    global_load_dwordx4 a[184:187], v108, s[40:41] offset:0 sc1
    global_load_dwordx4 a[188:191], v108, s[40:41] offset:1024 sc1
    s_add_u32 s40, s24, 45056
    s_addc_u32 s41, s25, 0
    global_load_dwordx4 a[192:195], v108, s[40:41] offset:0 sc1
    global_load_dwordx4 a[196:199], v108, s[40:41] offset:1024 sc1
    s_add_u32 s40, s24, 73728
    s_addc_u32 s41, s25, 0
    global_load_dwordx4 v[208:211], v108, s[40:41] offset:0 sc1
    global_load_dwordx4 v[212:215], v108, s[40:41] offset:1024 sc1
    s_add_u32 s40, s24, 18432
    s_addc_u32 s41, s25, 0
    global_load_dwordx4 a[208:211], v108, s[40:41] offset:0 sc1
    global_load_dwordx4 a[212:215], v108, s[40:41] offset:1024 sc1
    s_add_u32 s40, s24, 47104
    s_addc_u32 s41, s25, 0
    global_load_dwordx4 a[216:219], v108, s[40:41] offset:0 sc1
    global_load_dwordx4 a[220:223], v108, s[40:41] offset:1024 sc1
    s_add_u32 s40, s24, 75776
    s_addc_u32 s41, s25, 0
    global_load_dwordx4 v[216:219], v108, s[40:41] offset:0 sc1
    global_load_dwordx4 v[220:223], v108, s[40:41] offset:1024 sc1
L_sc_w4:
    s_bitcmp0_b32 s47, 5
    s_cbranch_scc1 L_sc_w5
    s_waitcnt vmcnt(48)
    s_add_u32 s40, s24, 20480
    s_addc_u32 s41, s25, 0
    global_load_dwordx4 a[232:235], v108, s[40:41] offset:0 sc1
    global_load_dwordx4 a[236:239], v108, s[40:41] offset:1024 sc1
    s_add_u32 s40, s24, 49152
    s_addc_u32 s41, s25, 0
    global_load_dwordx4 a[240:243], v108, s[40:41] offset:0 sc1
    global_load_dwordx4 a[244:247], v108, s[40:41] offset:1024 sc1
    s_add_u32 s40, s24, 77824
    s_addc_u32 s41, s25, 0
    global_load_dwordx4 v[224:227], v108, s[40:41] offset:0 sc1
    global_load_dwordx4 v[228:231], v108, s[40:41] offset:1024 sc1
    s_add_u32 s40, s24, 22528
    s_addc_u32 s41, s25, 0
    global_load_dwordx4 v[144:147], v108, s[40:41] offset:0 sc1
    global_load_dwordx4 v[148:151], v108, s[40:41] offset:1024 sc1
    s_add_u32 s40, s24, 51200
    s_addc_u32 s41, s25, 0
    global_load_dwordx4 v[152:155], v108, s[40:41] offset:0 sc1
    global_load_dwordx4 v[156:159], v108, s[40:41] offset:1024 sc1
    s_add_u32 s40, s24, 79872
    s_addc_u32 s41, s25, 0
    global_load_dwordx4 v[232:235], v108, s[40:41] offset:0 sc1
    global_load_dwordx4 v[236:239], v108, s[40:41] offset:1024 sc1
L_sc_w5:
    s_bitcmp0_b32 s47, 6
    s_cbranch_scc1 L_sc_w6
    s_waitcnt vmcnt(48)
    s_add_u32 s40, s24, 24576
    s_addc_u32 s41, s25, 0
    global_load_dwordx4 v[168:171], v108, s[40:41] offset:0 sc1
    global_load_dwordx4 v[172:175], v108, s[40:41] offset:1024 sc1
    s_add_u32 s40, s24, 53248
    s_addc_u32 s41, s25, 0
    global_load_dwordx4 v[176:179], v108, s[40:41] offset:0 sc1
    global_load_dwordx4 v[180:183], v108, s[40:41] offset:1024 sc1
    s_add_u32 s40, s24, 81920
    s_addc_u32 s41, s25, 0
    global_load_dwordx4 v[240:243], v108, s[40:41] offset:0 sc1
    global_load_dwordx4 v[244:247], v108, s[40:41] offset:1024 sc1
    s_add_u32 s40, s24, 26624
    s_addc_u32 s41, s25, 0
    global_load_dwordx4 v[192:195], v108, s[40:41] offset:0 sc1
    global_load_dwordx4 v[196:199], v108, s[40:41] offset:1024 sc1
    s_add_u32 s40, s24, 55296
    s_addc_u32 s41, s25, 0
    global_load_dwordx4 v[200:203], v108, s[40:41] offset:0 sc1
    global_load_dwordx4 v[204:207], v108, s[40:41] offset:1024 sc1
    s_add_u32 s40, s24, 83968
    s_addc_u32 s41, s25, 0
    global_load_dwordx4 v[248:251], v108, s[40:41] offset:0 sc1
    global_load_dwordx4 v[252:255], v108, s[40:41] offset:1024 sc1
L_sc_w6:
    s_cmp_lg_u32 s46, 0
    s_cbranch_scc1 L_sc_w
    s_waitcnt vmcnt(48)
    v_min_u32 v110, 30, v0
    global_load_ubyte v111, v110, s[96:97] offset:224 sc1
    s_add_u32 s40, s24, 0
    s_addc_u32 s41, s25, 0
    global_load_dwordx4 a[8:11], v109, s[40:41] offset:0 sc1
    global_load_dwordx4 a[12:15], v109, s[40:41] offset:1024 sc1
    s_add_u32 s40, s24, 2048
    s_addc_u32 s41, s25, 0
    global_load_dwordx4 a[32:35], v109, s[40:41] offset:0 sc1
    global_load_dwordx4 a[36:39], v109, s[40:41] offset:1024 sc1
    s_add_u32 s40, s24, 4096
    s_addc_u32 s41, s25, 0
    global_load_dwordx4 a[56:59], v109, s[40:41] offset:0 sc1
    global_load_dwordx4 a[60:63], v109, s[40:41] offset:1024 sc1
    s_add_u32 s40, s24, 6144
    s_addc_u32 s41, s25, 0
    global_load_dwordx4 a[80:83], v109, s[40:41] offset:0 sc1
    global_load_dwordx4 a[84:87], v109, s[40:41] offset:1024 sc1
    s_add_u32 s40, s24, 8192
    s_addc_u32 s41, s25, 0
    global_load_dwordx4 a[104:107], v109, s[40:41] offset:0 sc1
    global_load_dwordx4 a[108:111], v109, s[40:41] offset:1024 sc1
    s_add_u32 s40, s24, 10240
    s_addc_u32 s41, s25, 0
    global_load_dwordx4 a[136:139], v109, s[40:41] offset:0 sc1
    global_load_dwordx4 a[140:143], v109, s[40:41] offset:1024 sc1
    s_add_u32 s40, s24, 12288
    s_addc_u32 s41, s25, 0
    global_load_dwordx4 a[168:171], v109, s[40:41] offset:0 sc1
    global_load_dwordx4 a[172:175], v109, s[40:41] offset:1024 sc1
    s_waitcnt vmcnt(14)
    v_cmp_eq_u32 vcc, 0, v111
    s_cbranch_vccz L_sc_xk
L_sc_xc:
    global_load_ubyte v111, v110, s[96:97] offset:224 sc1
    s_add_u32 s6, s6, 1
    s_cmp_gt_u32 s6, 2097152
    s_cbranch_scc1 L_bail
    s_waitcnt vmcnt(0)
    v_cmp_eq_u32 vcc, 0, v111
    s_cbranch_vccnz L_sc_xc
L_sc_xk:
    v_cmp_ne_u32 vcc, s75, v111
    s_cmp_eq_u64 vcc, 0
    s_cselect_b32 s64, 1, 0
    s_add_u32 s14, s8, 42205184
    s_addc_u32 s15, s9, 0
    s_mov_b32 m0, s36
    s_nop 0
    global_load_lds_dwordx4 v2, s[14:15] sc1
    s_mov_b64 exec, s[38:39]
    global_load_lds_dwordx4 v2, s[14:15] offset:1024 sc1
    s_mov_b64 exec, -1
    ds_write_b128 v16, v[84:87] offset:0
    ds_write_b128 v16, v[88:91] offset:1024
    ds_write_b128 v16, v[92:95] offset:2048
    ds_write_b128 v16, v[96:99] offset:3072
    ds_write_b128 v16, v[100:103] offset:4096
    ds_write_b128 v16, v[104:107] offset:5120
    s_add_u32 s14, s8, 42205184
    s_addc_u32 s15, s9, 0
    v_and_b32 v20, 16, v0
    v_cmp_eq_u32 vcc, 0, v20
    v_mov_b32 v20, 0x21800000
    s_nop 0
    v_cndmask_b32 v0, 0, v20, vcc
    s_mov_b32 s26, 0x5d000000
    s_waitcnt vmcnt(0) lgkmcnt(0)
    s_barrier
    s_cmp_eq_u32 s64, 0
    s_cbranch_scc1 L_sd_go
    s_branch L_sc_go
.p2align 6, , 63
    s_nop 0
    s_nop 0
L_sc_step:
L_sc_mp:
    s_mov_b32 m0, s36
L_sc_mpl:
    global_load_dword v112, v4, s[14:15] sc1
    global_load_lds_dwordx4 v2, s[14:15] sc1
    s_mov_b64 exec, s[38:39]
    global_load_lds_dwordx4 v2, s[14:15] offset:1024 sc1
    s_mov_b64 exec, -1
    s_add_u32 s6, s6, 1
    s_cmp_gt_u32 s6, 2097152
    s_cbranch_scc1 L_bail
    s_waitcnt vmcnt(2)
    v_cmp_eq_u32 vcc, s7, v112
    s_cbranch_vccnz L_sc_mpl
    s_waitcnt vmcnt(0) lgkmcnt(0)
    s_barrier
L_sc_go:
    ds_read_b128 v[20:23], v5 offset:0
    ds_read_b128 v[24:27], v5 offset:512
    s_waitcnt lgkmcnt(1)
    v_smfmac_f32_16x16x64_bf16 v[128:131], v[20:23], v[84:91], v1
    ds_read_b128 v[116:119], v6 offset:0
    ds_read_b128 v[32:35], v5 offset:1536
    v_smfmac_f32_16x16x64_bf16 v[132:135], v[20:23], v[92:99], v1
    ds_read_b128 v[28:31], v5 offset:1024
    s_waitcnt lgkmcnt(3)
    v_smfmac_f32_16x16x64_bf16 v[128:131], v[24:27], v[100:107], v1
    ds_read_b128 v[36:39], v5 offset:2048
    v_max_u32 v19, v20, v24
    v_smfmac_f32_16x16x64_bf16 v[132:135], v[24:27], a[0:7], v1
    ds_read_b128 v[124:127], v6 offset:512
    s_waitcnt lgkmcnt(4)
    v_smfmac_f32_16x16x64_bf16 v[140:143], v[116:119], a[8:15], v1
    ds_read_b128 v[116:119], v6 offset:1024
    s_waitcnt lgkmcnt(3)
    v_smfmac_f32_16x16x64_bf16 v[128:131], v[28:31], a[16:23], v1
    ds_read_b128 v[40:43], v5 offset:2560
    v_smfmac_f32_16x16x64_bf16 v[132:135], v[28:31], a[24:31], v1
    s_waitcnt lgkmcnt(2)
    v_smfmac_f32_16x16x64_bf16 v[140:143], v[124:127], a[32:39], v1
    ds_read_b128 v[124:127], v6 offset:1536
    v_smfmac_f32_16x16x64_bf16 v[128:131], v[32:35], a[40:47], v1
    ds_read_b128 v[44:47], v5 offset:3072
    v_max3_u32 v19, v28, v32, v19
    v_smfmac_f32_16x16x64_bf16 v[132:135], v[32:35], a[48:55], v1
    s_waitcnt lgkmcnt(3)
    v_smfmac_f32_16x16x64_bf16 v[140:143], v[116:119], a[56:63], v1
    ds_read_b128 v[116:119], v6 offset:2048
    v_smfmac_f32_16x16x64_bf16 v[128:131], v[36:39], a[64:71], v1
    ds_read_b128 v[48:51], v5 offset:3584
    v_smfmac_f32_16x16x64_bf16 v[132:135], v[36:39], a[72:79], v1
    s_waitcnt lgkmcnt(3)
    v_smfmac_f32_16x16x64_bf16 v[140:143], v[124:127], a[80:87], v1
    ds_read_b128 v[124:127], v6 offset:2560
    v_smfmac_f32_16x16x64_bf16 v[128:131], v[40:43], a[88:95], v1
    v_max3_u32 v19, v36, v40, v19
    v_smfmac_f32_16x16x64_bf16 v[132:135], v[40:43], a[96:103], v1
    s_add_u32 s40, s16, 20480
    s_addc_u32 s41, s17, 0
    s_waitcnt lgkmcnt(2)
    v_smfmac_f32_16x16x64_bf16 v[140:143], v[116:119], a[104:111], v1
    ds_read_b128 v[116:119], v6 offset:3072
    v_smfmac_f32_16x16x64_bf16 v[136:139], v[20:23], a[112:119], v1
    ds_read_b128 v[20:23], v5 offset:4096
    v_smfmac_f32_16x16x64_bf16 v[128:131], v[44:47], a[120:127], v1
    v_smfmac_f32_16x16x64_bf16 v[132:135], v[44:47], a[128:135], v1
    s_mov_b64 exec, s[30:31]
    global_store_dword v13, v18, s[40:41]
    s_mov_b64 exec, -1
    s_waitcnt lgkmcnt(2)
    v_smfmac_f32_16x16x64_bf16 v[140:143], v[124:127], a[136:143], v1
    v_smfmac_f32_16x16x64_bf16 v[136:139], v[24:27], a[144:151], v1
    ds_read_b128 v[24:27], v5 offset:4608
    v_smfmac_f32_16x16x64_bf16 v[128:131], v[48:51], a[152:159], v1
    v_max3_u32 v19, v44, v48, v19
    v_smfmac_f32_16x16x64_bf16 v[132:135], v[48:51], a[160:167], v1
    s_waitcnt lgkmcnt(2)
    v_smfmac_f32_16x16x64_bf16 v[140:143], v[116:119], a[168:175], v1
    v_smfmac_f32_16x16x64_bf16 v[136:139], v[28:31], a[176:183], v1
    ds_read_b128 v[28:31], v5 offset:5120
    s_waitcnt lgkmcnt(2)
    v_smfmac_f32_16x16x64_bf16 v[128:131], v[20:23], a[184:191], v1
    v_cvt_pk_bf16_f32 v114, v140, v141
    v_smfmac_f32_16x16x64_bf16 v[132:135], v[20:23], a[192:199], v1
    v_cvt_pk_bf16_f32 v115, v142, v143
    v_smfmac_f32_16x16x64_bf16 v[136:139], v[32:35], a[200:207], v1
    ds_read_b128 v[32:35], v5 offset:5632
    s_waitcnt lgkmcnt(2)
    v_smfmac_f32_16x16x64_bf16 v[128:131], v[24:27], a[208:215], v1
    ds_write_b64 v9, v[114:115] offset:2304
    v_max3_u32 v19, v20, v24, v19
    v_smfmac_f32_16x16x64_bf16 v[132:135], v[24:27], a[216:223], v1
    ds_read_b64_tr_b16 v[108:109], v10 offset:2304
    ds_read_b64_tr_b16 v[110:111], v10 offset:2688
    v_smfmac_f32_16x16x64_bf16 v[136:139], v[36:39], a[224:231], v1
    ds_read_b128 v[36:39], v5 offset:6144
    s_waitcnt lgkmcnt(5)
    v_smfmac_f32_16x16x64_bf16 v[128:131], v[28:31], a[232:239], v1
    ds_read_b128 v[96:99], v8
    v_smfmac_f32_16x16x64_bf16 v[132:135], v[28:31], a[240:247], v1
    v_smfmac_f32_16x16x64_bf16 v[136:139], v[40:43], a[248:255], v1
    ds_read_b128 v[40:43], v5 offset:6656
    s_waitcnt lgkmcnt(6)
    v_smfmac_f32_16x16x64_bf16 v[128:131], v[32:35], v[144:151], v1
    ds_read_b128 v[84:87], v7 offset:0
    v_max3_u32 v19, v28, v32, v19
    v_smfmac_f32_16x16x64_bf16 v[132:135], v[32:35], v[152:159], v1
    v_smfmac_f32_16x16x64_bf16 v[136:139], v[44:47], v[160:167], v1
    s_waitcnt lgkmcnt(3)
    v_smfmac_f32_16x16x64_bf16 v[128:131], v[36:39], v[168:175], v1
    ds_read_b128 v[88:91], v7 offset:512
    v_smfmac_f32_16x16x64_bf16 v[132:135], v[36:39], v[176:183], v1
    v_smfmac_f32_16x16x64_bf16 v[136:139], v[48:51], v[184:191], v1
    s_waitcnt lgkmcnt(2)
    v_smfmac_f32_16x16x64_bf16 v[128:131], v[40:43], v[192:199], v1
    ds_read_b128 v[92:95], v7 offset:1024
    v_max3_u32 v19, v36, v40, v19
    v_smfmac_f32_16x16x64_bf16 v[132:135], v[40:43], v[200:207], v1
    v_cmp_eq_u32 vcc, s7, v19
    v_smfmac_f32_16x16x64_bf16 v[136:139], v[20:23], v[208:215], v1
    v_cvt_pk_bf16_f32 v112, v128, v129
    v_smfmac_f32_16x16x64_bf16 v[136:139], v[24:27], v[216:223], v1
    v_cvt_pk_bf16_f32 v113, v130, v131
    v_smfmac_f32_16x16x64_bf16 v[136:139], v[28:31], v[224:231], v1
    ds_write_b64 v9, v[112:113] offset:0
    v_cvt_pk_bf16_f32 v114, v132, v133
    v_smfmac_f32_16x16x64_bf16 v[136:139], v[32:35], v[232:239], v1
    ds_read_b64_tr_b16 v[100:101], v10 offset:0
    ds_read_b64_tr_b16 v[102:103], v10 offset:384
    v_cvt_pk_bf16_f32 v115, v134, v135
    v_smfmac_f32_16x16x64_bf16 v[136:139], v[36:39], v[240:247], v1
    ds_write_b64 v9, v[114:115] offset:768
    v_smfmac_f32_16x16x64_bf16 v[136:139], v[40:43], v[248:255], v1
    ds_read_b64_tr_b16 v[104:105], v10 offset:768
    ds_read_b64_tr_b16 v[106:107], v10 offset:1152
    v_smfmac_f32_16x16x64_bf16 v[120:123], v[108:111], v[76:83], v1
    v_mfma_f32_16x16x32_bf16 v[116:119], v[96:99], v[108:111], 0
    v_cvt_pk_bf16_f32 v112, v136, v137
    v_cvt_pk_bf16_f32 v113, v138, v139
    ds_write_b64 v9, v[112:113] offset:1536
    ds_read_b64_tr_b16 v[20:21], v10 offset:1536
    ds_read_b64_tr_b16 v[22:23], v10 offset:1920
    s_cbranch_vccnz L_sc_redo
    s_waitcnt lgkmcnt(11)
    s_waitcnt lgkmcnt(6)
    v_smfmac_f32_16x16x64_bf16 v[120:123], v[100:103], v[52:59], v1
    v_mfma_f32_16x16x32_bf16 v[116:119], v[84:87], v[100:103], v[116:119]
    s_waitcnt lgkmcnt(3)
    v_smfmac_f32_16x16x64_bf16 v[120:123], v[104:107], v[60:67], v1
    v_mfma_f32_16x16x32_bf16 v[116:119], v[88:91], v[104:107], v[116:119]
    s_waitcnt lgkmcnt(0)
    v_mfma_f32_16x16x32_bf16 v[116:119], v[92:95], v[20:23], v[116:119]
    v_smfmac_f32_16x16x64_bf16 v[120:123], v[20:23], v[68:75], v1
    s_nop 3
    v_cndmask_b32 v24, v116, v117, s[32:33]
    v_cndmask_b32 v25, v118, v119, s[32:33]
    v_cndmask_b32 v24, v24, v25, s[34:35]
    ds_write_b32 v17, v24
    ds_write2_b32 v11, v120, v121 offset0:0 offset1:44
    ds_write2_b32 v11, v122, v123 offset0:88 offset1:132
    v_mov_b32 v128, 0
    v_mov_b32 v129, 0
    v_mov_b32 v130, 0
    v_mov_b32 v131, 0
    v_mov_b32 v132, 0
    s_waitcnt lgkmcnt(0)
    s_barrier
    ds_read_b64 v[24:25], v12 offset:0
    ds_read_b64 v[26:27], v12 offset:1408
    ds_read_b64 v[28:29], v12 offset:2816
    ds_read_b64 v[30:31], v12 offset:4224
    v_mov_b32 v133, 0
    v_mov_b32 v134, 0
    v_mov_b32 v135, 0
    s_waitcnt lgkmcnt(2)
    v_pk_add_f32 v[24:25], v[24:25], v[26:27]
    s_waitcnt lgkmcnt(0)
    v_pk_add_f32 v[28:29], v[28:29], v[30:31]
    v_pk_add_f32 v[24:25], v[24:25], v[28:29]
    v_exp_f32 v32, v24
    v_exp_f32 v33, v25
    s_nop 0
    v_add_f32 v34, v32, v33
    s_nop 1
    v_add_f32_dpp v34, v34, v34 row_ror:8 row_mask:0xf bank_mask:0xf
    s_nop 1
    v_add_f32_dpp v34, v34, v34 row_ror:4 row_mask:0xf bank_mask:0xf
    s_nop 1
    v_add_f32_dpp v34, v34, v34 row_ror:2 row_mask:0xf bank_mask:0xf
    s_nop 1
    v_add_f32_dpp v34, v34, v34 row_ror:1 row_mask:0xf bank_mask:0xf
    v_mov_b32 v35, v34
    v_med3_f32 v37, v34, v0, s26
    v_cmp_neq_f32 vcc, v37, v34
    v_permlane16_swap_b32 v34, v35
    v_add_f32 v34, v34, v35
    v_rcp_f32 v36, v34
    s_mov_b64 exec, s[30:31]
    v_pk_mul_f32 v[32:33], v[32:33], v[36:37] op_sel_hi:[1,0]
    v_cvt_pk_bf16_f32 v32, v32, v33
    s_cbranch_vccnz L_sc_max
L_sc_norm:
    global_store_dword v13, v32, s[16:17]
    s_mov_b64 exec, -1
    s_add_u32 s5, s5, 1
    s_cmp_ge_u32 s5, 63
    s_cbranch_scc1 L_sc_end
    s_cmp_ge_u32 s5, 62
    s_cbranch_scc1 L_sc_nox
    s_add_u32 m0, s37, 0
    s_nop 0
    global_load_lds_dwordx4 v14, s[10:11] offset:0
    s_add_u32 m0, s37, 1024
    s_nop 0
    global_load_lds_dwordx4 v14, s[12:13] offset:0
    s_add_u32 m0, s37, 1984
    s_nop 0
    global_load_lds_dwordx4 v14, s[10:11] offset:64
    s_add_u32 m0, s37, 3008
    s_nop 0
    global_load_lds_dwordx4 v14, s[12:13] offset:64
    s_add_u32 m0, s37, 3968
    s_nop 0
    global_load_lds_dwordx4 v14, s[10:11] offset:128
    s_add_u32 m0, s37, 4992
    s_nop 0
    global_load_lds_dwordx4 v14, s[12:13] offset:128
    s_add_u32 m0, s37, 6144
    s_nop 0
    global_load_lds_dwordx4 v15, s[10:11]
    s_add_u32 m0, s37, 7168
    s_nop 0
    global_load_lds_dwordx4 v15, s[12:13]
    s_add_u32 s10, s10, 28672
    s_addc_u32 s11, s11, 0
    s_add_u32 s12, s12, 28672
    s_addc_u32 s13, s13, 0
    s_xor_b32 s37, s37, 0x8000
    s_branch L_sc_nof
L_sc_nox:
    s_lshl_b32 s42, s3, 2
    s_add_u32 s42, s42, s4
    s_mul_i32 s42, s42, 10240
    s_add_u32 s40, s8, 61353984
    s_addc_u32 s41, s9, 0
    s_add_u32 s40, s40, s42
    s_addc_u32 s41, s41, 0
    s_lshl_b32 s42, s4, 13
    s_lshl_b32 s43, s4, 11
    v_subrev_u32 v20, s36, v2
    s_add_u32 m0, s42, 131072
    s_nop 0
    global_load_lds_dwordx4 v20, s[40:41] offset:0 sc1
    s_add_u32 m0, s42, 131072
    s_nop 0
    global_load_lds_dwordx4 v20, s[40:41] offset:1024 sc1
    s_add_u32 m0, s42, 131072
    s_nop 0
    global_load_lds_dwordx4 v20, s[40:41] offset:2048 sc1
    s_add_u32 m0, s42, 131072
    s_nop 0
    global_load_lds_dwordx4 v20, s[40:41] offset:3072 sc1
    s_add_u32 s40, s40, 4096
    s_addc_u32 s41, s41, 0
    s_add_u32 m0, s42, 135168
    s_nop 0
    global_load_lds_dwordx4 v20, s[40:41] offset:0 sc1
    s_add_u32 m0, s42, 135168
    s_nop 0
    global_load_lds_dwordx4 v20, s[40:41] offset:1024 sc1
    s_add_u32 m0, s42, 135168
    s_nop 0
    global_load_lds_dwordx4 v20, s[40:41] offset:2048 sc1
    s_add_u32 m0, s42, 135168
    s_nop 0
    global_load_lds_dwordx4 v20, s[40:41] offset:3072 sc1
    s_add_u32 s40, s40, 4096
    s_addc_u32 s41, s41, 0
    s_add_u32 m0, s43, 51200
    s_nop 0
    global_load_lds_dwordx4 v20, s[40:41] offset:0 sc1
    s_add_u32 m0, s43, 51200
    s_nop 0
    global_load_lds_dwordx4 v20, s[40:41] offset:1024 sc1
L_sc_nof:
    ds_read_b128 v[84:87], v16 offset:0
    ds_read_b128 v[88:91], v16 offset:1024
    ds_read_b128 v[92:95], v16 offset:2048
    ds_read_b128 v[96:99], v16 offset:3072
    ds_read_b128 v[100:103], v16 offset:4096
    ds_read_b128 v[104:107], v16 offset:5120
    v_mov_b32 v136, 0
    v_mov_b32 v137, 0
    v_mov_b32 v138, 0
    v_mov_b32 v139, 0
    v_mov_b32 v140, 0
    v_mov_b32 v141, 0
    v_mov_b32 v142, 0
    v_mov_b32 v143, 0
    s_add_u32 s16, s16, 10240
    s_addc_u32 s17, s17, 0
    s_add_u32 s14, s14, 8192
    s_addc_u32 s15, s15, 0
    ds_read_b128 v[20:23], v3 offset:0
    ds_read_b128 v[24:27], v3 offset:1024
    ds_read_b128 v[28:31], v3 offset:2048
    ds_read_b128 v[32:35], v3 offset:3072
    ds_read_b128 v[36:39], v3 offset:4096
    ds_read_b128 v[40:43], v3 offset:5120
    ds_read_b128 v[44:47], v3 offset:6144
    ds_read_b128 v[48:51], v3 offset:7168
    s_waitcnt lgkmcnt(6)
    v_mov_b32 v52, v20
    v_mov_b32 v53, v24
    v_mov_b32 v54, v21
    v_mov_b32 v55, v25
    v_mov_b32 v56, v22
    v_mov_b32 v57, v26
    v_mov_b32 v58, v23
    v_mov_b32 v59, v27
    s_waitcnt lgkmcnt(4)
    v_mov_b32 v60, v28
    v_mov_b32 v61, v32
    v_mov_b32 v62, v29
    v_mov_b32 v63, v33
    v_mov_b32 v64, v30
    v_mov_b32 v65, v34
    v_mov_b32 v66, v31
    v_mov_b32 v67, v35
    s_waitcnt lgkmcnt(2)
    v_mov_b32 v68, v36
    v_mov_b32 v69, v40
    v_mov_b32 v70, v37
    v_mov_b32 v71, v41
    v_mov_b32 v72, v38
    v_mov_b32 v73, v42
    v_mov_b32 v74, v39
    v_mov_b32 v75, v43
    s_waitcnt lgkmcnt(0)
    v_mov_b32 v76, v44
    v_mov_b32 v77, v48
    v_mov_b32 v78, v45
    v_mov_b32 v79, v49
    v_mov_b32 v80, v46
    v_mov_b32 v81, v50
    v_mov_b32 v82, v47
    v_mov_b32 v83, v51
    v_mov_b32 v120, 0
    v_mov_b32 v121, 0
    v_mov_b32 v122, 0
    v_mov_b32 v123, 0
    v_xor_b32 v3, 0x8000, v3
    s_branch L_sc_step
L_sc_max:
    s_mov_b64 exec, -1
    s_nop 1
    v_max_f32 v34, v24, v25
    s_nop 1
    v_max_f32_dpp v34, v34, v34 row_ror:8 row_mask:0xf bank_mask:0xf
    s_nop 1
    v_max_f32_dpp v34, v34, v34 row_ror:4 row_mask:0xf bank_mask:0xf
    s_nop 1
    v_max_f32_dpp v34, v34, v34 row_ror:2 row_mask:0xf bank_mask:0xf
    s_nop 1
    v_max_f32_dpp v34, v34, v34 row_ror:1 row_mask:0xf bank_mask:0xf
    v_mov_b32 v35, v34
    s_nop 1
    v_permlane16_swap_b32 v34, v35
    v_max_f32 v34, v34, v35
    v_sub_f32 v32, v24, v34
    v_sub_f32 v33, v25, v34
    v_exp_f32 v32, v32
    v_exp_f32 v33, v33
    s_nop 0
    v_add_f32 v34, v32, v33
    s_nop 1
    v_add_f32_dpp v34, v34, v34 row_ror:8 row_mask:0xf bank_mask:0xf
    s_nop 1
    v_add_f32_dpp v34, v34, v34 row_ror:4 row_mask:0xf bank_mask:0xf
    s_nop 1
    v_add_f32_dpp v34, v34, v34 row_ror:2 row_mask:0xf bank_mask:0xf
    s_nop 1
    v_add_f32_dpp v34, v34, v34 row_ror:1 row_mask:0xf bank_mask:0xf
    v_mov_b32 v35, v34
    s_nop 1
    v_permlane16_swap_b32 v34, v35
    v_add_f32 v34, v34, v35
    v_rcp_f32 v36, v34
    s_mov_b64 exec, s[30:31]
    v_pk_mul_f32 v[32:33], v[32:33], v[36:37] op_sel_hi:[1,0]
    v_cvt_pk_bf16_f32 v32, v32, v33
    s_branch L_sc_norm
L_sc_redo:
    s_waitcnt vmcnt(0) lgkmcnt(0)
    s_nop 15
    s_barrier
    ds_read_b128 v[84:87], v16 offset:0
    ds_read_b128 v[88:91], v16 offset:1024
    ds_read_b128 v[92:95], v16 offset:2048
    ds_read_b128 v[96:99], v16 offset:3072
    ds_read_b128 v[100:103], v16 offset:4096
    ds_read_b128 v[104:107], v16 offset:5120
    v_mov_b32 v128, 0
    v_mov_b32 v129, 0
    v_mov_b32 v130, 0
    v_mov_b32 v131, 0
    v_mov_b32 v132, 0
    v_mov_b32 v133, 0
    v_mov_b32 v134, 0
    v_mov_b32 v135, 0
    v_mov_b32 v136, 0
    v_mov_b32 v137, 0
    v_mov_b32 v138, 0
    v_mov_b32 v139, 0
    v_mov_b32 v140, 0
    v_mov_b32 v141, 0
    v_mov_b32 v142, 0
    v_mov_b32 v143, 0
    v_mov_b32 v120, 0
    v_mov_b32 v121, 0
    v_mov_b32 v122, 0
    v_mov_b32 v123, 0
    s_branch L_sc_mp
.p2align 6, , 63
    s_nop 0
    s_nop 0
L_sd_step:
L_sd_mp:
    s_mov_b32 m0, s36
L_sd_mpl:
    global_load_dword v112, v4, s[14:15] sc1
    global_load_lds_dwordx4 v2, s[14:15] sc1
    s_mov_b64 exec, s[38:39]
    global_load_lds_dwordx4 v2, s[14:15] offset:1024 sc1
    s_mov_b64 exec, -1
    s_add_u32 s6, s6, 1
    s_cmp_gt_u32 s6, 2097152
    s_cbranch_scc1 L_bail
    s_waitcnt vmcnt(2)
    v_cmp_eq_u32 vcc, s7, v112
    s_cbranch_vccnz L_sd_mpl
    s_waitcnt vmcnt(0) lgkmcnt(0)
    s_barrier
L_sd_go:
    ds_read_b128 v[20:23], v5 offset:0
    ds_read_b128 v[24:27], v5 offset:512
    s_waitcnt lgkmcnt(1)
    v_smfmac_f32_16x16x64_bf16 v[128:131], v[20:23], v[84:91], v1
    ds_read_b128 v[116:119], v6 offset:0
    ds_read_b128 v[32:35], v5 offset:1536
    v_smfmac_f32_16x16x64_bf16 v[132:135], v[20:23], v[92:99], v1
    ds_read_b128 v[28:31], v5 offset:1024
    s_waitcnt lgkmcnt(3)
    v_smfmac_f32_16x16x64_bf16 v[128:131], v[24:27], v[100:107], v1
    ds_read_b128 v[36:39], v5 offset:2048
    v_max_u32 v19, v20, v24
    v_smfmac_f32_16x16x64_bf16 v[132:135], v[24:27], a[0:7], v1
    ds_read_b128 v[124:127], v6 offset:512
    s_waitcnt lgkmcnt(4)
    v_smfmac_f32_16x16x64_bf16 v[140:143], v[116:119], a[8:15], v1
    ds_read_b128 v[116:119], v6 offset:1024
    s_waitcnt lgkmcnt(3)
    v_smfmac_f32_16x16x64_bf16 v[128:131], v[28:31], a[16:23], v1
    ds_read_b128 v[40:43], v5 offset:2560
    v_smfmac_f32_16x16x64_bf16 v[132:135], v[28:31], a[24:31], v1
    s_waitcnt lgkmcnt(2)
    v_smfmac_f32_16x16x64_bf16 v[140:143], v[124:127], a[32:39], v1
    ds_read_b128 v[124:127], v6 offset:1536
    v_smfmac_f32_16x16x64_bf16 v[128:131], v[32:35], a[40:47], v1
    ds_read_b128 v[44:47], v5 offset:3072
    v_max3_u32 v19, v28, v32, v19
    v_smfmac_f32_16x16x64_bf16 v[132:135], v[32:35], a[48:55], v1
    s_waitcnt lgkmcnt(3)
    v_smfmac_f32_16x16x64_bf16 v[140:143], v[116:119], a[56:63], v1
    ds_read_b128 v[116:119], v6 offset:2048
    v_smfmac_f32_16x16x64_bf16 v[128:131], v[36:39], a[64:71], v1
    ds_read_b128 v[48:51], v5 offset:3584
    v_smfmac_f32_16x16x64_bf16 v[132:135], v[36:39], a[72:79], v1
    s_waitcnt lgkmcnt(3)
    v_smfmac_f32_16x16x64_bf16 v[140:143], v[124:127], a[80:87], v1
    ds_read_b128 v[124:127], v6 offset:2560
    v_smfmac_f32_16x16x64_bf16 v[128:131], v[40:43], a[88:95], v1
    v_max3_u32 v19, v36, v40, v19
    v_smfmac_f32_16x16x64_bf16 v[132:135], v[40:43], a[96:103], v1
    s_add_u32 s40, s16, 20480
    s_addc_u32 s41, s17, 0
    s_waitcnt lgkmcnt(2)
    v_smfmac_f32_16x16x64_bf16 v[140:143], v[116:119], a[104:111], v1
    ds_read_b128 v[116:119], v6 offset:3072
    v_smfmac_f32_16x16x64_bf16 v[136:139], v[20:23], a[112:119], v1
    ds_read_b128 v[20:23], v5 offset:4096
    v_smfmac_f32_16x16x64_bf16 v[128:131], v[44:47], a[120:127], v1
    v_smfmac_f32_16x16x64_bf16 v[132:135], v[44:47], a[128:135], v1
    s_mov_b64 exec, s[30:31]
    global_store_dword v13, v18, s[40:41] sc1
    s_mov_b64 exec, -1
    s_waitcnt lgkmcnt(2)
    v_smfmac_f32_16x16x64_bf16 v[140:143], v[124:127], a[136:143], v1
    v_smfmac_f32_16x16x64_bf16 v[136:139], v[24:27], a[144:151], v1
    ds_read_b128 v[24:27], v5 offset:4608
    v_smfmac_f32_16x16x64_bf16 v[128:131], v[48:51], a[152:159], v1
    v_max3_u32 v19, v44, v48, v19
    v_smfmac_f32_16x16x64_bf16 v[132:135], v[48:51], a[160:167], v1
    s_waitcnt lgkmcnt(2)
    v_smfmac_f32_16x16x64_bf16 v[140:143], v[116:119], a[168:175], v1
    v_smfmac_f32_16x16x64_bf16 v[136:139], v[28:31], a[176:183], v1
    ds_read_b128 v[28:31], v5 offset:5120
    s_waitcnt lgkmcnt(2)
    v_smfmac_f32_16x16x64_bf16 v[128:131], v[20:23], a[184:191], v1
    v_cvt_pk_bf16_f32 v114, v140, v141
    v_smfmac_f32_16x16x64_bf16 v[132:135], v[20:23], a[192:199], v1
    v_cvt_pk_bf16_f32 v115, v142, v143
    v_smfmac_f32_16x16x64_bf16 v[136:139], v[32:35], a[200:207], v1
    ds_read_b128 v[32:35], v5 offset:5632
    s_waitcnt lgkmcnt(2)
    v_smfmac_f32_16x16x64_bf16 v[128:131], v[24:27], a[208:215], v1
    ds_write_b64 v9, v[114:115] offset:2304
    v_max3_u32 v19, v20, v24, v19
    v_smfmac_f32_16x16x64_bf16 v[132:135], v[24:27], a[216:223], v1
    ds_read_b64_tr_b16 v[108:109], v10 offset:2304
    ds_read_b64_tr_b16 v[110:111], v10 offset:2688
    v_smfmac_f32_16x16x64_bf16 v[136:139], v[36:39], a[224:231], v1
    ds_read_b128 v[36:39], v5 offset:6144
    s_waitcnt lgkmcnt(5)
    v_smfmac_f32_16x16x64_bf16 v[128:131], v[28:31], a[232:239], v1
    ds_read_b128 v[96:99], v8
    v_smfmac_f32_16x16x64_bf16 v[132:135], v[28:31], a[240:247], v1
    v_smfmac_f32_16x16x64_bf16 v[136:139], v[40:43], a[248:255], v1
    ds_read_b128 v[40:43], v5 offset:6656
    s_waitcnt lgkmcnt(6)
    v_smfmac_f32_16x16x64_bf16 v[128:131], v[32:35], v[144:151], v1
    ds_read_b128 v[84:87], v7 offset:0
    v_max3_u32 v19, v28, v32, v19
    v_smfmac_f32_16x16x64_bf16 v[132:135], v[32:35], v[152:159], v1
    v_smfmac_f32_16x16x64_bf16 v[136:139], v[44:47], v[160:167], v1
    s_waitcnt lgkmcnt(3)
    v_smfmac_f32_16x16x64_bf16 v[128:131], v[36:39], v[168:175], v1
    ds_read_b128 v[88:91], v7 offset:512
    v_smfmac_f32_16x16x64_bf16 v[132:135], v[36:39], v[176:183], v1
    v_smfmac_f32_16x16x64_bf16 v[136:139], v[48:51], v[184:191], v1
    s_waitcnt lgkmcnt(2)
    v_smfmac_f32_16x16x64_bf16 v[128:131], v[40:43], v[192:199], v1
    ds_read_b128 v[92:95], v7 offset:1024
    v_max3_u32 v19, v36, v40, v19
    v_smfmac_f32_16x16x64_bf16 v[132:135], v[40:43], v[200:207], v1
    v_cmp_eq_u32 vcc, s7, v19
    v_smfmac_f32_16x16x64_bf16 v[136:139], v[20:23], v[208:215], v1
    v_cvt_pk_bf16_f32 v112, v128, v129
    v_smfmac_f32_16x16x64_bf16 v[136:139], v[24:27], v[216:223], v1
    v_cvt_pk_bf16_f32 v113, v130, v131
    v_smfmac_f32_16x16x64_bf16 v[136:139], v[28:31], v[224:231], v1
    ds_write_b64 v9, v[112:113] offset:0
    v_cvt_pk_bf16_f32 v114, v132, v133
    v_smfmac_f32_16x16x64_bf16 v[136:139], v[32:35], v[232:239], v1
    ds_read_b64_tr_b16 v[100:101], v10 offset:0
    ds_read_b64_tr_b16 v[102:103], v10 offset:384
    v_cvt_pk_bf16_f32 v115, v134, v135
    v_smfmac_f32_16x16x64_bf16 v[136:139], v[36:39], v[240:247], v1
    ds_write_b64 v9, v[114:115] offset:768
    v_smfmac_f32_16x16x64_bf16 v[136:139], v[40:43], v[248:255], v1
    ds_read_b64_tr_b16 v[104:105], v10 offset:768
    ds_read_b64_tr_b16 v[106:107], v10 offset:1152
    v_smfmac_f32_16x16x64_bf16 v[120:123], v[108:111], v[76:83], v1
    v_mfma_f32_16x16x32_bf16 v[116:119], v[96:99], v[108:111], 0
    v_cvt_pk_bf16_f32 v112, v136, v137
    v_cvt_pk_bf16_f32 v113, v138, v139
    ds_write_b64 v9, v[112:113] offset:1536
    ds_read_b64_tr_b16 v[20:21], v10 offset:1536
    ds_read_b64_tr_b16 v[22:23], v10 offset:1920
    s_cbranch_vccnz L_sd_redo
    s_waitcnt lgkmcnt(11)
    s_waitcnt lgkmcnt(6)
    v_smfmac_f32_16x16x64_bf16 v[120:123], v[100:103], v[52:59], v1
    v_mfma_f32_16x16x32_bf16 v[116:119], v[84:87], v[100:103], v[116:119]
    s_waitcnt lgkmcnt(3)
    v_smfmac_f32_16x16x64_bf16 v[120:123], v[104:107], v[60:67], v1
    v_mfma_f32_16x16x32_bf16 v[116:119], v[88:91], v[104:107], v[116:119]
    s_waitcnt lgkmcnt(0)
    v_mfma_f32_16x16x32_bf16 v[116:119], v[92:95], v[20:23], v[116:119]
    v_smfmac_f32_16x16x64_bf16 v[120:123], v[20:23], v[68:75], v1
    s_nop 3
    v_cndmask_b32 v24, v116, v117, s[32:33]
    v_cndmask_b32 v25, v118, v119, s[32:33]
    v_cndmask_b32 v24, v24, v25, s[34:35]
    ds_write_b32 v17, v24
    ds_write2_b32 v11, v120, v121 offset0:0 offset1:44
    ds_write2_b32 v11, v122, v123 offset0:88 offset1:132
    v_mov_b32 v128, 0
    v_mov_b32 v129, 0
    v_mov_b32 v130, 0
    v_mov_b32 v131, 0
    v_mov_b32 v132, 0
    s_waitcnt lgkmcnt(0)
    s_barrier
    ds_read_b64 v[24:25], v12 offset:0
    ds_read_b64 v[26:27], v12 offset:1408
    ds_read_b64 v[28:29], v12 offset:2816
    ds_read_b64 v[30:31], v12 offset:4224
    v_mov_b32 v133, 0
    v_mov_b32 v134, 0
    v_mov_b32 v135, 0
    s_waitcnt lgkmcnt(2)
    v_pk_add_f32 v[24:25], v[24:25], v[26:27]
    s_waitcnt lgkmcnt(0)
    v_pk_add_f32 v[28:29], v[28:29], v[30:31]
    v_pk_add_f32 v[24:25], v[24:25], v[28:29]
    v_exp_f32 v32, v24
    v_exp_f32 v33, v25
    s_nop 0
    v_add_f32 v34, v32, v33
    s_nop 1
    v_add_f32_dpp v34, v34, v34 row_ror:8 row_mask:0xf bank_mask:0xf
    s_nop 1
    v_add_f32_dpp v34, v34, v34 row_ror:4 row_mask:0xf bank_mask:0xf
    s_nop 1
    v_add_f32_dpp v34, v34, v34 row_ror:2 row_mask:0xf bank_mask:0xf
    s_nop 1
    v_add_f32_dpp v34, v34, v34 row_ror:1 row_mask:0xf bank_mask:0xf
    v_mov_b32 v35, v34
    v_med3_f32 v37, v34, v0, s26
    v_cmp_neq_f32 vcc, v37, v34
    v_permlane16_swap_b32 v34, v35
    v_add_f32 v34, v34, v35
    v_rcp_f32 v36, v34
    s_mov_b64 exec, s[30:31]
    v_pk_mul_f32 v[32:33], v[32:33], v[36:37] op_sel_hi:[1,0]
    v_cvt_pk_bf16_f32 v32, v32, v33
    s_cbranch_vccnz L_sd_max
L_sd_norm:
    global_store_dword v13, v32, s[16:17] sc1
    s_mov_b64 exec, -1
    s_add_u32 s5, s5, 1
    s_cmp_ge_u32 s5, 63
    s_cbranch_scc1 L_sc_end
    s_cmp_ge_u32 s5, 62
    s_cbranch_scc1 L_sd_nox
    s_add_u32 m0, s37, 0
    s_nop 0
    global_load_lds_dwordx4 v14, s[10:11] offset:0
    s_add_u32 m0, s37, 1024
    s_nop 0
    global_load_lds_dwordx4 v14, s[12:13] offset:0
    s_add_u32 m0, s37, 1984
    s_nop 0
    global_load_lds_dwordx4 v14, s[10:11] offset:64
    s_add_u32 m0, s37, 3008
    s_nop 0
    global_load_lds_dwordx4 v14, s[12:13] offset:64
    s_add_u32 m0, s37, 3968
    s_nop 0
    global_load_lds_dwordx4 v14, s[10:11] offset:128
    s_add_u32 m0, s37, 4992
    s_nop 0
    global_load_lds_dwordx4 v14, s[12:13] offset:128
    s_add_u32 m0, s37, 6144
    s_nop 0
    global_load_lds_dwordx4 v15, s[10:11]
    s_add_u32 m0, s37, 7168
    s_nop 0
    global_load_lds_dwordx4 v15, s[12:13]
    s_add_u32 s10, s10, 28672
    s_addc_u32 s11, s11, 0
    s_add_u32 s12, s12, 28672
    s_addc_u32 s13, s13, 0
    s_xor_b32 s37, s37, 0x8000
    s_branch L_sd_nof
L_sd_nox:
    s_lshl_b32 s42, s3, 2
    s_add_u32 s42, s42, s4
    s_mul_i32 s42, s42, 10240
    s_add_u32 s40, s8, 61353984
    s_addc_u32 s41, s9, 0
    s_add_u32 s40, s40, s42
    s_addc_u32 s41, s41, 0
    s_lshl_b32 s42, s4, 13
    s_lshl_b32 s43, s4, 11
    v_subrev_u32 v20, s36, v2
    s_add_u32 m0, s42, 131072
    s_nop 0
    global_load_lds_dwordx4 v20, s[40:41] offset:0 sc1
    s_add_u32 m0, s42, 131072
    s_nop 0
    global_load_lds_dwordx4 v20, s[40:41] offset:1024 sc1
    s_add_u32 m0, s42, 131072
    s_nop 0
    global_load_lds_dwordx4 v20, s[40:41] offset:2048 sc1
    s_add_u32 m0, s42, 131072
    s_nop 0
    global_load_lds_dwordx4 v20, s[40:41] offset:3072 sc1
    s_add_u32 s40, s40, 4096
    s_addc_u32 s41, s41, 0
    s_add_u32 m0, s42, 135168
    s_nop 0
    global_load_lds_dwordx4 v20, s[40:41] offset:0 sc1
    s_add_u32 m0, s42, 135168
    s_nop 0
    global_load_lds_dwordx4 v20, s[40:41] offset:1024 sc1
    s_add_u32 m0, s42, 135168
    s_nop 0
    global_load_lds_dwordx4 v20, s[40:41] offset:2048 sc1
    s_add_u32 m0, s42, 135168
    s_nop 0
    global_load_lds_dwordx4 v20, s[40:41] offset:3072 sc1
    s_add_u32 s40, s40, 4096
    s_addc_u32 s41, s41, 0
    s_add_u32 m0, s43, 51200
    s_nop 0
    global_load_lds_dwordx4 v20, s[40:41] offset:0 sc1
    s_add_u32 m0, s43, 51200
    s_nop 0
    global_load_lds_dwordx4 v20, s[40:41] offset:1024 sc1
L_sd_nof:
    ds_read_b128 v[84:87], v16 offset:0
    ds_read_b128 v[88:91], v16 offset:1024
    ds_read_b128 v[92:95], v16 offset:2048
    ds_read_b128 v[96:99], v16 offset:3072
    ds_read_b128 v[100:103], v16 offset:4096
    ds_read_b128 v[104:107], v16 offset:5120
    v_mov_b32 v136, 0
    v_mov_b32 v137, 0
    v_mov_b32 v138, 0
    v_mov_b32 v139, 0
    v_mov_b32 v140, 0
    v_mov_b32 v141, 0
    v_mov_b32 v142, 0
    v_mov_b32 v143, 0
    s_add_u32 s16, s16, 10240
    s_addc_u32 s17, s17, 0
    s_add_u32 s14, s14, 8192
    s_addc_u32 s15, s15, 0
    ds_read_b128 v[20:23], v3 offset:0
    ds_read_b128 v[24:27], v3 offset:1024
    ds_read_b128 v[28:31], v3 offset:2048
    ds_read_b128 v[32:35], v3 offset:3072
    ds_read_b128 v[36:39], v3 offset:4096
    ds_read_b128 v[40:43], v3 offset:5120
    ds_read_b128 v[44:47], v3 offset:6144
    ds_read_b128 v[48:51], v3 offset:7168
    s_waitcnt lgkmcnt(6)
    v_mov_b32 v52, v20
    v_mov_b32 v53, v24
    v_mov_b32 v54, v21
    v_mov_b32 v55, v25
    v_mov_b32 v56, v22
    v_mov_b32 v57, v26
    v_mov_b32 v58, v23
    v_mov_b32 v59, v27
    s_waitcnt lgkmcnt(4)
    v_mov_b32 v60, v28
    v_mov_b32 v61, v32
    v_mov_b32 v62, v29
    v_mov_b32 v63, v33
    v_mov_b32 v64, v30
    v_mov_b32 v65, v34
    v_mov_b32 v66, v31
    v_mov_b32 v67, v35
    s_waitcnt lgkmcnt(2)
    v_mov_b32 v68, v36
    v_mov_b32 v69, v40
    v_mov_b32 v70, v37
    v_mov_b32 v71, v41
    v_mov_b32 v72, v38
    v_mov_b32 v73, v42
    v_mov_b32 v74, v39
    v_mov_b32 v75, v43
    s_waitcnt lgkmcnt(0)
    v_mov_b32 v76, v44
    v_mov_b32 v77, v48
    v_mov_b32 v78, v45
    v_mov_b32 v79, v49
    v_mov_b32 v80, v46
    v_mov_b32 v81, v50
    v_mov_b32 v82, v47
    v_mov_b32 v83, v51
    v_mov_b32 v120, 0
    v_mov_b32 v121, 0
    v_mov_b32 v122, 0
    v_mov_b32 v123, 0
    v_xor_b32 v3, 0x8000, v3
    s_branch L_sd_step
L_sd_max:
    s_mov_b64 exec, -1
    s_nop 1
    v_max_f32 v34, v24, v25
    s_nop 1
    v_max_f32_dpp v34, v34, v34 row_ror:8 row_mask:0xf bank_mask:0xf
    s_nop 1
    v_max_f32_dpp v34, v34, v34 row_ror:4 row_mask:0xf bank_mask:0xf
    s_nop 1
    v_max_f32_dpp v34, v34, v34 row_ror:2 row_mask:0xf bank_mask:0xf
    s_nop 1
    v_max_f32_dpp v34, v34, v34 row_ror:1 row_mask:0xf bank_mask:0xf
    v_mov_b32 v35, v34
    s_nop 1
    v_permlane16_swap_b32 v34, v35
    v_max_f32 v34, v34, v35
    v_sub_f32 v32, v24, v34
    v_sub_f32 v33, v25, v34
    v_exp_f32 v32, v32
    v_exp_f32 v33, v33
    s_nop 0
    v_add_f32 v34, v32, v33
    s_nop 1
    v_add_f32_dpp v34, v34, v34 row_ror:8 row_mask:0xf bank_mask:0xf
    s_nop 1
    v_add_f32_dpp v34, v34, v34 row_ror:4 row_mask:0xf bank_mask:0xf
    s_nop 1
    v_add_f32_dpp v34, v34, v34 row_ror:2 row_mask:0xf bank_mask:0xf
    s_nop 1
    v_add_f32_dpp v34, v34, v34 row_ror:1 row_mask:0xf bank_mask:0xf
    v_mov_b32 v35, v34
    s_nop 1
    v_permlane16_swap_b32 v34, v35
    v_add_f32 v34, v34, v35
    v_rcp_f32 v36, v34
    s_mov_b64 exec, s[30:31]
    v_pk_mul_f32 v[32:33], v[32:33], v[36:37] op_sel_hi:[1,0]
    v_cvt_pk_bf16_f32 v32, v32, v33
    s_branch L_sd_norm
L_sd_redo:
    s_waitcnt vmcnt(0) lgkmcnt(0)
    s_nop 15
    s_barrier
    ds_read_b128 v[84:87], v16 offset:0
    ds_read_b128 v[88:91], v16 offset:1024
    ds_read_b128 v[92:95], v16 offset:2048
    ds_read_b128 v[96:99], v16 offset:3072
    ds_read_b128 v[100:103], v16 offset:4096
    ds_read_b128 v[104:107], v16 offset:5120
    v_mov_b32 v128, 0
    v_mov_b32 v129, 0
    v_mov_b32 v130, 0
    v_mov_b32 v131, 0
    v_mov_b32 v132, 0
    v_mov_b32 v133, 0
    v_mov_b32 v134, 0
    v_mov_b32 v135, 0
    v_mov_b32 v136, 0
    v_mov_b32 v137, 0
    v_mov_b32 v138, 0
    v_mov_b32 v139, 0
    v_mov_b32 v140, 0
    v_mov_b32 v141, 0
    v_mov_b32 v142, 0
    v_mov_b32 v143, 0
    v_mov_b32 v120, 0
    v_mov_b32 v121, 0
    v_mov_b32 v122, 0
    v_mov_b32 v123, 0
    s_branch L_sd_mp
L_sc_end:
    v_mbcnt_lo_u32_b32 v0, -1, 0
    v_mbcnt_hi_u32_b32 v0, -1, v0
    v_and_b32 v1, 15, v0
    v_lshrrev_b32 v2, 4, v0
    v_lshlrev_b32 v3, 4, v0
    s_mul_i32 s40, s4, 1792
    v_add_u32 v56, s40, v3
    v_min_u32 v57, 47, v0
    v_lshlrev_b32 v57, 4, v57
    v_add3_u32 v57, v57, s40, s40
    v_subrev_u32 v57, s40, v57
    v_add_u32 v57, 1024, v57
    s_and_b32 s46, s4, 1
    s_lshr_b32 s41, s4, 1
    s_mul_i32 s41, s41, 7
    s_lshl_b32 s40, s46, 2
    s_add_u32 s40, s40, s41
    s_add_u32 s41, s41, 3
    s_sub_u32 s24, 0, s46
    s_mov_b32 s25, s24
    s_and_b32 s45, s4, 1
    s_lshl_b32 s45, s45, 3
    v_and_b32 v9, 7, v0
    v_lshlrev_b32 v8, 7, v2
    v_lshl_add_u32 v8, v9, 4, v8
    s_lshl_b32 s42, s40, 9
    s_add_u32 s42, s42, 61440
    v_add_u32 v58, s42, v8
    s_lshl_b32 s42, s41, 9
    s_add_u32 s42, s42, s45
    s_add_u32 s42, s42, 61440
    v_add_u32 v59, s42, v8
    s_mul_i32 s42, s4, 5632
    s_add_u32 s42, s42, 69632
    v_mul_u32_u24 v8, 176, v1
    v_lshl_add_u32 v8, v2, 4, v8
    v_add_u32 v60, s42, v8
    v_lshrrev_b32 v10, 3, v0
    v_lshl_add_u32 v10, s4, 3, v10
    v_min_u32 v11, 4, v9
    v_subrev_u32 v11, 1, v11
    v_lshrrev_b32 v12, 1, v11
    v_and_b32 v13, 1, v11
    v_lshlrev_b32 v13, 2, v13
    v_lshl_add_u32 v13, v12, 4, v13
    v_lshlrev_b32 v14, 2, v13
    v_add_u32 v14, 32, v14
    v_add_u32 v15, 32, v14
    v_cmp_eq_u32 s[34:35], 0, v9
    s_nop 1
    v_cndmask_b32 v14, v14, 0, s[34:35]
    v_cndmask_b32 v15, v15, 16, s[34:35]
    v_mul_u32_u24 v8, 176, v10
    v_add_u32 v8, 69632, v8
    v_add_u32 v61, v8, v14
    v_add_u32 v62, v8, v15
    v_cmp_gt_u32 s[32:33], 5, v9
    v_add_u32 v8, 0, v13
    v_cmp_le_u32 vcc, v8, v10
    s_or_b64 vcc, vcc, s[34:35]
    s_and_b64 s[48:49], vcc, s[32:33]
    v_add_u32 v8, 1, v13
    v_cmp_le_u32 vcc, v8, v10
    s_or_b64 vcc, vcc, s[34:35]
    s_and_b64 s[50:51], vcc, s[32:33]
    v_add_u32 v8, 2, v13
    v_cmp_le_u32 vcc, v8, v10
    s_or_b64 vcc, vcc, s[34:35]
    s_and_b64 s[52:53], vcc, s[32:33]
    v_add_u32 v8, 3, v13
    v_cmp_le_u32 vcc, v8, v10
    s_or_b64 vcc, vcc, s[34:35]
    s_and_b64 s[54:55], vcc, s[32:33]
    v_add_u32 v8, 8, v13
    v_cmp_le_u32 vcc, v8, v10
    s_or_b64 vcc, vcc, s[34:35]
    s_and_b64 s[56:57], vcc, s[32:33]
    v_add_u32 v8, 9, v13
    v_cmp_le_u32 vcc, v8, v10
    s_or_b64 vcc, vcc, s[34:35]
    s_and_b64 s[58:59], vcc, s[32:33]
    v_add_u32 v8, 10, v13
    v_cmp_le_u32 vcc, v8, v10
    s_or_b64 vcc, vcc, s[34:35]
    s_and_b64 s[60:61], vcc, s[32:33]
    v_add_u32 v8, 11, v13
    v_cmp_le_u32 vcc, v8, v10
    s_or_b64 vcc, vcc, s[34:35]
    s_and_b64 s[62:63], vcc, s[32:33]
    s_and_b32 s42, s3, 3
    v_mov_b32 v8, s42
    v_cndmask_b32 v12, v11, v8, s[34:35]
    v_cndmask_b32 v8, v8, 4, s[34:35]
    v_lshrrev_b32 v14, 4, v10
    v_lshl_add_u32 v8, v8, 1, v14
    v_lshlrev_b32 v8, 10, v8
    v_and_b32 v14, 15, v10
    v_lshl_add_u32 v14, v12, 4, v14
    v_lshl_add_u32 v14, v14, 4, v8
    s_lshr_b32 s43, s3, 2
    s_mul_i32 s43, s43, 10240
    v_add_u32 v63, s43, v14
    s_lshl_b32 s42, s4, 13
    s_add_u32 s42, s42, 131072
    v_add_u32 v4, s42, v3
    s_lshl_b32 s42, s4, 11
    s_add_u32 s42, s42, 51200
    v_add_u32 v5, s42, v3
    ds_read_b128 v[8:11], v4 offset:0
    ds_read_b128 v[12:15], v4 offset:1024
    ds_read_b128 v[16:19], v4 offset:2048
    ds_read_b128 v[20:23], v4 offset:3072
    ds_read_b128 v[24:27], v4 offset:4096
    ds_read_b128 v[28:31], v4 offset:5120
    ds_read_b128 v[32:35], v4 offset:6144
    ds_read_b128 v[96:99], v4 offset:7168
    ds_read_b128 v[100:103], v5 offset:0
    ds_read_b128 v[104:107], v5 offset:1024
    s_add_u32 s14, s14, 8192
    s_addc_u32 s15, s15, 0
    s_add_u32 s16, s8, 53972992
    s_addc_u32 s17, s9, 0
    s_waitcnt lgkmcnt(0)
    ds_write_b128 v60, v[96:99] offset:32
    ds_write_b128 v60, v[100:103] offset:2848
    ds_write_b128 v60, v[104:107] offset:2912
L_sf_mf:
    global_load_dwordx4 v[64:67], v56, s[14:15] sc1
    global_load_dwordx4 v[68:71], v57, s[14:15] sc1
    s_add_u32 s6, s6, 1
    s_cmp_gt_u32 s6, 1048576
    s_cbranch_scc1 L_bail
    s_waitcnt vmcnt(0)
    v_max3_u32 v72, v64, v65, v66
    v_max3_u32 v72, v72, v67, v68
    v_max3_u32 v72, v72, v69, v70
    v_max_u32 v72, v72, v71
    v_cmp_eq_u32 vcc, s7, v72
    s_cbranch_vccnz L_sf_mf
    ds_write_b128 v56, v[64:67] offset:61440
    ds_write_b128 v57, v[68:71] offset:61440
    s_waitcnt lgkmcnt(0)
    s_barrier
    ds_read_b128 v[36:39], v58 offset:0
    ds_read_b128 v[40:43], v58 offset:512
    ds_read_b128 v[44:47], v58 offset:1024
    ds_read_b64 v[48:49], v59
    s_waitcnt lgkmcnt(1)
    v_mfma_f32_16x16x32_bf16 v[108:111], v[36:39], v[8:11], 0
    v_mfma_f32_16x16x32_bf16 v[112:115], v[36:39], v[12:15], 0
    v_mfma_f32_16x16x32_bf16 v[108:111], v[40:43], v[16:19], v[108:111]
    v_mfma_f32_16x16x32_bf16 v[112:115], v[40:43], v[20:23], v[112:115]
    v_mfma_f32_16x16x32_bf16 v[108:111], v[44:47], v[24:27], v[108:111]
    v_mfma_f32_16x16x32_bf16 v[112:115], v[44:47], v[28:31], v[112:115]
    s_waitcnt lgkmcnt(0)
    v_mfma_f32_16x16x16_bf16 v[108:111], v[48:49], v[32:33], v[108:111]
    v_mfma_f32_16x16x16_bf16 v[112:115], v[48:49], v[34:35], v[112:115]
    s_mov_b32 exec_hi, 0
    s_nop 2
    ds_write_b128 v60, v[108:111]
    s_nop 2
    ds_write_b128 v60, v[112:115] offset:2816
    s_mov_b64 exec, -1
    s_waitcnt lgkmcnt(0)
    s_barrier
    ds_read_b128 v[64:67], v61 offset:0
    ds_read_b128 v[68:71], v62 offset:0
    ds_read_b128 v[72:75], v61 offset:5632
    ds_read_b128 v[76:79], v62 offset:5632
    ds_read_b128 v[80:83], v61 offset:11264
    ds_read_b128 v[84:87], v62 offset:11264
    ds_read_b128 v[88:91], v61 offset:16896
    ds_read_b128 v[92:95], v62 offset:16896
    v_mov_b32 v37, 0xff800000
    s_waitcnt lgkmcnt(0)
    v_pk_add_f32 v[64:65], v[64:65], v[72:73]
    v_pk_add_f32 v[66:67], v[66:67], v[74:75]
    v_pk_add_f32 v[68:69], v[68:69], v[76:77]
    v_pk_add_f32 v[70:71], v[70:71], v[78:79]
    v_pk_add_f32 v[80:81], v[80:81], v[88:89]
    v_pk_add_f32 v[82:83], v[82:83], v[90:91]
    v_pk_add_f32 v[84:85], v[84:85], v[92:93]
    v_pk_add_f32 v[86:87], v[86:87], v[94:95]
    v_pk_add_f32 v[64:65], v[64:65], v[80:81]
    v_pk_add_f32 v[66:67], v[66:67], v[82:83]
    v_pk_add_f32 v[68:69], v[68:69], v[84:85]
    v_pk_add_f32 v[70:71], v[70:71], v[86:87]
    v_cndmask_b32 v64, v37, v64, s[48:49]
    v_cndmask_b32 v65, v37, v65, s[50:51]
    v_cndmask_b32 v66, v37, v66, s[52:53]
    v_cndmask_b32 v67, v37, v67, s[54:55]
    v_cndmask_b32 v68, v37, v68, s[56:57]
    v_cndmask_b32 v69, v37, v69, s[58:59]
    v_cndmask_b32 v70, v37, v70, s[60:61]
    v_cndmask_b32 v71, v37, v71, s[62:63]
    v_max3_f32 v36, v64, v65, v66
    v_max3_f32 v36, v36, v67, v68
    v_max3_f32 v36, v36, v69, v70
    v_max_f32 v36, v36, v71
    s_nop 1
    v_max_f32_dpp v36, v36, v36 quad_perm:[1,0,3,2] row_mask:0xf bank_mask:0xf
    s_nop 1
    v_max_f32_dpp v36, v36, v36 quad_perm:[2,3,0,1] row_mask:0xf bank_mask:0xf
    s_nop 1
    v_max_f32_dpp v36, v36, v36 row_half_mirror row_mask:0xf bank_mask:0xf
    v_sub_f32 v64, v64, v36
    v_sub_f32 v65, v65, v36
    v_sub_f32 v66, v66, v36
    v_sub_f32 v67, v67, v36
    v_sub_f32 v68, v68, v36
    v_sub_f32 v69, v69, v36
    v_sub_f32 v70, v70, v36
    v_sub_f32 v71, v71, v36
    v_exp_f32 v64, v64
    v_exp_f32 v65, v65
    v_exp_f32 v66, v66
    v_exp_f32 v67, v67
    v_exp_f32 v68, v68
    v_exp_f32 v69, v69
    v_exp_f32 v70, v70
    v_exp_f32 v71, v71
    v_pk_add_f32 v[36:37], v[64:65], v[66:67]
    v_pk_add_f32 v[38:39], v[68:69], v[70:71]
    v_pk_add_f32 v[36:37], v[36:37], v[38:39]
    v_add_f32 v36, v36, v37
    s_nop 1
    v_add_f32_dpp v36, v36, v36 quad_perm:[1,0,3,2] row_mask:0xf bank_mask:0xf
    s_nop 1
    v_add_f32_dpp v36, v36, v36 quad_perm:[2,3,0,1] row_mask:0xf bank_mask:0xf
    s_nop 1
    v_add_f32_dpp v36, v36, v36 row_half_mirror row_mask:0xf bank_mask:0xf
    v_rcp_f32 v36, v36
    s_nop 0
    v_pk_mul_f32 v[64:65], v[64:65], v[36:37] op_sel_hi:[1,0]
    v_pk_mul_f32 v[66:67], v[66:67], v[36:37] op_sel_hi:[1,0]
    v_pk_mul_f32 v[68:69], v[68:69], v[36:37] op_sel_hi:[1,0]
    v_pk_mul_f32 v[70:71], v[70:71], v[36:37] op_sel_hi:[1,0]
    v_cvt_pk_bf16_f32 v72, v64, v65
    v_cvt_pk_bf16_f32 v76, v66, v67
    v_cvt_pk_bf16_f32 v77, v68, v69
    v_cvt_pk_bf16_f32 v75, v70, v71
    v_cndmask_b32 v73, v77, v76, s[34:35]
    v_cndmask_b32 v74, v76, v77, s[34:35]
    s_mov_b64 exec, s[32:33]
    s_cmp_eq_u32 s64, 0
    s_cbranch_scc1 L_sf_slow
    global_store_dwordx4 v63, v[72:75], s[16:17]
    s_endpgm
L_sf_slow:
    global_store_dwordx4 v63, v[72:75], s[16:17] sc1
    s_endpgm
L_value:
    s_load_dwordx2 s[10:11], s[0:1], 88
    s_waitcnt lgkmcnt(0)
    s_mov_b32 s5, 0
    s_mov_b32 s6, 0
    s_mov_b32 s7, 4290772927
    s_mov_b32 s90, 0
    s_mov_b32 s27, s3
    s_sub_u32 s3, s3, 16
    v_and_b32 v20, 15, v0
    v_lshrrev_b32 v21, 4, v0
    v_and_b32 v22, 7, v0
    v_mov_b32 v1, 0x4444
    v_mov_b32 v23, 0xeeee
    v_cmp_lt_u32 vcc, 7, v20
    s_nop 1
    v_cndmask_b32 v1, v1, v23, vcc
    s_mul_i32 s36, s4, 1792
    v_lshlrev_b32 v2, 4, v0
    v_add_u32 v2, s36, v2
    s_mov_b32 s38, -1
    s_mov_b32 s39, 0xffff
    v_min_u32 v24, 13, v0
    v_lshlrev_b32 v24, 7, v24
    v_add3_u32 v4, s36, v24, 64
    v_lshlrev_b32 v5, 7, v21
    v_lshl_add_u32 v5, v22, 4, v5
    s_mul_i32 s40, s4, 28672
    s_add_u32 s40, s40, 16384
    v_lshl_add_u32 v6, v0, 4, s40
    s_lshl_b32 s40, s4, 13
    v_lshl_add_u32 v7, v0, 4, s40
    v_add_u32 v8, 4096, v7
    s_mul_i32 s40, s4, 2560
    v_and_b32 v25, 1, v21
    v_lshl_add_u32 v10, v0, 4, s40
    v_lshl_add_u32 v9, v0, 2, s40
    v_lshlrev_b32 v17, 2, v20
    s_and_b32 s41, s4, 1
    s_lshl_b32 s41, s41, 13
    v_lshl_add_u32 v19, v0, 4, s41
    s_add_u32 s37, s41, 131072
    v_lshl_add_u32 v18, v0, 4, s37
    s_mul_i32 s40, s4, 1536
    s_add_u32 s40, s40, 8192
    v_lshrrev_b32 v27, 5, v0
    v_lshl_add_u32 v27, v27, 4, v20
    v_mul_u32_u24 v27, 48, v27
    v_lshl_add_u32 v27, v25, 4, v27
    v_add_u32 v12, s40, v27
    s_and_b32 s40, s4, 1
    s_lshl_b32 s40, s40, 4
    s_lshr_b32 s41, s4, 1
    s_lshl_b32 s41, s41, 2
    s_add_u32 s40, s40, s41
    v_bfe_u32 v27, v0, 2, 1
    v_lshlrev_b32 v27, 3, v27
    v_and_b32 v28, 3, v0
    v_add3_u32 v27, v27, v28, s40
    v_mul_u32_u24 v27, 48, v27
    v_lshrrev_b32 v28, 3, v0
    v_lshl_add_u32 v27, v28, 2, v27
    v_add_u32 v13, 8192, v27
    s_lshl_b32 s40, s3, 9
    s_lshl_b32 s41, s4, 7
    s_add_u32 s40, s40, s41
    v_lshl_add_u32 v14, v0, 1, s40
    v_mov_b32 v11, 4290772927
    s_add_u32 s14, s8, 42205184
    s_addc_u32 s15, s9, 0
    s_add_u32 s40, s14, 8192
    s_addc_u32 s41, s15, 0
    s_add_u32 s42, s14, 16384
    s_addc_u32 s43, s15, 0
    global_store_short v14, v11, s[40:41] sc1
    global_store_short v14, v11, s[42:43] sc1
    s_getreg_b32 s75, hwreg(HW_REG_XCC_ID, 0, 4)
    s_add_u32 s75, s75, 1
    v_mov_b32 v32, s27
    v_mov_b32 v33, s75
    s_waitcnt vmcnt(0)
    s_barrier
    global_store_byte v32, v33, s[96:97] offset:224 sc1
    s_mul_i32 s40, s4, 1605632
    s_mul_i32 s41, s3, 28672
    s_add_u32 s40, s40, s41
    s_cmp_ge_u32 s3, 8
    s_cselect_b32 s27, 1, 0
    v_lshlrev_b32 v28, 4, v0
    s_add_u32 s24, s8, 6422528
    s_addc_u32 s25, s9, 0
    s_add_u32 s24, s24, s40
    s_addc_u32 s25, s25, 0
    s_add_u32 s18, s8, 43982848
    s_addc_u32 s19, s9, 0
    s_lshl_b32 s40, s27, 11
    s_lshl_b32 s41, s4, 9
    s_add_u32 s40, s40, s41
    v_bfe_u32 v32, v0, 3, 2
    v_lshl_add_u32 v32, v32, 7, s40
    v_lshl_add_u32 v32, v22, 2, v32
    s_mov_b32 s46, 15
L_va_w:
    s_sleep 2
    global_load_dword v33, v32, s[18:19] sc1
    s_add_u32 s6, s6, 1
    s_cmp_gt_u32 s6, 2097152
    s_cbranch_scc1 L_bail
    s_waitcnt vmcnt(0)
    v_cmp_eq_u32 vcc, 0, v33
    s_mov_b32 s47, vcc_lo
    s_bitcmp0_b32 s46, 3
    s_cbranch_scc1 L_va_w3
    s_and_b32 s40, s47, 4278190080
    s_cbranch_scc1 L_va_w3
    s_bitset0_b32 s46, 3
    s_waitcnt vmcnt(32)
    s_add_u32 s40, s24, 1204224
    s_addc_u32 s41, s25, 0
    global_load_dwordx4 v[60:63], v28, s[40:41] offset:0 sc1
    global_load_dwordx4 v[64:67], v28, s[40:41] offset:1024 sc1
    global_load_dwordx4 v[68:71], v28, s[40:41] offset:2048 sc1
    global_load_dwordx4 v[72:75], v28, s[40:41] offset:3072 sc1
    s_add_u32 s40, s40, 4096
    s_addc_u32 s41, s41, 0
    global_load_dwordx4 v[76:79], v28, s[40:41] offset:0 sc1
    global_load_dwordx4 v[80:83], v28, s[40:41] offset:1024 sc1
    global_load_dwordx4 v[84:87], v28, s[40:41] offset:2048 sc1
    global_load_dwordx4 v[88:91], v28, s[40:41] offset:3072 sc1
    s_add_u32 s40, s40, 4096
    s_addc_u32 s41, s41, 0
    global_load_dwordx4 v[92:95], v28, s[40:41] offset:0 sc1
    global_load_dwordx4 v[96:99], v28, s[40:41] offset:1024 sc1
    global_load_dwordx4 v[100:103], v28, s[40:41] offset:2048 sc1
    global_load_dwordx4 v[104:107], v28, s[40:41] offset:3072 sc1
    s_add_u32 s40, s40, 4096
    s_addc_u32 s41, s41, 0
    global_load_dwordx4 v[108:111], v28, s[40:41] offset:0 sc1
    global_load_dwordx4 v[112:115], v28, s[40:41] offset:1024 sc1
    global_load_dwordx4 v[116:119], v28, s[40:41] offset:2048 sc1
    global_load_dwordx4 v[120:123], v28, s[40:41] offset:3072 sc1
    s_add_u32 s40, s40, 4096
    s_addc_u32 s41, s41, 0
    global_load_dwordx4 v[124:127], v28, s[40:41] offset:0 sc1
    global_load_dwordx4 v[128:131], v28, s[40:41] offset:1024 sc1
    global_load_dwordx4 v[132:135], v28, s[40:41] offset:2048 sc1
    global_load_dwordx4 v[136:139], v28, s[40:41] offset:3072 sc1
    s_add_u32 s40, s40, 4096
    s_addc_u32 s41, s41, 0
    global_load_dwordx4 v[140:143], v28, s[40:41] offset:0 sc1
    global_load_dwordx4 v[144:147], v28, s[40:41] offset:1024 sc1
    global_load_dwordx4 v[148:151], v28, s[40:41] offset:2048 sc1
    global_load_dwordx4 v[152:155], v28, s[40:41] offset:3072 sc1
    s_add_u32 s40, s40, 4096
    s_addc_u32 s41, s41, 0
    global_load_dwordx4 v[156:159], v28, s[40:41] offset:0 sc1
    global_load_dwordx4 v[160:163], v28, s[40:41] offset:1024 sc1
    global_load_dwordx4 v[164:167], v28, s[40:41] offset:2048 sc1
    global_load_dwordx4 v[168:171], v28, s[40:41] offset:3072 sc1
L_va_w3:
    s_bitcmp0_b32 s46, 0
    s_cbranch_scc1 L_va_w0
    s_and_b32 s40, s47, 255
    s_cbranch_scc1 L_va_w0
    s_bitset0_b32 s46, 0
    s_waitcnt vmcnt(32)
    s_add_u32 s40, s24, 0
    s_addc_u32 s41, s25, 0
    global_load_dwordx4 a[0:3], v28, s[40:41] offset:0 sc1
    global_load_dwordx4 a[4:7], v28, s[40:41] offset:1024 sc1
    global_load_dwordx4 a[8:11], v28, s[40:41] offset:2048 sc1
    global_load_dwordx4 a[12:15], v28, s[40:41] offset:3072 sc1
    s_add_u32 s40, s40, 4096
    s_addc_u32 s41, s41, 0
    global_load_dwordx4 a[16:19], v28, s[40:41] offset:0 sc1
    global_load_dwordx4 a[20:23], v28, s[40:41] offset:1024 sc1
    global_load_dwordx4 a[24:27], v28, s[40:41] offset:2048 sc1
    global_load_dwordx4 a[28:31], v28, s[40:41] offset:3072 sc1
    s_add_u32 s40, s40, 4096
    s_addc_u32 s41, s41, 0
    global_load_dwordx4 a[32:35], v28, s[40:41] offset:0 sc1
    global_load_dwordx4 a[36:39], v28, s[40:41] offset:1024 sc1
    global_load_dwordx4 a[40:43], v28, s[40:41] offset:2048 sc1
    global_load_dwordx4 a[44:47], v28, s[40:41] offset:3072 sc1
    s_add_u32 s40, s40, 4096
    s_addc_u32 s41, s41, 0
    global_load_dwordx4 a[48:51], v28, s[40:41] offset:0 sc1
    global_load_dwordx4 a[52:55], v28, s[40:41] offset:1024 sc1
    global_load_dwordx4 a[56:59], v28, s[40:41] offset:2048 sc1
    global_load_dwordx4 a[60:63], v28, s[40:41] offset:3072 sc1
    s_add_u32 s40, s40, 4096
    s_addc_u32 s41, s41, 0
    global_load_dwordx4 a[64:67], v28, s[40:41] offset:0 sc1
    global_load_dwordx4 a[68:71], v28, s[40:41] offset:1024 sc1
    global_load_dwordx4 a[72:75], v28, s[40:41] offset:2048 sc1
    global_load_dwordx4 a[76:79], v28, s[40:41] offset:3072 sc1
    s_add_u32 s40, s40, 4096
    s_addc_u32 s41, s41, 0
    global_load_dwordx4 a[80:83], v28, s[40:41] offset:0 sc1
    global_load_dwordx4 a[84:87], v28, s[40:41] offset:1024 sc1
    global_load_dwordx4 a[88:91], v28, s[40:41] offset:2048 sc1
    global_load_dwordx4 a[92:95], v28, s[40:41] offset:3072 sc1
    s_add_u32 s40, s40, 4096
    s_addc_u32 s41, s41, 0
    global_load_dwordx4 a[96:99], v28, s[40:41] offset:0 sc1
    global_load_dwordx4 a[100:103], v28, s[40:41] offset:1024 sc1
    global_load_dwordx4 a[104:107], v28, s[40:41] offset:2048 sc1
    global_load_dwordx4 a[108:111], v28, s[40:41] offset:3072 sc1
L_va_w0:
    s_bitcmp0_b32 s46, 1
    s_cbranch_scc1 L_va_w1
    s_and_b32 s40, s47, 65280
    s_cbranch_scc1 L_va_w1
    s_bitset0_b32 s46, 1
    s_waitcnt vmcnt(32)
    s_add_u32 s40, s24, 401408
    s_addc_u32 s41, s25, 0
    global_load_dwordx4 a[112:115], v28, s[40:41] offset:0 sc1
    global_load_dwordx4 a[116:119], v28, s[40:41] offset:1024 sc1
    global_load_dwordx4 a[120:123], v28, s[40:41] offset:2048 sc1
    global_load_dwordx4 a[124:127], v28, s[40:41] offset:3072 sc1
    s_add_u32 s40, s40, 4096
    s_addc_u32 s41, s41, 0
    global_load_dwordx4 a[128:131], v28, s[40:41] offset:0 sc1
    global_load_dwordx4 a[132:135], v28, s[40:41] offset:1024 sc1
    global_load_dwordx4 a[136:139], v28, s[40:41] offset:2048 sc1
    global_load_dwordx4 a[140:143], v28, s[40:41] offset:3072 sc1
    s_add_u32 s40, s40, 4096
    s_addc_u32 s41, s41, 0
    global_load_dwordx4 a[144:147], v28, s[40:41] offset:0 sc1
    global_load_dwordx4 a[148:151], v28, s[40:41] offset:1024 sc1
    global_load_dwordx4 a[152:155], v28, s[40:41] offset:2048 sc1
    global_load_dwordx4 a[156:159], v28, s[40:41] offset:3072 sc1
    s_add_u32 s40, s40, 4096
    s_addc_u32 s41, s41, 0
    global_load_dwordx4 a[160:163], v28, s[40:41] offset:0 sc1
    global_load_dwordx4 a[164:167], v28, s[40:41] offset:1024 sc1
    global_load_dwordx4 a[168:171], v28, s[40:41] offset:2048 sc1
    global_load_dwordx4 a[172:175], v28, s[40:41] offset:3072 sc1
    s_add_u32 s40, s40, 4096
    s_addc_u32 s41, s41, 0
    global_load_dwordx4 a[176:179], v28, s[40:41] offset:0 sc1
    global_load_dwordx4 a[180:183], v28, s[40:41] offset:1024 sc1
    global_load_dwordx4 a[184:187], v28, s[40:41] offset:2048 sc1
    global_load_dwordx4 a[188:191], v28, s[40:41] offset:3072 sc1
    s_add_u32 s40, s40, 4096
    s_addc_u32 s41, s41, 0
    global_load_dwordx4 a[192:195], v28, s[40:41] offset:0 sc1
    global_load_dwordx4 a[196:199], v28, s[40:41] offset:1024 sc1
    global_load_dwordx4 a[200:203], v28, s[40:41] offset:2048 sc1
    global_load_dwordx4 a[204:207], v28, s[40:41] offset:3072 sc1
    s_add_u32 s40, s40, 4096
    s_addc_u32 s41, s41, 0
    global_load_dwordx4 a[208:211], v28, s[40:41] offset:0 sc1
    global_load_dwordx4 a[212:215], v28, s[40:41] offset:1024 sc1
    global_load_dwordx4 a[216:219], v28, s[40:41] offset:2048 sc1
    global_load_dwordx4 a[220:223], v28, s[40:41] offset:3072 sc1
L_va_w1:
    s_bitcmp0_b32 s46, 2
    s_cbranch_scc1 L_va_w2
    s_and_b32 s40, s47, 16711680
    s_cbranch_scc1 L_va_w2
    s_bitset0_b32 s46, 2
    s_waitcnt vmcnt(32)
    s_add_u32 s40, s24, 802816
    s_addc_u32 s41, s25, 0
    global_load_dwordx4 a[224:227], v28, s[40:41] offset:0 sc1
    global_load_dwordx4 a[228:231], v28, s[40:41] offset:1024 sc1
    global_load_dwordx4 a[232:235], v28, s[40:41] offset:2048 sc1
    global_load_dwordx4 a[236:239], v28, s[40:41] offset:3072 sc1
    s_add_u32 s40, s40, 4096
    s_addc_u32 s41, s41, 0
    global_load_dwordx4 a[240:243], v28, s[40:41] offset:0 sc1
    global_load_dwordx4 a[244:247], v28, s[40:41] offset:1024 sc1
    global_load_dwordx4 a[248:251], v28, s[40:41] offset:2048 sc1
    global_load_dwordx4 a[252:255], v28, s[40:41] offset:3072 sc1
    s_add_u32 s40, s40, 4096
    s_addc_u32 s41, s41, 0
    global_load_dwordx4 v[176:179], v28, s[40:41] offset:0 sc1
    global_load_dwordx4 v[180:183], v28, s[40:41] offset:1024 sc1
    global_load_dwordx4 v[184:187], v28, s[40:41] offset:2048 sc1
    global_load_dwordx4 v[188:191], v28, s[40:41] offset:3072 sc1
    s_add_u32 s40, s40, 4096
    s_addc_u32 s41, s41, 0
    global_load_dwordx4 v[192:195], v28, s[40:41] offset:0 sc1
    global_load_dwordx4 v[196:199], v28, s[40:41] offset:1024 sc1
    global_load_dwordx4 v[200:203], v28, s[40:41] offset:2048 sc1
    global_load_dwordx4 v[204:207], v28, s[40:41] offset:3072 sc1
    s_add_u32 s40, s40, 4096
    s_addc_u32 s41, s41, 0
    global_load_dwordx4 v[208:211], v28, s[40:41] offset:0 sc1
    global_load_dwordx4 v[212:215], v28, s[40:41] offset:1024 sc1
    global_load_dwordx4 v[216:219], v28, s[40:41] offset:2048 sc1
    global_load_dwordx4 v[220:223], v28, s[40:41] offset:3072 sc1
    s_add_u32 s40, s40, 4096
    s_addc_u32 s41, s41, 0
    global_load_dwordx4 v[224:227], v28, s[40:41] offset:0 sc1
    global_load_dwordx4 v[228:231], v28, s[40:41] offset:1024 sc1
    global_load_dwordx4 v[232:235], v28, s[40:41] offset:2048 sc1
    global_load_dwordx4 v[236:239], v28, s[40:41] offset:3072 sc1
    s_add_u32 s40, s40, 4096
    s_addc_u32 s41, s41, 0
    global_load_dwordx4 v[240:243], v28, s[40:41] offset:0 sc1
    global_load_dwordx4 v[244:247], v28, s[40:41] offset:1024 sc1
    global_load_dwordx4 v[248:251], v28, s[40:41] offset:2048 sc1
    global_load_dwordx4 v[252:255], v28, s[40:41] offset:3072 sc1
L_va_w2:
    s_cmp_lg_u32 s46, 0
    s_cbranch_scc1 L_va_w
    s_waitcnt vmcnt(0)
    ds_write_b128 v6, v[100:103] offset:10240
    ds_write_b128 v6, v[104:107] offset:11264
    ds_write_b128 v6, v[108:111] offset:12288
    ds_write_b128 v6, v[112:115] offset:13312
    ds_write_b128 v6, v[116:119] offset:14336
    ds_write_b128 v6, v[120:123] offset:15360
    ds_write_b128 v6, v[124:127] offset:16384
    ds_write_b128 v6, v[128:131] offset:17408
    ds_write_b128 v6, v[132:135] offset:18432
    ds_write_b128 v6, v[136:139] offset:19456
    ds_write_b128 v6, v[140:143] offset:20480
    ds_write_b128 v6, v[144:147] offset:21504
    ds_write_b128 v6, v[148:151] offset:22528
    ds_write_b128 v6, v[152:155] offset:23552
    ds_write_b128 v6, v[156:159] offset:24576
    ds_write_b128 v6, v[160:163] offset:25600
    ds_write_b128 v6, v[164:167] offset:26624
    ds_write_b128 v6, v[168:171] offset:27648
    s_waitcnt lgkmcnt(0)
    v_mov_b32 v136, v60
    v_mov_b32 v137, v61
    v_mov_b32 v138, v62
    v_mov_b32 v139, v63
    v_mov_b32 v140, v64
    v_mov_b32 v141, v65
    v_mov_b32 v142, v66
    v_mov_b32 v143, v67
    v_mov_b32 v144, v68
    v_mov_b32 v145, v69
    v_mov_b32 v146, v70
    v_mov_b32 v147, v71
    v_mov_b32 v148, v72
    v_mov_b32 v149, v73
    v_mov_b32 v150, v74
    v_mov_b32 v151, v75
    v_mov_b32 v152, v76
    v_mov_b32 v153, v77
    v_mov_b32 v154, v78
    v_mov_b32 v155, v79
    v_mov_b32 v156, v80
    v_mov_b32 v157, v81
    v_mov_b32 v158, v82
    v_mov_b32 v159, v83
    v_mov_b32 v160, v84
    v_mov_b32 v161, v85
    v_mov_b32 v162, v86
    v_mov_b32 v163, v87
    v_mov_b32 v164, v88
    v_mov_b32 v165, v89
    v_mov_b32 v166, v90
    v_mov_b32 v167, v91
    v_mov_b32 v168, v92
    v_mov_b32 v169, v93
    v_mov_b32 v170, v94
    v_mov_b32 v171, v95
    v_mov_b32 v172, v96
    v_mov_b32 v173, v97
    v_mov_b32 v174, v98
    v_mov_b32 v175, v99
    v_min_u32 v32, 30, v0
L_va_xc:
    global_load_ubyte v33, v32, s[96:97] offset:224 sc1
    s_add_u32 s6, s6, 1
    s_cmp_gt_u32 s6, 2097152
    s_cbranch_scc1 L_bail
    s_waitcnt vmcnt(0)
    v_cmp_eq_u32 vcc, 0, v33
    s_cbranch_vccnz L_va_xc
L_va_xk:
    v_cmp_ne_u32 vcc, s75, v33
    s_cmp_eq_u64 vcc, 0
    s_cselect_b32 s64, 1, 0
    s_add_u32 s16, s8, 43237376
    s_addc_u32 s17, s9, 0
    s_add_u32 s68, s8, 43962368
    s_addc_u32 s69, s9, 0
    s_add_u32 s20, s8, 43223040
    s_addc_u32 s21, s9, 0
    s_mul_i32 s40, s3, 32768
    s_add_u32 s18, s8, 12845056
    s_addc_u32 s19, s9, 0
    s_add_u32 s18, s18, s40
    s_addc_u32 s19, s19, 0
    s_waitcnt vmcnt(0) lgkmcnt(0)
L_va_f0:
    global_load_dword v16, v17, s[68:69] sc1
    s_add_u32 s6, s6, 1
    s_cmp_gt_u32 s6, 2097152
    s_cbranch_scc1 L_bail
    s_waitcnt vmcnt(0)
    v_cmp_eq_u32 vcc, 0, v16
    s_cbranch_vccnz L_va_f0
L_va_f0_ok:
    s_add_u32 s68, s68, 256
    s_addc_u32 s69, s69, 0
    v_mov_b32 v116, 0
    v_mov_b32 v117, 0
    v_mov_b32 v118, 0
    v_mov_b32 v119, 0
    v_mov_b32 v120, 0
    v_mov_b32 v121, 0
    v_mov_b32 v122, 0
    v_mov_b32 v123, 0
    global_load_dwordx4 v[60:63], v7, s[18:19] offset:0 sc1
    global_load_dwordx4 v[76:79], v7, s[18:19] offset:1024 sc1
    global_load_dwordx4 v[64:67], v7, s[18:19] offset:2048 sc1
    v_mov_b32 v92, 0
    v_mov_b32 v93, 0
    v_mov_b32 v94, 0
    v_mov_b32 v95, 0
    v_mov_b32 v96, 0
    v_mov_b32 v97, 0
    v_mov_b32 v98, 0
    v_mov_b32 v99, 0
    v_mov_b32 v100, 0
    v_mov_b32 v101, 0
    v_mov_b32 v102, 0
    v_mov_b32 v103, 0
    v_mov_b32 v104, 0
    v_mov_b32 v105, 0
    v_mov_b32 v106, 0
    v_mov_b32 v107, 0
    ds_read_b128 v[36:39], v6 offset:10240
    ds_read_b128 v[40:43], v6 offset:11264
    ds_read_b128 v[44:47], v6 offset:12288
    ds_read_b128 v[48:51], v6 offset:13312
    s_cmp_eq_u32 s64, 0
    s_cbranch_scc1 L_vb_step
.p2align 6, , 63
    s_nop 0
    s_nop 0
    s_nop 0
    s_nop 0
L_va_step:
L_va_mp:
    s_mov_b32 m0, s36
L_va_mpl:
    global_load_dword v134, v4, s[14:15] sc1
    global_load_lds_dwordx4 v2, s[14:15] sc1
    s_mov_b64 exec, s[38:39]
    global_load_lds_dwordx4 v2, s[14:15] offset:1024 sc1
    s_mov_b64 exec, -1
    s_add_u32 s6, s6, 1
    s_cmp_gt_u32 s6, 2097152
    s_cbranch_scc1 L_bail
    s_waitcnt vmcnt(2)
    v_cmp_eq_u32 vcc, s7, v134
    s_cbranch_vccnz L_va_mpl
    s_waitcnt vmcnt(0) lgkmcnt(0)
    s_barrier
    ds_read_b128 v[20:23], v5 offset:0
    ds_read_b128 v[24:27], v5 offset:512
    ds_read_b128 v[28:31], v5 offset:1024
    s_add_u32 s40, s14, 24576
    s_addc_u32 s41, s15, 0
    global_store_short v14, v11, s[40:41]
    s_waitcnt lgkmcnt(2)
    v_smfmac_f32_16x16x64_bf16 v[92:95], v[20:23], a[0:7], v1
    v_smfmac_f32_16x16x64_bf16 v[96:99], v[20:23], a[112:119], v1
    ds_read_b128 v[32:35], v5 offset:1536
    v_smfmac_f32_16x16x64_bf16 v[100:103], v[20:23], a[224:231], v1
    global_load_dwordx4 v[80:83], v7, s[18:19] offset:3072 sc1
    v_mov_b32 v3, v20
    v_smfmac_f32_16x16x64_bf16 v[104:107], v[20:23], v[136:143], v1
    s_waitcnt lgkmcnt(2)
    v_smfmac_f32_16x16x64_bf16 v[92:95], v[24:27], a[8:15], v1
    v_smfmac_f32_16x16x64_bf16 v[96:99], v[24:27], a[120:127], v1
    ds_read_b128 v[20:23], v5 offset:2048
    v_smfmac_f32_16x16x64_bf16 v[100:103], v[24:27], a[232:239], v1
    global_load_dwordx4 v[68:71], v8, s[18:19] offset:0 sc1
    v_max_u32 v3, v3, v24
    v_smfmac_f32_16x16x64_bf16 v[104:107], v[24:27], v[144:151], v1
    s_waitcnt lgkmcnt(2)
    v_smfmac_f32_16x16x64_bf16 v[92:95], v[28:31], a[16:23], v1
    v_smfmac_f32_16x16x64_bf16 v[96:99], v[28:31], a[128:135], v1
    ds_read_b128 v[24:27], v5 offset:2560
    v_smfmac_f32_16x16x64_bf16 v[100:103], v[28:31], a[240:247], v1
    global_load_dwordx4 v[84:87], v8, s[18:19] offset:1024 sc1
    v_max_u32 v3, v3, v28
    v_smfmac_f32_16x16x64_bf16 v[104:107], v[28:31], v[152:159], v1
    s_waitcnt lgkmcnt(2)
    v_smfmac_f32_16x16x64_bf16 v[92:95], v[32:35], a[24:31], v1
    v_smfmac_f32_16x16x64_bf16 v[96:99], v[32:35], a[136:143], v1
    ds_read_b128 v[28:31], v5 offset:3072
    v_smfmac_f32_16x16x64_bf16 v[100:103], v[32:35], a[248:255], v1
    global_load_dwordx4 v[72:75], v8, s[18:19] offset:2048 sc1
    v_max_u32 v3, v3, v32
    v_smfmac_f32_16x16x64_bf16 v[104:107], v[32:35], v[160:167], v1
    s_waitcnt lgkmcnt(2)
    v_smfmac_f32_16x16x64_bf16 v[92:95], v[20:23], a[32:39], v1
    v_smfmac_f32_16x16x64_bf16 v[96:99], v[20:23], a[144:151], v1
    ds_read_b128 v[32:35], v5 offset:3584
    v_smfmac_f32_16x16x64_bf16 v[100:103], v[20:23], v[176:183], v1
    global_load_dwordx4 v[88:91], v8, s[18:19] offset:3072 sc1
    v_max_u32 v3, v3, v20
    v_smfmac_f32_16x16x64_bf16 v[104:107], v[20:23], v[168:175], v1
    s_waitcnt lgkmcnt(2)
    v_smfmac_f32_16x16x64_bf16 v[92:95], v[24:27], a[40:47], v1
    ds_read_b128 v[52:55], v6 offset:14336
    ds_read_b128 v[56:59], v6 offset:15360
    v_smfmac_f32_16x16x64_bf16 v[96:99], v[24:27], a[152:159], v1
    ds_read_b128 v[20:23], v5 offset:4096
    v_smfmac_f32_16x16x64_bf16 v[100:103], v[24:27], v[184:191], v1
    global_load_dword v16, v17, s[68:69] sc1
    v_max_u32 v3, v3, v24
    v_smfmac_f32_16x16x64_bf16 v[104:107], v[24:27], v[36:43], v1
    s_waitcnt lgkmcnt(4)
    v_smfmac_f32_16x16x64_bf16 v[92:95], v[28:31], a[48:55], v1
    ds_read_b128 v[36:39], v6 offset:16384
    ds_read_b128 v[40:43], v6 offset:17408
    v_smfmac_f32_16x16x64_bf16 v[96:99], v[28:31], a[160:167], v1
    ds_read_b128 v[24:27], v5 offset:4608
    v_smfmac_f32_16x16x64_bf16 v[100:103], v[28:31], v[192:199], v1
    v_max_u32 v3, v3, v28
    v_smfmac_f32_16x16x64_bf16 v[104:107], v[28:31], v[44:51], v1
    s_waitcnt lgkmcnt(6)
    v_smfmac_f32_16x16x64_bf16 v[92:95], v[32:35], a[56:63], v1
    ds_read_b128 v[44:47], v6 offset:18432
    ds_read_b128 v[48:51], v6 offset:19456
    v_smfmac_f32_16x16x64_bf16 v[96:99], v[32:35], a[168:175], v1
    ds_read_b128 v[28:31], v5 offset:5120
    v_smfmac_f32_16x16x64_bf16 v[100:103], v[32:35], v[200:207], v1
    v_max_u32 v3, v3, v32
    s_waitcnt lgkmcnt(7)
    v_smfmac_f32_16x16x64_bf16 v[104:107], v[32:35], v[52:59], v1
    s_waitcnt lgkmcnt(6)
    v_smfmac_f32_16x16x64_bf16 v[92:95], v[20:23], a[64:71], v1
    ds_read_b128 v[52:55], v6 offset:20480
    ds_read_b128 v[56:59], v6 offset:21504
    v_smfmac_f32_16x16x64_bf16 v[96:99], v[20:23], a[176:183], v1
    ds_read_b128 v[32:35], v5 offset:5632
    v_smfmac_f32_16x16x64_bf16 v[100:103], v[20:23], v[208:215], v1
    v_max_u32 v3, v3, v20
    s_waitcnt lgkmcnt(7)
    v_smfmac_f32_16x16x64_bf16 v[104:107], v[20:23], v[36:43], v1
    s_waitcnt lgkmcnt(6)
    v_smfmac_f32_16x16x64_bf16 v[92:95], v[24:27], a[72:79], v1
    ds_read_b128 v[36:39], v6 offset:22528
    ds_read_b128 v[40:43], v6 offset:23552
    v_smfmac_f32_16x16x64_bf16 v[96:99], v[24:27], a[184:191], v1
    ds_read_b128 v[20:23], v5 offset:6144
    v_smfmac_f32_16x16x64_bf16 v[100:103], v[24:27], v[216:223], v1
    v_max_u32 v3, v3, v24
    s_waitcnt lgkmcnt(7)
    v_smfmac_f32_16x16x64_bf16 v[104:107], v[24:27], v[44:51], v1
    s_waitcnt lgkmcnt(6)
    v_smfmac_f32_16x16x64_bf16 v[92:95], v[28:31], a[80:87], v1
    ds_read_b128 v[44:47], v6 offset:24576
    ds_read_b128 v[48:51], v6 offset:25600
    v_smfmac_f32_16x16x64_bf16 v[96:99], v[28:31], a[192:199], v1
    ds_read_b128 v[24:27], v5 offset:6656
    v_smfmac_f32_16x16x64_bf16 v[100:103], v[28:31], v[224:231], v1
    v_max_u32 v3, v3, v28
    s_waitcnt lgkmcnt(7)
    v_smfmac_f32_16x16x64_bf16 v[104:107], v[28:31], v[52:59], v1
    s_waitcnt lgkmcnt(6)
    v_smfmac_f32_16x16x64_bf16 v[92:95], v[32:35], a[88:95], v1
    ds_read_b128 v[52:55], v6 offset:26624
    ds_read_b128 v[56:59], v6 offset:27648
    v_smfmac_f32_16x16x64_bf16 v[96:99], v[32:35], a[200:207], v1
    v_smfmac_f32_16x16x64_bf16 v[100:103], v[32:35], v[232:239], v1
    v_max_u32 v3, v3, v32
    s_waitcnt lgkmcnt(6)
    v_smfmac_f32_16x16x64_bf16 v[104:107], v[32:35], v[36:43], v1
    s_waitcnt lgkmcnt(5)
    v_smfmac_f32_16x16x64_bf16 v[92:95], v[20:23], a[96:103], v1
    v_smfmac_f32_16x16x64_bf16 v[96:99], v[20:23], a[208:215], v1
    v_smfmac_f32_16x16x64_bf16 v[100:103], v[20:23], v[240:247], v1
    v_max_u32 v3, v3, v20
    s_waitcnt lgkmcnt(3)
    v_smfmac_f32_16x16x64_bf16 v[104:107], v[20:23], v[44:51], v1
    s_waitcnt lgkmcnt(2)
    v_smfmac_f32_16x16x64_bf16 v[92:95], v[24:27], a[104:111], v1
    v_smfmac_f32_16x16x64_bf16 v[96:99], v[24:27], a[216:223], v1
    v_smfmac_f32_16x16x64_bf16 v[100:103], v[24:27], v[248:255], v1
    v_max_u32 v3, v3, v24
    s_waitcnt lgkmcnt(0)
    v_smfmac_f32_16x16x64_bf16 v[104:107], v[24:27], v[52:59], v1
    v_cmp_eq_u32 vcc, s7, v3
    s_cbranch_vccnz L_va_redo
    s_cmp_lt_u32 s5, 60
    s_cbranch_scc1 L_va_nr
    s_cmp_eq_u32 s5, 63
    s_cbranch_scc1 L_va_fin
    v_cmp_eq_u32 vcc, 0, v135
    s_cbranch_vccz L_va_nr
    s_add_u32 s40, s8, 43978560
    s_addc_u32 s41, s9, 0
L_va_ex:
    global_load_dword v135, v17, s[40:41] sc1
    s_add_u32 s6, s6, 1
    s_cmp_gt_u32 s6, 2097152
    s_cbranch_scc1 L_bail
    s_waitcnt vmcnt(0)
    v_cmp_eq_u32 vcc, 0, v135
    s_cbranch_vccnz L_va_ex
L_va_nr:
    v_cvt_pk_bf16_f32 v108, v92, v93
    v_cvt_pk_bf16_f32 v112, v96, v97
    v_cvt_pk_bf16_f32 v109, v100, v101
    v_cvt_pk_bf16_f32 v113, v104, v105
    v_cvt_pk_bf16_f32 v110, v94, v95
    v_cvt_pk_bf16_f32 v114, v98, v99
    v_cvt_pk_bf16_f32 v111, v102, v103
    v_cvt_pk_bf16_f32 v115, v106, v107
    v_permlane32_swap_b32 v108, v112
    v_permlane32_swap_b32 v109, v113
    v_permlane32_swap_b32 v110, v114
    v_permlane32_swap_b32 v111, v115
L_va_pp:
    global_load_dwordx4 v[124:127], v10, s[16:17] sc1
    global_load_dwordx4 v[128:131], v10, s[16:17] offset:1024 sc1
    global_load_dword v132, v9, s[16:17] offset:2048 sc1
    global_load_dword v133, v9, s[16:17] offset:2304 sc1
    s_add_u32 s6, s6, 1
    s_cmp_gt_u32 s6, 2097152
    s_cbranch_scc1 L_bail
    v_mov_b32 v116, 0
    v_mov_b32 v117, 0
    v_mov_b32 v118, 0
    v_mov_b32 v119, 0
    v_mov_b32 v120, 0
    v_mov_b32 v121, 0
    v_mov_b32 v122, 0
    v_mov_b32 v123, 0
    s_waitcnt vmcnt(3)
    v_smfmac_f32_16x16x64_bf16 v[116:119], v[124:127], v[60:67], v1
    v_smfmac_f32_16x16x64_bf16 v[120:123], v[124:127], v[76:83], v1
    s_waitcnt vmcnt(0)
    v_max3_u32 v3, v124, v128, v132
    v_smfmac_f32_16x16x64_bf16 v[116:119], v[128:131], v[68:75], v1
    v_max_u32 v3, v3, v133
    v_smfmac_f32_16x16x64_bf16 v[120:123], v[128:131], v[84:91], v1
    v_cmp_eq_u32 vcc, s7, v3
    v_smfmac_f32_16x16x32_bf16 v[116:119], v[132:133], v[108:111], v1
    v_smfmac_f32_16x16x32_bf16 v[120:123], v[132:133], v[112:115], v1
    s_cbranch_vccnz L_va_pp
    s_nop 6
    v_permlane32_swap_b32 v116, v120
    v_permlane32_swap_b32 v117, v121
    v_permlane32_swap_b32 v118, v122
    v_permlane32_swap_b32 v119, v123
    v_pk_add_f32 v[116:117], v[116:117], v[120:121]
    v_pk_add_f32 v[118:119], v[118:119], v[122:123]
    ds_write_b128 v12, v[116:119]
    v_mov_b32 v92, 0
    v_mov_b32 v93, 0
    v_mov_b32 v94, 0
    v_mov_b32 v95, 0
    s_waitcnt lgkmcnt(0)
    s_barrier
    ds_read_b32 v24, v13 offset:0
    ds_read_b32 v25, v13 offset:1536
    ds_read_b32 v26, v13 offset:3072
    ds_read_b32 v27, v13 offset:4608
    v_mov_b32 v96, 0
    s_add_u32 s14, s14, 8192
    s_addc_u32 s15, s15, 0
    s_add_u32 s16, s16, 10240
    s_addc_u32 s17, s17, 0
    s_waitcnt lgkmcnt(0)
    v_pk_add_f32 v[24:25], v[24:25], v[26:27]
    v_add_f32 v24, v24, v25
    v_cvt_pk_bf16_f32 v15, v24, v24
    global_store_short v14, v15, s[14:15]
    s_add_u32 s5, s5, 1
    v_cmp_eq_u32 vcc, 0, v16
    s_cbranch_vccz L_va_f1_ok
L_va_f1:
    global_load_dword v16, v17, s[68:69] sc1
    s_add_u32 s6, s6, 1
    s_cmp_gt_u32 s6, 2097152
    s_cbranch_scc1 L_bail
    s_waitcnt vmcnt(0)
    v_cmp_eq_u32 vcc, 0, v16
    s_cbranch_vccnz L_va_f1
L_va_f1_ok:
    s_add_u32 s18, s18, 458752
    s_addc_u32 s19, s19, 0
    s_add_u32 s68, s68, 256
    s_addc_u32 s69, s69, 0
    global_load_dwordx4 v[60:63], v7, s[18:19] offset:0 sc1
    global_load_dwordx4 v[76:79], v7, s[18:19] offset:1024 sc1
    global_load_dwordx4 v[64:67], v7, s[18:19] offset:2048 sc1
    s_cmp_lt_u32 s5, 60
    s_cbranch_scc1 L_va_nd
    s_cmp_eq_u32 s5, 63
    s_cbranch_scc1 L_va_fs
    s_add_u32 s40, s8, 43978560
    s_addc_u32 s41, s9, 0
    global_load_dword v135, v17, s[40:41] sc1
    s_cmp_lg_u32 s5, 62
    s_cbranch_scc1 L_va_nd
    global_store_short v14, v15, s[20:21] sc1
    s_branch L_va_nd
L_va_fs:
    v_min_u32 v124, 38, v0
    v_cmp_lt_u32 vcc, 22, v124
    s_nop 1
    v_cndmask_b32 v125, 0, 9, vcc
    v_add_lshl_u32 v124, v124, v125, 2
    v_min_u32 v117, 152, v124
    s_mul_i32 s40, s4, 10240
    v_lshl_add_u32 v116, v0, 4, s40
    v_and_b32 v124, 15, v0
    v_lshrrev_b32 v125, 4, v0
    s_mul_i32 s40, s4, 4608
    s_add_u32 s40, s40, 16384
    v_mul_u32_u24 v126, 144, v124
    v_lshl_add_u32 v126, v125, 4, v126
    v_add_u32 v118, s40, v126
    v_lshrrev_b32 v124, 3, v0
    v_lshl_add_u32 v124, s4, 3, v124
    v_and_b32 v125, 7, v0
    v_mul_u32_u24 v126, 144, v124
    v_lshl_add_u32 v126, v125, 4, v126
    v_add_u32 v119, 16384, v126
    s_lshl_b32 s40, s3, 6
    v_mul_u32_u24 v126, 896, v124
    v_lshl_add_u32 v126, v125, 3, v126
    v_add_u32 v120, s40, v126
    v_lshlrev_b32 v121, 1, v120
    v_lshlrev_b32 v122, 2, v124
L_va_nd:
    v_mov_b32 v92, 0
    v_mov_b32 v93, 0
    v_mov_b32 v94, 0
    v_mov_b32 v95, 0
    v_mov_b32 v96, 0
    v_mov_b32 v97, 0
    v_mov_b32 v98, 0
    v_mov_b32 v99, 0
    v_mov_b32 v100, 0
    v_mov_b32 v101, 0
    v_mov_b32 v102, 0
    v_mov_b32 v103, 0
    v_mov_b32 v104, 0
    v_mov_b32 v105, 0
    v_mov_b32 v106, 0
    v_mov_b32 v107, 0
    ds_read_b128 v[36:39], v6 offset:10240
    ds_read_b128 v[40:43], v6 offset:11264
    ds_read_b128 v[44:47], v6 offset:12288
    ds_read_b128 v[48:51], v6 offset:13312
    s_branch L_va_step
L_va_redo:
    s_waitcnt vmcnt(0) lgkmcnt(0)
    s_nop 15
    s_barrier
    v_mov_b32 v92, 0
    v_mov_b32 v93, 0
    v_mov_b32 v94, 0
    v_mov_b32 v95, 0
    v_mov_b32 v96, 0
    v_mov_b32 v97, 0
    v_mov_b32 v98, 0
    v_mov_b32 v99, 0
    v_mov_b32 v100, 0
    v_mov_b32 v101, 0
    v_mov_b32 v102, 0
    v_mov_b32 v103, 0
    v_mov_b32 v104, 0
    v_mov_b32 v105, 0
    v_mov_b32 v106, 0
    v_mov_b32 v107, 0
    ds_read_b128 v[36:39], v6 offset:10240
    ds_read_b128 v[40:43], v6 offset:11264
    ds_read_b128 v[44:47], v6 offset:12288
    ds_read_b128 v[48:51], v6 offset:13312
    s_branch L_va_mp
.p2align 6, , 63
    s_nop 0
    s_nop 0
    s_nop 0
    s_nop 0
L_vb_step:
L_vb_mp:
    s_mov_b32 m0, s36
L_vb_mpl:
    global_load_dword v134, v4, s[14:15] sc1
    global_load_lds_dwordx4 v2, s[14:15] sc1
    s_mov_b64 exec, s[38:39]
    global_load_lds_dwordx4 v2, s[14:15] offset:1024 sc1
    s_mov_b64 exec, -1
    s_add_u32 s6, s6, 1
    s_cmp_gt_u32 s6, 2097152
    s_cbranch_scc1 L_bail
    s_waitcnt vmcnt(2)
    v_cmp_eq_u32 vcc, s7, v134
    s_cbranch_vccnz L_vb_mpl
    s_waitcnt vmcnt(0) lgkmcnt(0)
    s_barrier
    ds_read_b128 v[20:23], v5 offset:0
    ds_read_b128 v[24:27], v5 offset:512
    ds_read_b128 v[28:31], v5 offset:1024
    s_add_u32 s40, s14, 24576
    s_addc_u32 s41, s15, 0
    global_store_short v14, v11, s[40:41] sc1
    s_waitcnt lgkmcnt(2)
    v_smfmac_f32_16x16x64_bf16 v[92:95], v[20:23], a[0:7], v1
    v_smfmac_f32_16x16x64_bf16 v[96:99], v[20:23], a[112:119], v1
    ds_read_b128 v[32:35], v5 offset:1536
    v_smfmac_f32_16x16x64_bf16 v[100:103], v[20:23], a[224:231], v1
    global_load_dwordx4 v[80:83], v7, s[18:19] offset:3072 sc1
    v_mov_b32 v3, v20
    v_smfmac_f32_16x16x64_bf16 v[104:107], v[20:23], v[136:143], v1
    s_waitcnt lgkmcnt(2)
    v_smfmac_f32_16x16x64_bf16 v[92:95], v[24:27], a[8:15], v1
    v_smfmac_f32_16x16x64_bf16 v[96:99], v[24:27], a[120:127], v1
    ds_read_b128 v[20:23], v5 offset:2048
    v_smfmac_f32_16x16x64_bf16 v[100:103], v[24:27], a[232:239], v1
    global_load_dwordx4 v[68:71], v8, s[18:19] offset:0 sc1
    v_max_u32 v3, v3, v24
    v_smfmac_f32_16x16x64_bf16 v[104:107], v[24:27], v[144:151], v1
    s_waitcnt lgkmcnt(2)
    v_smfmac_f32_16x16x64_bf16 v[92:95], v[28:31], a[16:23], v1
    v_smfmac_f32_16x16x64_bf16 v[96:99], v[28:31], a[128:135], v1
    ds_read_b128 v[24:27], v5 offset:2560
    v_smfmac_f32_16x16x64_bf16 v[100:103], v[28:31], a[240:247], v1
    global_load_dwordx4 v[84:87], v8, s[18:19] offset:1024 sc1
    v_max_u32 v3, v3, v28
    v_smfmac_f32_16x16x64_bf16 v[104:107], v[28:31], v[152:159], v1
    s_waitcnt lgkmcnt(2)
    v_smfmac_f32_16x16x64_bf16 v[92:95], v[32:35], a[24:31], v1
    v_smfmac_f32_16x16x64_bf16 v[96:99], v[32:35], a[136:143], v1
    ds_read_b128 v[28:31], v5 offset:3072
    v_smfmac_f32_16x16x64_bf16 v[100:103], v[32:35], a[248:255], v1
    global_load_dwordx4 v[72:75], v8, s[18:19] offset:2048 sc1
    v_max_u32 v3, v3, v32
    v_smfmac_f32_16x16x64_bf16 v[104:107], v[32:35], v[160:167], v1
    s_waitcnt lgkmcnt(2)
    v_smfmac_f32_16x16x64_bf16 v[92:95], v[20:23], a[32:39], v1
    v_smfmac_f32_16x16x64_bf16 v[96:99], v[20:23], a[144:151], v1
    ds_read_b128 v[32:35], v5 offset:3584
    v_smfmac_f32_16x16x64_bf16 v[100:103], v[20:23], v[176:183], v1
    global_load_dwordx4 v[88:91], v8, s[18:19] offset:3072 sc1
    v_max_u32 v3, v3, v20
    v_smfmac_f32_16x16x64_bf16 v[104:107], v[20:23], v[168:175], v1
    s_waitcnt lgkmcnt(2)
    v_smfmac_f32_16x16x64_bf16 v[92:95], v[24:27], a[40:47], v1
    ds_read_b128 v[52:55], v6 offset:14336
    ds_read_b128 v[56:59], v6 offset:15360
    v_smfmac_f32_16x16x64_bf16 v[96:99], v[24:27], a[152:159], v1
    ds_read_b128 v[20:23], v5 offset:4096
    v_smfmac_f32_16x16x64_bf16 v[100:103], v[24:27], v[184:191], v1
    global_load_dword v16, v17, s[68:69] sc1
    v_max_u32 v3, v3, v24
    v_smfmac_f32_16x16x64_bf16 v[104:107], v[24:27], v[36:43], v1
    s_waitcnt lgkmcnt(4)
    v_smfmac_f32_16x16x64_bf16 v[92:95], v[28:31], a[48:55], v1
    ds_read_b128 v[36:39], v6 offset:16384
    ds_read_b128 v[40:43], v6 offset:17408
    v_smfmac_f32_16x16x64_bf16 v[96:99], v[28:31], a[160:167], v1
    ds_read_b128 v[24:27], v5 offset:4608
    v_smfmac_f32_16x16x64_bf16 v[100:103], v[28:31], v[192:199], v1
    v_max_u32 v3, v3, v28
    v_smfmac_f32_16x16x64_bf16 v[104:107], v[28:31], v[44:51], v1
    s_waitcnt lgkmcnt(6)
    v_smfmac_f32_16x16x64_bf16 v[92:95], v[32:35], a[56:63], v1
    ds_read_b128 v[44:47], v6 offset:18432
    ds_read_b128 v[48:51], v6 offset:19456
    v_smfmac_f32_16x16x64_bf16 v[96:99], v[32:35], a[168:175], v1
    ds_read_b128 v[28:31], v5 offset:5120
    v_smfmac_f32_16x16x64_bf16 v[100:103], v[32:35], v[200:207], v1
    v_max_u32 v3, v3, v32
    s_waitcnt lgkmcnt(7)
    v_smfmac_f32_16x16x64_bf16 v[104:107], v[32:35], v[52:59], v1
    s_waitcnt lgkmcnt(6)
    v_smfmac_f32_16x16x64_bf16 v[92:95], v[20:23], a[64:71], v1
    ds_read_b128 v[52:55], v6 offset:20480
    ds_read_b128 v[56:59], v6 offset:21504
    v_smfmac_f32_16x16x64_bf16 v[96:99], v[20:23], a[176:183], v1
    ds_read_b128 v[32:35], v5 offset:5632
    v_smfmac_f32_16x16x64_bf16 v[100:103], v[20:23], v[208:215], v1
    v_max_u32 v3, v3, v20
    s_waitcnt lgkmcnt(7)
    v_smfmac_f32_16x16x64_bf16 v[104:107], v[20:23], v[36:43], v1
    s_waitcnt lgkmcnt(6)
    v_smfmac_f32_16x16x64_bf16 v[92:95], v[24:27], a[72:79], v1
    ds_read_b128 v[36:39], v6 offset:22528
    ds_read_b128 v[40:43], v6 offset:23552
    v_smfmac_f32_16x16x64_bf16 v[96:99], v[24:27], a[184:191], v1
    ds_read_b128 v[20:23], v5 offset:6144
    v_smfmac_f32_16x16x64_bf16 v[100:103], v[24:27], v[216:223], v1
    v_max_u32 v3, v3, v24
    s_waitcnt lgkmcnt(7)
    v_smfmac_f32_16x16x64_bf16 v[104:107], v[24:27], v[44:51], v1
    s_waitcnt lgkmcnt(6)
    v_smfmac_f32_16x16x64_bf16 v[92:95], v[28:31], a[80:87], v1
    ds_read_b128 v[44:47], v6 offset:24576
    ds_read_b128 v[48:51], v6 offset:25600
    v_smfmac_f32_16x16x64_bf16 v[96:99], v[28:31], a[192:199], v1
    ds_read_b128 v[24:27], v5 offset:6656
    v_smfmac_f32_16x16x64_bf16 v[100:103], v[28:31], v[224:231], v1
    v_max_u32 v3, v3, v28
    s_waitcnt lgkmcnt(7)
    v_smfmac_f32_16x16x64_bf16 v[104:107], v[28:31], v[52:59], v1
    s_waitcnt lgkmcnt(6)
    v_smfmac_f32_16x16x64_bf16 v[92:95], v[32:35], a[88:95], v1
    ds_read_b128 v[52:55], v6 offset:26624
    ds_read_b128 v[56:59], v6 offset:27648
    v_smfmac_f32_16x16x64_bf16 v[96:99], v[32:35], a[200:207], v1
    v_smfmac_f32_16x16x64_bf16 v[100:103], v[32:35], v[232:239], v1
    v_max_u32 v3, v3, v32
    s_waitcnt lgkmcnt(6)
    v_smfmac_f32_16x16x64_bf16 v[104:107], v[32:35], v[36:43], v1
    s_waitcnt lgkmcnt(5)
    v_smfmac_f32_16x16x64_bf16 v[92:95], v[20:23], a[96:103], v1
    v_smfmac_f32_16x16x64_bf16 v[96:99], v[20:23], a[208:215], v1
    v_smfmac_f32_16x16x64_bf16 v[100:103], v[20:23], v[240:247], v1
    v_max_u32 v3, v3, v20
    s_waitcnt lgkmcnt(3)
    v_smfmac_f32_16x16x64_bf16 v[104:107], v[20:23], v[44:51], v1
    s_waitcnt lgkmcnt(2)
    v_smfmac_f32_16x16x64_bf16 v[92:95], v[24:27], a[104:111], v1
    v_smfmac_f32_16x16x64_bf16 v[96:99], v[24:27], a[216:223], v1
    v_smfmac_f32_16x16x64_bf16 v[100:103], v[24:27], v[248:255], v1
    v_max_u32 v3, v3, v24
    s_waitcnt lgkmcnt(0)
    v_smfmac_f32_16x16x64_bf16 v[104:107], v[24:27], v[52:59], v1
    v_cmp_eq_u32 vcc, s7, v3
    s_cbranch_vccnz L_vb_redo
    s_cmp_lt_u32 s5, 60
    s_cbranch_scc1 L_vb_nr
    s_cmp_eq_u32 s5, 63
    s_cbranch_scc1 L_va_fin
    v_cmp_eq_u32 vcc, 0, v135
    s_cbranch_vccz L_vb_nr
    s_add_u32 s40, s8, 43978560
    s_addc_u32 s41, s9, 0
L_vb_ex:
    global_load_dword v135, v17, s[40:41] sc1
    s_add_u32 s6, s6, 1
    s_cmp_gt_u32 s6, 2097152
    s_cbranch_scc1 L_bail
    s_waitcnt vmcnt(0)
    v_cmp_eq_u32 vcc, 0, v135
    s_cbranch_vccnz L_vb_ex
L_vb_nr:
    v_cvt_pk_bf16_f32 v108, v92, v93
    v_cvt_pk_bf16_f32 v112, v96, v97
    v_cvt_pk_bf16_f32 v109, v100, v101
    v_cvt_pk_bf16_f32 v113, v104, v105
    v_cvt_pk_bf16_f32 v110, v94, v95
    v_cvt_pk_bf16_f32 v114, v98, v99
    v_cvt_pk_bf16_f32 v111, v102, v103
    v_cvt_pk_bf16_f32 v115, v106, v107
    v_permlane32_swap_b32 v108, v112
    v_permlane32_swap_b32 v109, v113
    v_permlane32_swap_b32 v110, v114
    v_permlane32_swap_b32 v111, v115
L_vb_pp:
    global_load_dwordx4 v[124:127], v10, s[16:17] sc1
    global_load_dwordx4 v[128:131], v10, s[16:17] offset:1024 sc1
    global_load_dword v132, v9, s[16:17] offset:2048 sc1
    global_load_dword v133, v9, s[16:17] offset:2304 sc1
    s_add_u32 s6, s6, 1
    s_cmp_gt_u32 s6, 2097152
    s_cbranch_scc1 L_bail
    v_mov_b32 v116, 0
    v_mov_b32 v117, 0
    v_mov_b32 v118, 0
    v_mov_b32 v119, 0
    v_mov_b32 v120, 0
    v_mov_b32 v121, 0
    v_mov_b32 v122, 0
    v_mov_b32 v123, 0
    s_waitcnt vmcnt(3)
    v_smfmac_f32_16x16x64_bf16 v[116:119], v[124:127], v[60:67], v1
    v_smfmac_f32_16x16x64_bf16 v[120:123], v[124:127], v[76:83], v1
    s_waitcnt vmcnt(0)
    v_max3_u32 v3, v124, v128, v132
    v_smfmac_f32_16x16x64_bf16 v[116:119], v[128:131], v[68:75], v1
    v_max_u32 v3, v3, v133
    v_smfmac_f32_16x16x64_bf16 v[120:123], v[128:131], v[84:91], v1
    v_cmp_eq_u32 vcc, s7, v3
    v_smfmac_f32_16x16x32_bf16 v[116:119], v[132:133], v[108:111], v1
    v_smfmac_f32_16x16x32_bf16 v[120:123], v[132:133], v[112:115], v1
    s_cbranch_vccnz L_vb_pp
    s_nop 6
    v_permlane32_swap_b32 v116, v120
    v_permlane32_swap_b32 v117, v121
    v_permlane32_swap_b32 v118, v122
    v_permlane32_swap_b32 v119, v123
    v_pk_add_f32 v[116:117], v[116:117], v[120:121]
    v_pk_add_f32 v[118:119], v[118:119], v[122:123]
    ds_write_b128 v12, v[116:119]
    v_mov_b32 v92, 0
    v_mov_b32 v93, 0
    v_mov_b32 v94, 0
    v_mov_b32 v95, 0
    s_waitcnt lgkmcnt(0)
    s_barrier
    ds_read_b32 v24, v13 offset:0
    ds_read_b32 v25, v13 offset:1536
    ds_read_b32 v26, v13 offset:3072
    ds_read_b32 v27, v13 offset:4608
    v_mov_b32 v96, 0
    s_add_u32 s14, s14, 8192
    s_addc_u32 s15, s15, 0
    s_add_u32 s16, s16, 10240
    s_addc_u32 s17, s17, 0
    s_waitcnt lgkmcnt(0)
    v_pk_add_f32 v[24:25], v[24:25], v[26:27]
    v_add_f32 v24, v24, v25
    v_cvt_pk_bf16_f32 v15, v24, v24
    global_store_short v14, v15, s[14:15] sc1
    s_add_u32 s5, s5, 1
    v_cmp_eq_u32 vcc, 0, v16
    s_cbranch_vccz L_vb_f1_ok
L_vb_f1:
    global_load_dword v16, v17, s[68:69] sc1
    s_add_u32 s6, s6, 1
    s_cmp_gt_u32 s6, 2097152
    s_cbranch_scc1 L_bail
    s_waitcnt vmcnt(0)
    v_cmp_eq_u32 vcc, 0, v16
    s_cbranch_vccnz L_vb_f1
L_vb_f1_ok:
    s_add_u32 s18, s18, 458752
    s_addc_u32 s19, s19, 0
    s_add_u32 s68, s68, 256
    s_addc_u32 s69, s69, 0
    global_load_dwordx4 v[60:63], v7, s[18:19] offset:0 sc1
    global_load_dwordx4 v[76:79], v7, s[18:19] offset:1024 sc1
    global_load_dwordx4 v[64:67], v7, s[18:19] offset:2048 sc1
    s_cmp_lt_u32 s5, 60
    s_cbranch_scc1 L_vb_nd
    s_cmp_eq_u32 s5, 63
    s_cbranch_scc1 L_vb_fs
    s_add_u32 s40, s8, 43978560
    s_addc_u32 s41, s9, 0
    global_load_dword v135, v17, s[40:41] sc1
    s_cmp_lg_u32 s5, 62
    s_cbranch_scc1 L_vb_nd
    global_store_short v14, v15, s[20:21] sc1
    s_branch L_vb_nd
L_vb_fs:
    v_min_u32 v124, 38, v0
    v_cmp_lt_u32 vcc, 22, v124
    s_nop 1
    v_cndmask_b32 v125, 0, 9, vcc
    v_add_lshl_u32 v124, v124, v125, 2
    v_min_u32 v117, 152, v124
    s_mul_i32 s40, s4, 10240
    v_lshl_add_u32 v116, v0, 4, s40
    v_and_b32 v124, 15, v0
    v_lshrrev_b32 v125, 4, v0
    s_mul_i32 s40, s4, 4608
    s_add_u32 s40, s40, 16384
    v_mul_u32_u24 v126, 144, v124
    v_lshl_add_u32 v126, v125, 4, v126
    v_add_u32 v118, s40, v126
    v_lshrrev_b32 v124, 3, v0
    v_lshl_add_u32 v124, s4, 3, v124
    v_and_b32 v125, 7, v0
    v_mul_u32_u24 v126, 144, v124
    v_lshl_add_u32 v126, v125, 4, v126
    v_add_u32 v119, 16384, v126
    s_lshl_b32 s40, s3, 6
    v_mul_u32_u24 v126, 896, v124
    v_lshl_add_u32 v126, v125, 3, v126
    v_add_u32 v120, s40, v126
    v_lshlrev_b32 v121, 1, v120
    v_lshlrev_b32 v122, 2, v124
L_vb_nd:
    v_mov_b32 v92, 0
    v_mov_b32 v93, 0
    v_mov_b32 v94, 0
    v_mov_b32 v95, 0
    v_mov_b32 v96, 0
    v_mov_b32 v97, 0
    v_mov_b32 v98, 0
    v_mov_b32 v99, 0
    v_mov_b32 v100, 0
    v_mov_b32 v101, 0
    v_mov_b32 v102, 0
    v_mov_b32 v103, 0
    v_mov_b32 v104, 0
    v_mov_b32 v105, 0
    v_mov_b32 v106, 0
    v_mov_b32 v107, 0
    ds_read_b128 v[36:39], v6 offset:10240
    ds_read_b128 v[40:43], v6 offset:11264
    ds_read_b128 v[44:47], v6 offset:12288
    ds_read_b128 v[48:51], v6 offset:13312
    s_branch L_vb_step
L_vb_redo:
    s_waitcnt vmcnt(0) lgkmcnt(0)
    s_nop 15
    s_barrier
    v_mov_b32 v92, 0
    v_mov_b32 v93, 0
    v_mov_b32 v94, 0
    v_mov_b32 v95, 0
    v_mov_b32 v96, 0
    v_mov_b32 v97, 0
    v_mov_b32 v98, 0
    v_mov_b32 v99, 0
    v_mov_b32 v100, 0
    v_mov_b32 v101, 0
    v_mov_b32 v102, 0
    v_mov_b32 v103, 0
    v_mov_b32 v104, 0
    v_mov_b32 v105, 0
    v_mov_b32 v106, 0
    v_mov_b32 v107, 0
    ds_read_b128 v[36:39], v6 offset:10240
    ds_read_b128 v[40:43], v6 offset:11264
    ds_read_b128 v[44:47], v6 offset:12288
    ds_read_b128 v[48:51], v6 offset:13312
    s_branch L_vb_mp
L_va_end:
    global_store_short v14, v15, s[20:21] sc1
    s_endpgm
L_va_fin:
    s_barrier
    s_nop 7
    v_cvt_pk_bf16_f32 v108, v92, v93
    v_cvt_pk_bf16_f32 v109, v94, v95
    v_cvt_pk_bf16_f32 v110, v96, v97
    v_cvt_pk_bf16_f32 v111, v98, v99
    v_cvt_pk_bf16_f32 v112, v100, v101
    v_cvt_pk_bf16_f32 v113, v102, v103
    v_cvt_pk_bf16_f32 v114, v104, v105
    v_cvt_pk_bf16_f32 v115, v106, v107
    v_permlane32_swap_b32 v108, v112
    v_permlane32_swap_b32 v109, v113
    v_permlane32_swap_b32 v110, v114
    v_permlane32_swap_b32 v111, v115
    s_nop 0
    v_permlane16_swap_b32 v108, v110
    v_permlane16_swap_b32 v109, v111
    v_permlane16_swap_b32 v112, v114
    v_permlane16_swap_b32 v113, v115
    s_add_u32 s68, s8, 43978560
    s_addc_u32 s69, s9, 0
    s_add_u32 s16, s8, 53972992
    s_addc_u32 s17, s9, 0
    s_add_u32 s42, s16, 4096
    s_addc_u32 s43, s17, 0
    s_add_u32 s46, s16, 8192
    s_addc_u32 s47, s17, 0
    v_mov_b32 v17, v117
L_va_f2:
    global_load_dword v16, v17, s[68:69] sc1
    s_add_u32 s6, s6, 1
    s_cmp_gt_u32 s6, 2097152
    s_cbranch_scc1 L_bail
    s_waitcnt vmcnt(0)
    v_cmp_eq_u32 vcc, 0, v16
    s_cbranch_vccnz L_va_f2
L_va_f2_ok:
    s_add_u32 s40, s8, 62009344
    s_addc_u32 s41, s9, 0
    global_load_dwordx4 v[232:235], v121, s[40:41] sc1
    s_add_u32 s40, s8, 43962240
    s_addc_u32 s41, s9, 0
    global_load_dword v236, v122, s[40:41] sc1
    s_add_u32 s10, s10, 1806336
    s_addc_u32 s11, s11, 0
L_va_fp:
    global_load_dwordx4 v[176:179], v116, s[16:17] offset:0 sc1
    global_load_dwordx4 v[180:183], v116, s[16:17] offset:1024 sc1
    global_load_dwordx4 v[184:187], v116, s[16:17] offset:2048 sc1
    global_load_dwordx4 v[188:191], v116, s[16:17] offset:3072 sc1
    global_load_dwordx4 v[192:195], v116, s[42:43] offset:0 sc1
    global_load_dwordx4 v[196:199], v116, s[42:43] offset:1024 sc1
    global_load_dwordx4 v[200:203], v116, s[42:43] offset:2048 sc1
    global_load_dwordx4 v[204:207], v116, s[42:43] offset:3072 sc1
    global_load_dwordx4 v[208:211], v116, s[46:47] offset:0 sc1
    global_load_dwordx4 v[212:215], v116, s[46:47] offset:1024 sc1
    s_add_u32 s6, s6, 1
    s_cmp_gt_u32 s6, 2097152
    s_cbranch_scc1 L_bail
    s_waitcnt vmcnt(0)
    v_max_u32 v3, v176, v180
    v_max3_u32 v3, v3, v184, v188
    v_max3_u32 v3, v3, v192, v196
    v_max3_u32 v3, v3, v200, v204
    v_max3_u32 v3, v3, v208, v212
    v_cmp_eq_u32 vcc, s7, v3
    v_mfma_f32_16x16x32_bf16 v[216:219], v[60:63], v[176:179], 0
    v_mfma_f32_16x16x32_bf16 v[224:227], v[76:79], v[176:179], 0
    s_cbranch_vccnz L_va_fp
    v_mfma_f32_16x16x32_bf16 v[220:223], v[60:63], v[180:183], 0
    v_mfma_f32_16x16x32_bf16 v[228:231], v[76:79], v[180:183], 0
    v_mfma_f32_16x16x32_bf16 v[216:219], v[64:67], v[184:187], v[216:219]
    v_mfma_f32_16x16x32_bf16 v[224:227], v[80:83], v[184:187], v[224:227]
    v_mfma_f32_16x16x32_bf16 v[220:223], v[64:67], v[188:191], v[220:223]
    v_mfma_f32_16x16x32_bf16 v[228:231], v[80:83], v[188:191], v[228:231]
    v_mfma_f32_16x16x32_bf16 v[216:219], v[68:71], v[192:195], v[216:219]
    v_mfma_f32_16x16x32_bf16 v[224:227], v[84:87], v[192:195], v[224:227]
    v_mfma_f32_16x16x32_bf16 v[220:223], v[68:71], v[196:199], v[220:223]
    v_mfma_f32_16x16x32_bf16 v[228:231], v[84:87], v[196:199], v[228:231]
    v_mfma_f32_16x16x32_bf16 v[216:219], v[72:75], v[200:203], v[216:219]
    v_mfma_f32_16x16x32_bf16 v[224:227], v[88:91], v[200:203], v[224:227]
    v_mfma_f32_16x16x32_bf16 v[220:223], v[72:75], v[204:207], v[220:223]
    v_mfma_f32_16x16x32_bf16 v[228:231], v[88:91], v[204:207], v[228:231]
    v_mfma_f32_16x16x32_bf16 v[216:219], v[108:111], v[208:211], v[216:219]
    v_mfma_f32_16x16x32_bf16 v[224:227], v[112:115], v[208:211], v[224:227]
    v_mfma_f32_16x16x32_bf16 v[220:223], v[108:111], v[212:215], v[220:223]
    v_mfma_f32_16x16x32_bf16 v[228:231], v[112:115], v[212:215], v[228:231]
    ds_write_b128 v118, v[216:219] offset:0
    ds_write_b128 v118, v[224:227] offset:64
    s_nop 1
    ds_write_b128 v118, v[220:223] offset:2304
    s_nop 2
    ds_write_b128 v118, v[228:231] offset:2368
    s_waitcnt lgkmcnt(0)
    s_barrier
    ds_read_b128 v[176:179], v119 offset:0
    ds_read_b128 v[180:183], v119 offset:4608
    ds_read_b128 v[184:187], v119 offset:9216
    ds_read_b128 v[188:191], v119 offset:13824
    s_waitcnt lgkmcnt(0)
    v_pk_add_f32 v[176:177], v[176:177], v[180:181]
    v_pk_add_f32 v[178:179], v[178:179], v[182:183]
    v_pk_add_f32 v[184:185], v[184:185], v[188:189]
    v_pk_add_f32 v[186:187], v[186:187], v[190:191]
    v_pk_add_f32 v[176:177], v[176:177], v[184:185]
    v_pk_add_f32 v[178:179], v[178:179], v[186:187]
    v_fmac_f32 v232, v236, v176
    v_fmac_f32 v233, v236, v177
    v_fmac_f32 v234, v236, v178
    v_fmac_f32 v235, v236, v179
    v_cvt_pk_bf16_f32 v232, v232, v233
    v_cvt_pk_bf16_f32 v233, v234, v235
    global_store_dwordx2 v120, v[232:233], s[10:11] nt
    s_endpgm
L_helper:
    s_load_dwordx2 s[10:11], s[0:1], 0
    s_waitcnt lgkmcnt(0)
    s_mov_b32 s5, 0
    s_mov_b32 s6, 0
    s_mov_b32 s7, 4290772927
    s_mov_b32 s90, 0
    s_getreg_b32 s75, hwreg(HW_REG_XCC_ID, 0, 4)
    s_add_u32 s75, s75, 1
    v_mov_b32 v20, s3
    v_mov_b32 v21, s75
    s_waitcnt vmcnt(0)
    s_barrier
    global_store_byte v20, v21, s[96:97] offset:224 sc1
    s_mul_i32 s36, s4, 1792
    v_lshlrev_b32 v1, 4, v0
    v_add_u32 v1, s36, v1
    s_mov_b32 s38, -1
    s_mov_b32 s39, 0xffff
    s_mul_i32 s40, s4, 7168
    v_min_u32 v2, 55, v0
    v_lshl_add_u32 v2, v2, 7, s40
    s_mul_i32 s40, s4, 2560
    v_min_u32 v3, 19, v0
    v_lshl_add_u32 v3, v3, 7, s40
    v_min_u32 v4, 13, v0
    v_lshl_add_u32 v4, v4, 7, s36
    v_add_u32 v4, 32768, v4
    v_add_u32 v3, 20480, v3
    v_mov_b32 v12, 0
    v_mov_b32 v13, 0
    v_mov_b32 v14, 0
    v_mov_b32 v15, 0
    v_min_u32 v20, 30, v0
L_he_xc:
    global_load_ubyte v21, v20, s[96:97] offset:224 sc1
    s_add_u32 s6, s6, 1
    s_cmp_gt_u32 s6, 2097152
    s_cbranch_scc1 L_bail
    s_waitcnt vmcnt(0)
    v_cmp_eq_u32 vcc, 0, v21
    s_cbranch_vccnz L_he_xc
L_he_xk:
    v_cmp_ne_u32 vcc, s75, v21
    s_cmp_eq_u64 vcc, 0
    s_cselect_b32 s64, 1, 0
    s_add_u32 s40, s8, 43216896
    s_addc_u32 s41, s9, 0
    global_load_dword v21, v3, s[40:41] sc1
    s_add_u32 s40, s8, 43227136
    s_addc_u32 s41, s9, 0
    global_load_dword v21, v3, s[40:41] sc1
    s_add_u32 s40, s8, 42172416
    s_addc_u32 s41, s9, 0
    global_load_dword v21, v4, s[40:41] sc1
    s_add_u32 s40, s8, 42180608
    s_addc_u32 s41, s9, 0
    global_load_dword v21, v4, s[40:41] sc1
    s_add_u32 s40, s8, 42188800
    s_addc_u32 s41, s9, 0
    global_load_dword v21, v4, s[40:41] sc1
    s_add_u32 s40, s8, 42196992
    s_addc_u32 s41, s9, 0
    global_load_dword v21, v4, s[40:41] sc1
    s_cmp_lg_u32 s4, 0
    s_cbranch_scc1 L_he_rb
    s_add_u32 s40, s8, 43982848
    s_addc_u32 s41, s9, 0
    v_lshrrev_b32 v20, 1, v0
    v_and_b32 v21, 1, v0
    v_lshlrev_b32 v21, 4, v21
    v_lshl_add_u32 v20, v20, 7, v21
    s_mov_b32 s42, 0
L_he_rp:
    global_load_dwordx4 v[22:25], v20, s[40:41] sc1
    s_add_u32 s42, s42, 1
    s_cmp_gt_u32 s42, 1048576
    s_cbranch_scc1 L_bail
    s_waitcnt vmcnt(0)
    v_min_u32 v22, v22, v23
    v_min_u32 v22, v22, v24
    v_min_u32 v22, v22, v25
    v_cmp_eq_u32 vcc, 0, v22
    s_cbranch_vccz L_he_rb
    s_sleep 8
    s_branch L_he_rp
L_he_rb:
    s_barrier
    s_mov_b32 s27, 14
    s_add_u32 s14, s8, 42205184
    s_addc_u32 s15, s9, 0
    s_add_u32 s20, s8, 42778624
    s_addc_u32 s21, s9, 0
    s_add_u32 s16, s8, 43237376
    s_addc_u32 s17, s9, 0
    s_add_u32 s10, s10, 28672
    s_addc_u32 s11, s11, 0
    global_load_dword v20, v2, s[10:11]
    global_load_dword v21, v3, s[16:17] sc1
    s_add_u32 s10, s10, 28672
    s_addc_u32 s11, s11, 0
    s_add_u32 s16, s16, 10240
    s_addc_u32 s17, s17, 0
    global_load_dword v20, v2, s[10:11]
    s_add_u32 s10, s10, 28672
    s_addc_u32 s11, s11, 0
L_he_step:
    s_sleep 2
    global_load_dwordx4 v[8:11], v1, s[14:15] sc1
    s_mov_b64 exec, s[38:39]
    global_load_dwordx4 v[12:15], v1, s[14:15] offset:1024 sc1
    s_mov_b64 exec, -1
    s_add_u32 s6, s6, 1
    s_cmp_gt_u32 s6, 2097152
    s_cbranch_scc1 L_bail
    s_waitcnt vmcnt(0)
    v_max3_u32 v16, v8, v9, v10
    v_max3_u32 v16, v16, v11, v12
    v_max3_u32 v16, v16, v13, v14
    v_max_u32 v16, v16, v15
    v_cmp_eq_u32 vcc, s7, v16
    s_cbranch_vccnz L_he_step
    s_add_u32 s5, s5, 1
    global_store_dwordx4 v1, v[8:11], s[20:21] sc1
    s_mov_b64 exec, s[38:39]
    global_store_dwordx4 v1, v[12:15], s[20:21] offset:1024 sc1
    s_mov_b64 exec, -1
    global_load_dword v21, v3, s[16:17] sc1
    global_load_dword v22, v4, s[14:15] sc1
    s_cmp_ge_u32 s5, 62
    s_cbranch_scc1 L_he_nox
    global_load_dword v20, v2, s[10:11]
L_he_nox:
    s_add_u32 s10, s10, 28672
    s_addc_u32 s11, s11, 0
    s_add_u32 s16, s16, 10240
    s_addc_u32 s17, s17, 0
    s_add_u32 s14, s14, 8192
    s_addc_u32 s15, s15, 0
    s_add_u32 s20, s20, 7168
    s_addc_u32 s21, s21, 0
    s_cmp_le_u32 s5, 61
    s_cbranch_scc1 L_he_step
    s_add_u32 s68, s8, 43978560
    s_addc_u32 s69, s9, 0
    v_min_u32 v20, 22, v0
    v_lshlrev_b32 v20, 2, v20
L_he_f:
    s_sleep 2
    global_load_dword v21, v20, s[68:69] sc1
    s_add_u32 s6, s6, 1
    s_cmp_gt_u32 s6, 2097152
    s_cbranch_scc1 L_bail
    s_waitcnt vmcnt(0)
    v_cmp_eq_u32 vcc, 0, v21
    s_cbranch_vccnz L_he_f
    s_mul_i32 s40, s4, 10240
    v_lshl_add_u32 v20, v0, 7, s40
    v_min_u32 v22, 15, v0
    v_lshl_add_u32 v22, v22, 7, s40
    s_mul_i32 s40, s4, 14336
    v_min_u32 v23, 55, v0
    v_lshl_add_u32 v23, v23, 7, s40
    s_add_u32 s40, s8, 53972992
    s_addc_u32 s41, s9, 0
    s_add_u32 s42, s40, 8192
    s_addc_u32 s43, s41, 0
    global_load_dword v21, v20, s[40:41] sc1
    global_load_dword v21, v22, s[42:43] sc1
    s_add_u32 s40, s8, 62009344
    s_addc_u32 s41, s9, 0
    s_add_u32 s42, s40, 7168
    s_addc_u32 s43, s41, 0
    global_load_dword v21, v23, s[40:41] sc1
    global_load_dword v21, v23, s[42:43] sc1
    s_add_u32 s40, s8, 43962240
    s_addc_u32 s41, s9, 0
    v_mov_b32 v20, 0
    global_load_dword v21, v20, s[40:41] sc1
    s_waitcnt vmcnt(0)
    s_endpgm
L_fetch:
    s_mov_b32 s5, 0
    s_mov_b32 s6, 0
    s_mov_b32 s7, 4290772927
    s_mov_b32 s90, 0
    s_getreg_b32 s75, hwreg(HW_REG_XCC_ID, 0, 4)
    s_add_u32 s75, s75, 1
    v_mov_b32 v20, s3
    v_mov_b32 v21, s75
    s_waitcnt vmcnt(0)
    s_barrier
    global_store_byte v20, v21, s[96:97] offset:224 sc1
    v_lshrrev_b32 v4, 4, v0
    v_and_b32 v5, 15, v0
    s_lshl_b32 s40, s4, 13
    v_lshl_add_u32 v5, v5, 7, s40
    v_and_b32 v2, 15, v0
    v_lshlrev_b32 v2, 2, v2
    v_mov_b32 v3, 4000
    v_add_u32 v6, 0, v4
    v_min_u32 v6, 13, v6
    v_lshl_add_u32 v8, v6, 15, v5
    v_add_u32 v6, 4, v4
    v_min_u32 v6, 13, v6
    v_lshl_add_u32 v9, v6, 15, v5
    v_add_u32 v6, 8, v4
    v_min_u32 v6, 13, v6
    v_lshl_add_u32 v10, v6, 15, v5
    v_add_u32 v6, 12, v4
    v_min_u32 v6, 13, v6
    v_lshl_add_u32 v11, v6, 15, v5
    v_min_u32 v30, 30, v0
L_fe_xc:
    global_load_ubyte v31, v30, s[96:97] offset:224 sc1
    s_add_u32 s6, s6, 1
    s_cmp_gt_u32 s6, 2097152
    s_cbranch_scc1 L_bail
    s_waitcnt vmcnt(0)
    v_cmp_eq_u32 vcc, 0, v31
    s_cbranch_vccnz L_fe_xc
L_fe_xk:
    v_cmp_ne_u32 vcc, s75, v31
    s_cmp_eq_u64 vcc, 0
    s_cselect_b32 s64, 1, 0
    s_add_u32 s14, s8, 42205184
    s_addc_u32 s15, s9, 0
    s_add_u32 s18, s8, 13762560
    s_addc_u32 s19, s9, 0
    s_add_u32 s68, s8, 43962880
    s_addc_u32 s69, s9, 0
L_fe_step:
    global_load_dword v24, v3, s[14:15] sc1
    global_load_dword v25, v2, s[68:69] sc1
    s_add_u32 s6, s6, 1
    s_cmp_gt_u32 s6, 2097152
    s_cbranch_scc1 L_bail
    s_waitcnt vmcnt(0)
    v_cmp_eq_u32 vcc, s7, v24
    v_cmp_eq_u32 s[40:41], 0, v25
    s_or_b64 vcc, vcc, s[40:41]
    s_cbranch_vccz L_fe_go
    s_sleep 2
    s_branch L_fe_step
L_fe_go:
    global_load_dword v26, v8, s[18:19] sc1
    global_load_dword v26, v9, s[18:19] sc1
    global_load_dword v26, v10, s[18:19] sc1
    global_load_dword v26, v11, s[18:19] sc1
    s_add_u32 s14, s14, 8192
    s_addc_u32 s15, s15, 0
    s_add_u32 s18, s18, 458752
    s_addc_u32 s19, s19, 0
    s_add_u32 s68, s68, 256
    s_addc_u32 s69, s69, 0
    s_add_u32 s5, s5, 1
    s_cmp_lt_u32 s5, 61
    s_cbranch_scc1 L_fe_step
    s_endpgm
L_spare:
    s_mov_b32 s27, 15
    s_endpgm
L_tokv:
    v_lshlrev_b32 v3, 4, v0
    s_mov_b32 s6, 0
    s_mov_b32 s7, 4290772927
    s_load_dwordx2 s[20:21], s[0:1], 0
    s_waitcnt lgkmcnt(0)
    s_mul_i32 s23, s4, 7168
    s_mul_i32 s40, s22, 28672
    s_mov_b32 s5, s22
    v_lshrrev_b32 v8, 2, v0
    v_mul_u32_u24 v8, 896, v8
    v_lshrrev_b32 v9, 5, v0
    v_lshlrev_b32 v9, 1, v9
    v_and_b32 v4, 3, v0
    v_xor_b32 v9, v9, v4
    v_lshl_add_u32 v4, v9, 4, v8
    v_lshrrev_b32 v8, 3, v1
    v_lshlrev_b32 v8, 1, v8
    v_xor_b32 v8, v8, v2
    v_lshl_add_u32 v8, v1, 2, v8
    v_lshlrev_b32 v5, 4, v8
    s_add_u32 s20, s20, s40
    s_addc_u32 s21, s21, 0
    s_mul_i32 s40, s4, 7
    s_add_u32 s40, s40, 0
    s_and_b32 s41, s40, 1
    s_mul_i32 s41, s41, 14336
    s_lshr_b32 s40, s40, 1
    s_lshl_b32 s40, s40, 6
    s_add_u32 s80, s40, s41
    s_mul_i32 s40, s4, 7
    s_add_u32 s40, s40, 1
    s_and_b32 s41, s40, 1
    s_mul_i32 s41, s41, 14336
    s_lshr_b32 s40, s40, 1
    s_lshl_b32 s40, s40, 6
    s_add_u32 s81, s40, s41
    s_mul_i32 s40, s4, 7
    s_add_u32 s40, s40, 2
    s_and_b32 s41, s40, 1
    s_mul_i32 s41, s41, 14336
    s_lshr_b32 s40, s40, 1
    s_lshl_b32 s40, s40, 6
    s_add_u32 s82, s40, s41
    s_mul_i32 s40, s4, 7
    s_add_u32 s40, s40, 3
    s_and_b32 s41, s40, 1
    s_mul_i32 s41, s41, 14336
    s_lshr_b32 s40, s40, 1
    s_lshl_b32 s40, s40, 6
    s_add_u32 s83, s40, s41
    s_mul_i32 s40, s4, 7
    s_add_u32 s40, s40, 4
    s_and_b32 s41, s40, 1
    s_mul_i32 s41, s41, 14336
    s_lshr_b32 s40, s40, 1
    s_lshl_b32 s40, s40, 6
    s_add_u32 s84, s40, s41
    s_mul_i32 s40, s4, 7
    s_add_u32 s40, s40, 5
    s_and_b32 s41, s40, 1
    s_mul_i32 s41, s41, 14336
    s_lshr_b32 s40, s40, 1
    s_lshl_b32 s40, s40, 6
    s_add_u32 s85, s40, s41
    s_mul_i32 s40, s4, 7
    s_add_u32 s40, s40, 6
    s_and_b32 s41, s40, 1
    s_mul_i32 s41, s41, 14336
    s_lshr_b32 s40, s40, 1
    s_lshl_b32 s40, s40, 6
    s_add_u32 s86, s40, s41
    s_add_u32 s40, s20, s80
    s_addc_u32 s41, s21, 0
    s_add_u32 m0, s23, 0
    s_nop 0
    global_load_lds_dwordx4 v4, s[40:41]
    s_add_u32 s40, s20, s81
    s_addc_u32 s41, s21, 0
    s_add_u32 m0, s23, 1024
    s_nop 0
    global_load_lds_dwordx4 v4, s[40:41]
    s_add_u32 s40, s20, s82
    s_addc_u32 s41, s21, 0
    s_add_u32 m0, s23, 2048
    s_nop 0
    global_load_lds_dwordx4 v4, s[40:41]
    s_add_u32 s40, s20, s83
    s_addc_u32 s41, s21, 0
    s_add_u32 m0, s23, 3072
    s_nop 0
    global_load_lds_dwordx4 v4, s[40:41]
    s_add_u32 s40, s20, s84
    s_addc_u32 s41, s21, 0
    s_add_u32 m0, s23, 4096
    s_nop 0
    global_load_lds_dwordx4 v4, s[40:41]
    s_add_u32 s40, s20, s85
    s_addc_u32 s41, s21, 0
    s_add_u32 m0, s23, 5120
    s_nop 0
    global_load_lds_dwordx4 v4, s[40:41]
    s_add_u32 s40, s20, s86
    s_addc_u32 s41, s21, 0
    s_add_u32 m0, s23, 6144
    s_nop 0
    global_load_lds_dwordx4 v4, s[40:41]
    s_add_u32 s20, s20, 114688
    s_addc_u32 s21, s21, 0
    s_cmp_lg_u32 s4, 0
    s_cbranch_scc1 L_tv_rb
    s_add_u32 s40, s8, 43982848
    s_addc_u32 s41, s9, 0
    v_bfe_u32 v8, v0, 3, 1
    v_lshlrev_b32 v8, 11, v8
    v_and_b32 v9, 7, v0
    v_lshl_add_u32 v8, v9, 2, v8
    s_lshl_b32 s43, s3, 7
    v_add_u32 v8, s43, v8
    s_mov_b32 s42, 0
L_tv_rp:
    global_load_dword v10, v8, s[40:41] sc1
    s_add_u32 s42, s42, 1
    s_cmp_gt_u32 s42, 1048576
    s_cbranch_scc1 L_bail
    s_waitcnt vmcnt(0)
    v_cmp_eq_u32 vcc, 0, v10
    s_cbranch_vccz L_tv_rb
    s_sleep 1
    s_branch L_tv_rp
L_tv_rb:
    s_barrier
    s_and_b32 s46, s4, 1
    s_lshr_b32 s41, s4, 1
    s_mul_i32 s41, s41, 7
    s_lshl_b32 s40, s46, 2
    s_add_u32 s40, s40, s41
    s_add_u32 s41, s41, 3
    s_sub_u32 s24, 0, s46
    s_mov_b32 s25, s24
    s_mul_i32 s42, s3, 401408
    s_mul_i32 s43, s40, 28672
    s_add_u32 s43, s43, s42
    s_mul_i32 s44, s41, 28672
    s_add_u32 s44, s44, s42
    s_add_u32 s10, s8, 6422528
    s_addc_u32 s11, s9, 0
    s_add_u32 s12, s10, s44
    s_addc_u32 s13, s11, 0
    s_add_u32 s10, s10, s43
    s_addc_u32 s11, s11, 0
    global_load_dwordx4 v[32:35], v3, s[10:11] offset:0 sc1
    global_load_dwordx4 v[36:39], v3, s[10:11] offset:1024 sc1
    global_load_dwordx4 v[40:43], v3, s[10:11] offset:2048 sc1
    global_load_dwordx4 v[44:47], v3, s[10:11] offset:3072 sc1
    s_add_u32 s10, s10, 4096
    s_addc_u32 s11, s11, 0
    global_load_dwordx4 v[48:51], v3, s[10:11] offset:0 sc1
    global_load_dwordx4 v[52:55], v3, s[10:11] offset:1024 sc1
    global_load_dwordx4 v[56:59], v3, s[10:11] offset:2048 sc1
    global_load_dwordx4 v[60:63], v3, s[10:11] offset:3072 sc1
    s_add_u32 s10, s10, 4096
    s_addc_u32 s11, s11, 0
    global_load_dwordx4 v[64:67], v3, s[10:11] offset:0 sc1
    global_load_dwordx4 v[68:71], v3, s[10:11] offset:1024 sc1
    global_load_dwordx4 v[72:75], v3, s[10:11] offset:2048 sc1
    global_load_dwordx4 v[76:79], v3, s[10:11] offset:3072 sc1
    s_add_u32 s10, s10, 4096
    s_addc_u32 s11, s11, 0
    global_load_dwordx4 v[80:83], v3, s[10:11] offset:0 sc1
    global_load_dwordx4 v[84:87], v3, s[10:11] offset:1024 sc1
    global_load_dwordx4 v[88:91], v3, s[10:11] offset:2048 sc1
    global_load_dwordx4 v[92:95], v3, s[10:11] offset:3072 sc1
    s_add_u32 s10, s10, 4096
    s_addc_u32 s11, s11, 0
    global_load_dwordx4 v[96:99], v3, s[10:11] offset:0 sc1
    global_load_dwordx4 v[100:103], v3, s[10:11] offset:1024 sc1
    global_load_dwordx4 v[104:107], v3, s[10:11] offset:2048 sc1
    global_load_dwordx4 v[108:111], v3, s[10:11] offset:3072 sc1
    s_add_u32 s10, s10, 4096
    s_addc_u32 s11, s11, 0
    global_load_dwordx4 v[112:115], v3, s[10:11] offset:0 sc1
    global_load_dwordx4 v[116:119], v3, s[10:11] offset:1024 sc1
    s_waitcnt vmcnt(20)
    v_accvgpr_write_b32 a0, v32
    v_accvgpr_write_b32 a56, v33
    v_accvgpr_write_b32 a1, v34
    v_accvgpr_write_b32 a57, v35
    v_accvgpr_write_b32 a2, v36
    v_accvgpr_write_b32 a58, v37
    v_accvgpr_write_b32 a3, v38
    v_accvgpr_write_b32 a59, v39
    global_load_dwordx4 v[32:35], v3, s[10:11] offset:2048 sc1
    global_load_dwordx4 v[36:39], v3, s[10:11] offset:3072 sc1
    s_add_u32 s10, s10, 4096
    s_addc_u32 s11, s11, 0
    s_waitcnt vmcnt(20)
    v_accvgpr_write_b32 a4, v40
    v_accvgpr_write_b32 a60, v41
    v_accvgpr_write_b32 a5, v42
    v_accvgpr_write_b32 a61, v43
    v_accvgpr_write_b32 a6, v44
    v_accvgpr_write_b32 a62, v45
    v_accvgpr_write_b32 a7, v46
    v_accvgpr_write_b32 a63, v47
    global_load_dwordx4 v[40:43], v3, s[10:11] offset:0 sc1
    global_load_dwordx4 v[44:47], v3, s[10:11] offset:1024 sc1
    s_waitcnt vmcnt(20)
    v_accvgpr_write_b32 a8, v48
    v_accvgpr_write_b32 a64, v49
    v_accvgpr_write_b32 a9, v50
    v_accvgpr_write_b32 a65, v51
    v_accvgpr_write_b32 a10, v52
    v_accvgpr_write_b32 a66, v53
    v_accvgpr_write_b32 a11, v54
    v_accvgpr_write_b32 a67, v55
    global_load_dwordx4 v[48:51], v3, s[10:11] offset:2048 sc1
    global_load_dwordx4 v[52:55], v3, s[10:11] offset:3072 sc1
    s_add_u32 s10, s10, 4096
    s_addc_u32 s11, s11, 0
    s_waitcnt vmcnt(20)
    v_accvgpr_write_b32 a12, v56
    v_accvgpr_write_b32 a68, v57
    v_accvgpr_write_b32 a13, v58
    v_accvgpr_write_b32 a69, v59
    v_accvgpr_write_b32 a14, v60
    v_accvgpr_write_b32 a70, v61
    v_accvgpr_write_b32 a15, v62
    v_accvgpr_write_b32 a71, v63
    global_load_dwordx4 v[56:59], v3, s[10:11] offset:0 sc1
    global_load_dwordx4 v[60:63], v3, s[10:11] offset:1024 sc1
    s_waitcnt vmcnt(20)
    v_accvgpr_write_b32 a16, v64
    v_accvgpr_write_b32 a72, v65
    v_accvgpr_write_b32 a17, v66
    v_accvgpr_write_b32 a73, v67
    v_accvgpr_write_b32 a18, v68
    v_accvgpr_write_b32 a74, v69
    v_accvgpr_write_b32 a19, v70
    v_accvgpr_write_b32 a75, v71
    global_load_dwordx4 v[64:67], v3, s[10:11] offset:2048 sc1
    global_load_dwordx4 v[68:71], v3, s[10:11] offset:3072 sc1
    s_add_u32 s10, s10, 4096
    s_addc_u32 s11, s11, 0
    s_waitcnt vmcnt(20)
    v_accvgpr_write_b32 a20, v72
    v_accvgpr_write_b32 a76, v73
    v_accvgpr_write_b32 a21, v74
    v_accvgpr_write_b32 a77, v75
    v_accvgpr_write_b32 a22, v76
    v_accvgpr_write_b32 a78, v77
    v_accvgpr_write_b32 a23, v78
    v_accvgpr_write_b32 a79, v79
    global_load_dwordx4 v[72:75], v3, s[10:11] offset:0 sc1
    global_load_dwordx4 v[76:79], v3, s[10:11] offset:1024 sc1
    s_waitcnt vmcnt(20)
    v_accvgpr_write_b32 a24, v80
    v_accvgpr_write_b32 a80, v81
    v_accvgpr_write_b32 a25, v82
    v_accvgpr_write_b32 a81, v83
    v_accvgpr_write_b32 a26, v84
    v_accvgpr_write_b32 a82, v85
    v_accvgpr_write_b32 a27, v86
    v_accvgpr_write_b32 a83, v87
    global_load_dwordx4 v[80:83], v3, s[10:11] offset:2048 sc1
    global_load_dwordx4 v[84:87], v3, s[10:11] offset:3072 sc1
    s_add_u32 s10, s10, 4096
    s_addc_u32 s11, s11, 0
    s_waitcnt vmcnt(20)
    v_accvgpr_write_b32 a28, v88
    v_accvgpr_write_b32 a84, v89
    v_accvgpr_write_b32 a29, v90
    v_accvgpr_write_b32 a85, v91
    v_accvgpr_write_b32 a30, v92
    v_accvgpr_write_b32 a86, v93
    v_accvgpr_write_b32 a31, v94
    v_accvgpr_write_b32 a87, v95
    global_load_dwordx4 v[88:91], v3, s[10:11] offset:0 sc1
    global_load_dwordx4 v[92:95], v3, s[10:11] offset:1024 sc1
    s_waitcnt vmcnt(20)
    v_accvgpr_write_b32 a32, v96
    v_accvgpr_write_b32 a88, v97
    v_accvgpr_write_b32 a33, v98
    v_accvgpr_write_b32 a89, v99
    v_accvgpr_write_b32 a34, v100
    v_accvgpr_write_b32 a90, v101
    v_accvgpr_write_b32 a35, v102
    v_accvgpr_write_b32 a91, v103
    global_load_dwordx4 v[96:99], v3, s[10:11] offset:2048 sc1
    global_load_dwordx4 v[100:103], v3, s[10:11] offset:3072 sc1
    s_add_u32 s10, s10, 4096
    s_addc_u32 s11, s11, 0
    s_waitcnt vmcnt(20)
    v_accvgpr_write_b32 a36, v104
    v_accvgpr_write_b32 a92, v105
    v_accvgpr_write_b32 a37, v106
    v_accvgpr_write_b32 a93, v107
    v_accvgpr_write_b32 a38, v108
    v_accvgpr_write_b32 a94, v109
    v_accvgpr_write_b32 a39, v110
    v_accvgpr_write_b32 a95, v111
    global_load_dwordx4 v[104:107], v3, s[10:11] offset:0 sc1
    global_load_dwordx4 v[108:111], v3, s[10:11] offset:1024 sc1
    s_waitcnt vmcnt(20)
    v_accvgpr_write_b32 a40, v112
    v_accvgpr_write_b32 a96, v113
    v_accvgpr_write_b32 a41, v114
    v_accvgpr_write_b32 a97, v115
    v_accvgpr_write_b32 a42, v116
    v_accvgpr_write_b32 a98, v117
    v_accvgpr_write_b32 a43, v118
    v_accvgpr_write_b32 a99, v119
    global_load_dwordx4 v[112:115], v3, s[10:11] offset:2048 sc1
    global_load_dwordx4 v[116:119], v3, s[10:11] offset:3072 sc1
    s_add_u32 s10, s10, 4096
    s_addc_u32 s11, s11, 0
    s_waitcnt vmcnt(20)
    v_accvgpr_write_b32 a44, v32
    v_accvgpr_write_b32 a100, v33
    v_accvgpr_write_b32 a45, v34
    v_accvgpr_write_b32 a101, v35
    v_accvgpr_write_b32 a46, v36
    v_accvgpr_write_b32 a102, v37
    v_accvgpr_write_b32 a47, v38
    v_accvgpr_write_b32 a103, v39
    global_load_dwordx4 v[32:35], v3, s[10:11] offset:0 sc1
    global_load_dwordx4 v[36:39], v3, s[10:11] offset:1024 sc1
    s_waitcnt vmcnt(20)
    v_accvgpr_write_b32 a48, v40
    v_accvgpr_write_b32 a104, v41
    v_accvgpr_write_b32 a49, v42
    v_accvgpr_write_b32 a105, v43
    v_accvgpr_write_b32 a50, v44
    v_accvgpr_write_b32 a106, v45
    v_accvgpr_write_b32 a51, v46
    v_accvgpr_write_b32 a107, v47
    global_load_dwordx4 v[40:43], v3, s[10:11] offset:2048 sc1
    global_load_dwordx4 v[44:47], v3, s[10:11] offset:3072 sc1
    s_add_u32 s10, s10, 4096
    s_addc_u32 s11, s11, 0
    s_waitcnt vmcnt(20)
    v_accvgpr_write_b32 a52, v48
    v_accvgpr_write_b32 a108, v49
    v_accvgpr_write_b32 a53, v50
    v_accvgpr_write_b32 a109, v51
    v_accvgpr_write_b32 a54, v52
    v_accvgpr_write_b32 a110, v53
    v_accvgpr_write_b32 a55, v54
    v_accvgpr_write_b32 a111, v55
    global_load_dwordx4 v[48:51], v3, s[10:11] offset:0 sc1
    global_load_dwordx4 v[52:55], v3, s[10:11] offset:1024 sc1
    s_waitcnt vmcnt(20)
    v_accvgpr_write_b32 a112, v56
    v_accvgpr_write_b32 a168, v57
    v_accvgpr_write_b32 a113, v58
    v_accvgpr_write_b32 a169, v59
    v_accvgpr_write_b32 a114, v60
    v_accvgpr_write_b32 a170, v61
    v_accvgpr_write_b32 a115, v62
    v_accvgpr_write_b32 a171, v63
    global_load_dwordx4 v[56:59], v3, s[10:11] offset:2048 sc1
    global_load_dwordx4 v[60:63], v3, s[10:11] offset:3072 sc1
    s_add_u32 s10, s10, 4096
    s_addc_u32 s11, s11, 0
    s_waitcnt vmcnt(20)
    v_accvgpr_write_b32 a116, v64
    v_accvgpr_write_b32 a172, v65
    v_accvgpr_write_b32 a117, v66
    v_accvgpr_write_b32 a173, v67
    v_accvgpr_write_b32 a118, v68
    v_accvgpr_write_b32 a174, v69
    v_accvgpr_write_b32 a119, v70
    v_accvgpr_write_b32 a175, v71
    global_load_dwordx4 v[64:67], v3, s[10:11] offset:0 sc1
    global_load_dwordx4 v[68:71], v3, s[10:11] offset:1024 sc1
    s_waitcnt vmcnt(20)
    v_accvgpr_write_b32 a120, v72
    v_accvgpr_write_b32 a176, v73
    v_accvgpr_write_b32 a121, v74
    v_accvgpr_write_b32 a177, v75
    v_accvgpr_write_b32 a122, v76
    v_accvgpr_write_b32 a178, v77
    v_accvgpr_write_b32 a123, v78
    v_accvgpr_write_b32 a179, v79
    global_load_dwordx4 v[72:75], v3, s[10:11] offset:2048 sc1
    global_load_dwordx4 v[76:79], v3, s[10:11] offset:3072 sc1
    s_add_u32 s10, s10, 4096
    s_addc_u32 s11, s11, 0
    s_waitcnt vmcnt(20)
    v_accvgpr_write_b32 a124, v80
    v_accvgpr_write_b32 a180, v81
    v_accvgpr_write_b32 a125, v82
    v_accvgpr_write_b32 a181, v83
    v_accvgpr_write_b32 a126, v84
    v_accvgpr_write_b32 a182, v85
    v_accvgpr_write_b32 a127, v86
    v_accvgpr_write_b32 a183, v87
    global_load_dwordx4 v[80:83], v3, s[10:11] offset:0 sc1
    global_load_dwordx4 v[84:87], v3, s[10:11] offset:1024 sc1
    s_waitcnt vmcnt(20)
    v_accvgpr_write_b32 a128, v88
    v_accvgpr_write_b32 a184, v89
    v_accvgpr_write_b32 a129, v90
    v_accvgpr_write_b32 a185, v91
    v_accvgpr_write_b32 a130, v92
    v_accvgpr_write_b32 a186, v93
    v_accvgpr_write_b32 a131, v94
    v_accvgpr_write_b32 a187, v95
    global_load_dwordx4 v[88:91], v3, s[10:11] offset:2048 sc1
    global_load_dwordx4 v[92:95], v3, s[10:11] offset:3072 sc1
    s_add_u32 s10, s10, 4096
    s_addc_u32 s11, s11, 0
    s_waitcnt vmcnt(20)
    v_accvgpr_write_b32 a132, v96
    v_accvgpr_write_b32 a188, v97
    v_accvgpr_write_b32 a133, v98
    v_accvgpr_write_b32 a189, v99
    v_accvgpr_write_b32 a134, v100
    v_accvgpr_write_b32 a190, v101
    v_accvgpr_write_b32 a135, v102
    v_accvgpr_write_b32 a191, v103
    global_load_dwordx4 v[96:99], v3, s[10:11] offset:0 sc1
    global_load_dwordx4 v[100:103], v3, s[10:11] offset:1024 sc1
    s_waitcnt vmcnt(20)
    v_accvgpr_write_b32 a136, v104
    v_accvgpr_write_b32 a192, v105
    v_accvgpr_write_b32 a137, v106
    v_accvgpr_write_b32 a193, v107
    v_accvgpr_write_b32 a138, v108
    v_accvgpr_write_b32 a194, v109
    v_accvgpr_write_b32 a139, v110
    v_accvgpr_write_b32 a195, v111
    global_load_dwordx4 v[104:107], v3, s[10:11] offset:2048 sc1
    global_load_dwordx4 v[108:111], v3, s[10:11] offset:3072 sc1
    s_add_u32 s10, s10, 4096
    s_addc_u32 s11, s11, 0
    s_waitcnt vmcnt(20)
    v_accvgpr_write_b32 a140, v112
    v_accvgpr_write_b32 a196, v113
    v_accvgpr_write_b32 a141, v114
    v_accvgpr_write_b32 a197, v115
    v_accvgpr_write_b32 a142, v116
    v_accvgpr_write_b32 a198, v117
    v_accvgpr_write_b32 a143, v118
    v_accvgpr_write_b32 a199, v119
    global_load_dwordx4 v[112:115], v3, s[10:11] offset:0 sc1
    global_load_dwordx4 v[116:119], v3, s[10:11] offset:1024 sc1
    s_waitcnt vmcnt(20)
    v_accvgpr_write_b32 a144, v32
    v_accvgpr_write_b32 a200, v33
    v_accvgpr_write_b32 a145, v34
    v_accvgpr_write_b32 a201, v35
    v_accvgpr_write_b32 a146, v36
    v_accvgpr_write_b32 a202, v37
    v_accvgpr_write_b32 a147, v38
    v_accvgpr_write_b32 a203, v39
    global_load_dwordx4 v[32:35], v3, s[10:11] offset:2048 sc1
    global_load_dwordx4 v[36:39], v3, s[10:11] offset:3072 sc1
    s_add_u32 s10, s10, 4096
    s_addc_u32 s11, s11, 0
    s_waitcnt vmcnt(20)
    v_accvgpr_write_b32 a148, v40
    v_accvgpr_write_b32 a204, v41
    v_accvgpr_write_b32 a149, v42
    v_accvgpr_write_b32 a205, v43
    v_accvgpr_write_b32 a150, v44
    v_accvgpr_write_b32 a206, v45
    v_accvgpr_write_b32 a151, v46
    v_accvgpr_write_b32 a207, v47
    global_load_dwordx4 v[40:43], v3, s[10:11] offset:0 sc1
    global_load_dwordx4 v[44:47], v3, s[10:11] offset:1024 sc1
    s_waitcnt vmcnt(20)
    v_accvgpr_write_b32 a152, v48
    v_accvgpr_write_b32 a208, v49
    v_accvgpr_write_b32 a153, v50
    v_accvgpr_write_b32 a209, v51
    v_accvgpr_write_b32 a154, v52
    v_accvgpr_write_b32 a210, v53
    v_accvgpr_write_b32 a155, v54
    v_accvgpr_write_b32 a211, v55
    global_load_dwordx4 v[48:51], v3, s[10:11] offset:2048 sc1
    global_load_dwordx4 v[52:55], v3, s[10:11] offset:3072 sc1
    s_add_u32 s10, s10, 4096
    s_addc_u32 s11, s11, 0
    s_waitcnt vmcnt(20)
    v_accvgpr_write_b32 a156, v56
    v_accvgpr_write_b32 a212, v57
    v_accvgpr_write_b32 a157, v58
    v_accvgpr_write_b32 a213, v59
    v_accvgpr_write_b32 a158, v60
    v_accvgpr_write_b32 a214, v61
    v_accvgpr_write_b32 a159, v62
    v_accvgpr_write_b32 a215, v63
    global_load_dwordx4 v[56:59], v3, s[10:11] offset:0 sc1
    global_load_dwordx4 v[60:63], v3, s[10:11] offset:1024 sc1
    s_waitcnt vmcnt(20)
    v_accvgpr_write_b32 a160, v64
    v_accvgpr_write_b32 a216, v65
    v_accvgpr_write_b32 a161, v66
    v_accvgpr_write_b32 a217, v67
    v_accvgpr_write_b32 a162, v68
    v_accvgpr_write_b32 a218, v69
    v_accvgpr_write_b32 a163, v70
    v_accvgpr_write_b32 a219, v71
    global_load_dwordx4 v[64:67], v3, s[10:11] offset:2048 sc1
    global_load_dwordx4 v[68:71], v3, s[10:11] offset:3072 sc1
    s_add_u32 s10, s10, 4096
    s_addc_u32 s11, s11, 0
    s_waitcnt vmcnt(20)
    v_accvgpr_write_b32 a164, v72
    v_accvgpr_write_b32 a220, v73
    v_accvgpr_write_b32 a165, v74
    v_accvgpr_write_b32 a221, v75
    v_accvgpr_write_b32 a166, v76
    v_accvgpr_write_b32 a222, v77
    v_accvgpr_write_b32 a167, v78
    v_accvgpr_write_b32 a223, v79
    global_load_dwordx4 v[72:75], v3, s[10:11] offset:0 sc1
    global_load_dwordx4 v[76:79], v3, s[10:11] offset:1024 sc1
    s_waitcnt vmcnt(20)
    v_accvgpr_write_b32 a224, v80
    v_mov_b32 v200, v81
    v_accvgpr_write_b32 a225, v82
    v_mov_b32 v201, v83
    v_accvgpr_write_b32 a226, v84
    v_mov_b32 v202, v85
    v_accvgpr_write_b32 a227, v86
    v_mov_b32 v203, v87
    global_load_dwordx4 v[80:83], v3, s[10:11] offset:2048 sc1
    global_load_dwordx4 v[84:87], v3, s[10:11] offset:3072 sc1
    s_add_u32 s10, s10, 4096
    s_addc_u32 s11, s11, 0
    s_waitcnt vmcnt(20)
    v_accvgpr_write_b32 a228, v88
    v_mov_b32 v204, v89
    v_accvgpr_write_b32 a229, v90
    v_mov_b32 v205, v91
    v_accvgpr_write_b32 a230, v92
    v_mov_b32 v206, v93
    v_accvgpr_write_b32 a231, v94
    v_mov_b32 v207, v95
    global_load_dwordx4 v[88:91], v3, s[10:11] offset:0 sc1
    global_load_dwordx4 v[92:95], v3, s[10:11] offset:1024 sc1
    s_waitcnt vmcnt(20)
    v_accvgpr_write_b32 a232, v96
    v_mov_b32 v208, v97
    v_accvgpr_write_b32 a233, v98
    v_mov_b32 v209, v99
    v_accvgpr_write_b32 a234, v100
    v_mov_b32 v210, v101
    v_accvgpr_write_b32 a235, v102
    v_mov_b32 v211, v103
    global_load_dwordx4 v[96:99], v3, s[10:11] offset:2048 sc1
    global_load_dwordx4 v[100:103], v3, s[10:11] offset:3072 sc1
    s_add_u32 s10, s10, 4096
    s_addc_u32 s11, s11, 0
    s_waitcnt vmcnt(20)
    v_accvgpr_write_b32 a236, v104
    v_mov_b32 v212, v105
    v_accvgpr_write_b32 a237, v106
    v_mov_b32 v213, v107
    v_accvgpr_write_b32 a238, v108
    v_mov_b32 v214, v109
    v_accvgpr_write_b32 a239, v110
    v_mov_b32 v215, v111
    global_load_dwordx4 v[104:107], v3, s[12:13] offset:0 sc1
    global_load_dwordx4 v[108:111], v3, s[12:13] offset:1024 sc1
    s_waitcnt vmcnt(20)
    v_accvgpr_write_b32 a240, v112
    v_mov_b32 v216, v113
    v_accvgpr_write_b32 a241, v114
    v_mov_b32 v217, v115
    v_accvgpr_write_b32 a242, v116
    v_mov_b32 v218, v117
    v_accvgpr_write_b32 a243, v118
    v_mov_b32 v219, v119
    global_load_dwordx4 v[112:115], v3, s[12:13] offset:2048 sc1
    global_load_dwordx4 v[116:119], v3, s[12:13] offset:3072 sc1
    s_add_u32 s12, s12, 4096
    s_addc_u32 s13, s13, 0
    s_waitcnt vmcnt(20)
    v_accvgpr_write_b32 a244, v32
    v_mov_b32 v220, v33
    v_accvgpr_write_b32 a245, v34
    v_mov_b32 v221, v35
    v_accvgpr_write_b32 a246, v36
    v_mov_b32 v222, v37
    v_accvgpr_write_b32 a247, v38
    v_mov_b32 v223, v39
    global_load_dwordx4 v[32:35], v3, s[12:13] offset:0 sc1
    global_load_dwordx4 v[36:39], v3, s[12:13] offset:1024 sc1
    s_waitcnt vmcnt(20)
    v_accvgpr_write_b32 a248, v40
    v_mov_b32 v224, v41
    v_accvgpr_write_b32 a249, v42
    v_mov_b32 v225, v43
    v_accvgpr_write_b32 a250, v44
    v_mov_b32 v226, v45
    v_accvgpr_write_b32 a251, v46
    v_mov_b32 v227, v47
    global_load_dwordx4 v[40:43], v3, s[12:13] offset:2048 sc1
    global_load_dwordx4 v[44:47], v3, s[12:13] offset:3072 sc1
    s_add_u32 s12, s12, 4096
    s_addc_u32 s13, s13, 0
    s_waitcnt vmcnt(20)
    v_accvgpr_write_b32 a252, v48
    v_mov_b32 v228, v49
    v_accvgpr_write_b32 a253, v50
    v_mov_b32 v229, v51
    v_accvgpr_write_b32 a254, v52
    v_mov_b32 v230, v53
    v_accvgpr_write_b32 a255, v54
    v_mov_b32 v231, v55
    global_load_dwordx4 v[48:51], v3, s[12:13] offset:0 sc1
    global_load_dwordx4 v[52:55], v3, s[12:13] offset:1024 sc1
    s_waitcnt vmcnt(20)
    v_mov_b32 v176, v56
    v_mov_b32 v232, v57
    v_mov_b32 v177, v58
    v_mov_b32 v233, v59
    v_mov_b32 v178, v60
    v_mov_b32 v234, v61
    v_mov_b32 v179, v62
    v_mov_b32 v235, v63
    global_load_dwordx4 v[56:59], v3, s[12:13] offset:2048 sc1
    global_load_dwordx4 v[60:63], v3, s[12:13] offset:3072 sc1
    s_add_u32 s12, s12, 4096
    s_addc_u32 s13, s13, 0
    s_waitcnt vmcnt(20)
    v_mov_b32 v180, v64
    v_mov_b32 v236, v65
    v_mov_b32 v181, v66
    v_mov_b32 v237, v67
    v_mov_b32 v182, v68
    v_mov_b32 v238, v69
    v_mov_b32 v183, v70
    v_mov_b32 v239, v71
    global_load_dwordx4 v[64:67], v3, s[12:13] offset:0 sc1
    global_load_dwordx4 v[68:71], v3, s[12:13] offset:1024 sc1
    s_waitcnt vmcnt(20)
    v_mov_b32 v184, v72
    v_mov_b32 v240, v73
    v_mov_b32 v185, v74
    v_mov_b32 v241, v75
    v_mov_b32 v186, v76
    v_mov_b32 v242, v77
    v_mov_b32 v187, v78
    v_mov_b32 v243, v79
    global_load_dwordx4 v[72:75], v3, s[12:13] offset:2048 sc1
    global_load_dwordx4 v[76:79], v3, s[12:13] offset:3072 sc1
    s_add_u32 s12, s12, 4096
    s_addc_u32 s13, s13, 0
    s_waitcnt vmcnt(20)
    v_mov_b32 v188, v80
    v_mov_b32 v244, v81
    v_mov_b32 v189, v82
    v_mov_b32 v245, v83
    v_mov_b32 v190, v84
    v_mov_b32 v246, v85
    v_mov_b32 v191, v86
    v_mov_b32 v247, v87
    global_load_dwordx4 v[80:83], v3, s[12:13] offset:0 sc1
    global_load_dwordx4 v[84:87], v3, s[12:13] offset:1024 sc1
    s_waitcnt vmcnt(20)
    v_mov_b32 v192, v88
    v_mov_b32 v248, v89
    v_mov_b32 v193, v90
    v_mov_b32 v249, v91
    v_mov_b32 v194, v92
    v_mov_b32 v250, v93
    v_mov_b32 v195, v94
    v_mov_b32 v251, v95
    global_load_dwordx4 v[88:91], v3, s[12:13] offset:2048 sc1
    global_load_dwordx4 v[92:95], v3, s[12:13] offset:3072 sc1
    s_add_u32 s12, s12, 4096
    s_addc_u32 s13, s13, 0
    s_waitcnt vmcnt(20)
    v_mov_b32 v196, v96
    v_mov_b32 v252, v97
    v_mov_b32 v197, v98
    v_mov_b32 v253, v99
    v_mov_b32 v198, v100
    v_mov_b32 v254, v101
    v_mov_b32 v199, v102
    v_mov_b32 v255, v103
    global_load_dwordx4 v[96:99], v3, s[12:13] offset:0 sc1
    global_load_dwordx4 v[100:103], v3, s[12:13] offset:1024 sc1
    s_waitcnt vmcnt(20)
    v_cndmask_b32 v120, v104, v105, s[24:25]
    v_cndmask_b32 v121, v106, v107, s[24:25]
    v_cndmask_b32 v122, v108, v109, s[24:25]
    v_cndmask_b32 v123, v110, v111, s[24:25]
    global_load_dwordx4 v[104:107], v3, s[12:13] offset:2048 sc1
    global_load_dwordx4 v[108:111], v3, s[12:13] offset:3072 sc1
    s_add_u32 s12, s12, 4096
    s_addc_u32 s13, s13, 0
    s_waitcnt vmcnt(20)
    v_cndmask_b32 v124, v112, v113, s[24:25]
    v_cndmask_b32 v125, v114, v115, s[24:25]
    v_cndmask_b32 v126, v116, v117, s[24:25]
    v_cndmask_b32 v127, v118, v119, s[24:25]
    global_load_dwordx4 v[112:115], v3, s[12:13] offset:0 sc1
    global_load_dwordx4 v[116:119], v3, s[12:13] offset:1024 sc1
    s_waitcnt vmcnt(20)
    v_cndmask_b32 v128, v32, v33, s[24:25]
    v_cndmask_b32 v129, v34, v35, s[24:25]
    v_cndmask_b32 v130, v36, v37, s[24:25]
    v_cndmask_b32 v131, v38, v39, s[24:25]
    global_load_dwordx4 v[32:35], v3, s[12:13] offset:2048 sc1
    global_load_dwordx4 v[36:39], v3, s[12:13] offset:3072 sc1
    s_add_u32 s12, s12, 4096
    s_addc_u32 s13, s13, 0
    s_waitcnt vmcnt(20)
    v_cndmask_b32 v132, v40, v41, s[24:25]
    v_cndmask_b32 v133, v42, v43, s[24:25]
    v_cndmask_b32 v134, v44, v45, s[24:25]
    v_cndmask_b32 v135, v46, v47, s[24:25]
    s_waitcnt vmcnt(18)
    v_cndmask_b32 v136, v48, v49, s[24:25]
    v_cndmask_b32 v137, v50, v51, s[24:25]
    v_cndmask_b32 v138, v52, v53, s[24:25]
    v_cndmask_b32 v139, v54, v55, s[24:25]
    s_waitcnt vmcnt(16)
    v_cndmask_b32 v140, v56, v57, s[24:25]
    v_cndmask_b32 v141, v58, v59, s[24:25]
    v_cndmask_b32 v142, v60, v61, s[24:25]
    v_cndmask_b32 v143, v62, v63, s[24:25]
    s_waitcnt vmcnt(14)
    v_cndmask_b32 v144, v64, v65, s[24:25]
    v_cndmask_b32 v145, v66, v67, s[24:25]
    v_cndmask_b32 v146, v68, v69, s[24:25]
    v_cndmask_b32 v147, v70, v71, s[24:25]
    s_waitcnt vmcnt(12)
    v_cndmask_b32 v148, v72, v73, s[24:25]
    v_cndmask_b32 v149, v74, v75, s[24:25]
    v_cndmask_b32 v150, v76, v77, s[24:25]
    v_cndmask_b32 v151, v78, v79, s[24:25]
    s_waitcnt vmcnt(10)
    v_cndmask_b32 v152, v80, v81, s[24:25]
    v_cndmask_b32 v153, v82, v83, s[24:25]
    v_cndmask_b32 v154, v84, v85, s[24:25]
    v_cndmask_b32 v155, v86, v87, s[24:25]
    s_waitcnt vmcnt(8)
    v_cndmask_b32 v156, v88, v89, s[24:25]
    v_cndmask_b32 v157, v90, v91, s[24:25]
    v_cndmask_b32 v158, v92, v93, s[24:25]
    v_cndmask_b32 v159, v94, v95, s[24:25]
    s_waitcnt vmcnt(6)
    v_cndmask_b32 v160, v96, v97, s[24:25]
    v_cndmask_b32 v161, v98, v99, s[24:25]
    v_cndmask_b32 v162, v100, v101, s[24:25]
    v_cndmask_b32 v163, v102, v103, s[24:25]
    s_waitcnt vmcnt(4)
    v_cndmask_b32 v164, v104, v105, s[24:25]
    v_cndmask_b32 v165, v106, v107, s[24:25]
    v_cndmask_b32 v166, v108, v109, s[24:25]
    v_cndmask_b32 v167, v110, v111, s[24:25]
    s_waitcnt vmcnt(2)
    v_cndmask_b32 v168, v112, v113, s[24:25]
    v_cndmask_b32 v169, v114, v115, s[24:25]
    v_cndmask_b32 v170, v116, v117, s[24:25]
    v_cndmask_b32 v171, v118, v119, s[24:25]
    s_waitcnt vmcnt(0)
    v_cndmask_b32 v172, v32, v33, s[24:25]
    v_cndmask_b32 v173, v34, v35, s[24:25]
    v_cndmask_b32 v174, v36, v37, s[24:25]
    v_cndmask_b32 v175, v38, v39, s[24:25]
    v_mov_b32 v60, v4
    s_and_b32 s46, s4, 1
    s_lshr_b32 s41, s4, 1
    s_mul_i32 s41, s41, 7
    s_lshl_b32 s40, s46, 2
    s_add_u32 s40, s40, s41
    s_add_u32 s41, s41, 3
    s_sub_u32 s24, 0, s46
    s_mov_b32 s25, s24
    s_mul_i32 s42, s22, 458752
    s_lshl_b32 s43, s3, 11
    s_add_u32 s42, s42, s43
    s_lshl_b32 s43, s40, 15
    s_add_u32 s43, s43, s42
    s_lshl_b32 s44, s41, 15
    s_add_u32 s44, s44, s42
    s_and_b32 s45, s4, 1
    s_lshl_b32 s45, s45, 10
    s_add_u32 s44, s44, s45
    v_lshrrev_b32 v8, 3, v1
    v_lshlrev_b32 v8, 10, v8
    v_and_b32 v9, 7, v0
    v_lshl_add_u32 v8, v9, 6, v8
    v_lshl_add_u32 v4, v2, 4, v8
    v_xor_b32 v9, 2, v2
    v_lshl_add_u32 v5, v9, 4, v8
    v_mov_b32 v6, 0x01010101
    v_mov_b32 v7, 0
    s_add_u32 s12, s8, 12845056
    s_addc_u32 s13, s9, 0
    s_add_u32 s14, s12, s44
    s_addc_u32 s15, s13, 0
    s_add_u32 s12, s12, s43
    s_addc_u32 s13, s13, 0
    s_lshl_b32 s42, s22, 8
    s_lshl_b32 s43, s3, 2
    s_add_u32 s42, s42, s43
    s_add_u32 s16, s8, 43962368
    s_addc_u32 s17, s9, 0
    s_add_u32 s16, s16, s42
    s_addc_u32 s17, s17, 0
L_tv_item:
    s_waitcnt vmcnt(0)
    s_barrier
    s_cmp_lt_u32 s5, 4
    s_cbranch_scc1 L_tv_nofl
    s_cmp_lg_u32 s4, 0
    s_cbranch_scc1 L_fs1
    global_store_dword v7, v6, s[16:17] sc1
L_fs1:
    s_add_u32 s16, s16, 1024
    s_addc_u32 s17, s17, 0
L_tv_nofl:
    s_cmp_ge_u32 s5, 64
    s_cbranch_scc1 L_tv_w
    s_xor_b32 s23, s23, 0x8000
    s_cmp_ge_u32 s5, 60
    s_cbranch_scc1 L_tv_nox
    s_add_u32 s40, s20, s80
    s_addc_u32 s41, s21, 0
    s_add_u32 m0, s23, 0
    s_nop 0
    global_load_lds_dwordx4 v60, s[40:41]
    s_add_u32 s40, s20, s81
    s_addc_u32 s41, s21, 0
    s_add_u32 m0, s23, 1024
    s_nop 0
    global_load_lds_dwordx4 v60, s[40:41]
    s_add_u32 s40, s20, s82
    s_addc_u32 s41, s21, 0
    s_add_u32 m0, s23, 2048
    s_nop 0
    global_load_lds_dwordx4 v60, s[40:41]
    s_add_u32 s40, s20, s83
    s_addc_u32 s41, s21, 0
    s_add_u32 m0, s23, 3072
    s_nop 0
    global_load_lds_dwordx4 v60, s[40:41]
    s_add_u32 s40, s20, s84
    s_addc_u32 s41, s21, 0
    s_add_u32 m0, s23, 4096
    s_nop 0
    global_load_lds_dwordx4 v60, s[40:41]
    s_add_u32 s40, s20, s85
    s_addc_u32 s41, s21, 0
    s_add_u32 m0, s23, 5120
    s_nop 0
    global_load_lds_dwordx4 v60, s[40:41]
    s_add_u32 s40, s20, s86
    s_addc_u32 s41, s21, 0
    s_add_u32 m0, s23, 6144
    s_nop 0
    global_load_lds_dwordx4 v60, s[40:41]
    s_add_u32 s20, s20, 114688
    s_addc_u32 s21, s21, 0
L_tv_nox:
    ds_read_b128 v[32:35], v4 offset:0
    ds_read_b128 v[36:39], v5 offset:512
    ds_read_b128 v[40:43], v4 offset:2048
    ds_read_b128 v[44:47], v5 offset:2560
    s_waitcnt lgkmcnt(3)
    v_mfma_f32_16x16x32_bf16 v[64:67], v[32:35], a[0:3], 0
    ds_read_b128 v[48:51], v4 offset:4096
    v_mfma_f32_16x16x32_bf16 v[72:75], v[32:35], a[56:59], 0
    v_mfma_f32_16x16x32_bf16 v[80:83], v[32:35], a[112:115], 0
    v_mfma_f32_16x16x32_bf16 v[88:91], v[32:35], a[168:171], 0
    v_mfma_f32_16x16x32_bf16 v[96:99], v[32:35], a[224:227], 0
    v_mfma_f32_16x16x32_bf16 v[104:107], v[32:35], v[200:203], 0
    v_mfma_f32_16x16x32_bf16 v[112:115], v[32:35], v[120:123], 0
    s_waitcnt lgkmcnt(3)
    v_mfma_f32_16x16x32_bf16 v[68:71], v[36:39], a[0:3], 0
    ds_read_b128 v[52:55], v5 offset:4608
    v_mfma_f32_16x16x32_bf16 v[76:79], v[36:39], a[56:59], 0
    v_mfma_f32_16x16x32_bf16 v[84:87], v[36:39], a[112:115], 0
    v_mfma_f32_16x16x32_bf16 v[92:95], v[36:39], a[168:171], 0
    v_mfma_f32_16x16x32_bf16 v[100:103], v[36:39], a[224:227], 0
    v_mfma_f32_16x16x32_bf16 v[108:111], v[36:39], v[200:203], 0
    v_mfma_f32_16x16x32_bf16 v[116:119], v[36:39], v[120:123], 0
    s_waitcnt lgkmcnt(3)
    v_mfma_f32_16x16x32_bf16 v[64:67], v[40:43], a[4:7], v[64:67]
    ds_read_b128 v[32:35], v4 offset:6144
    v_mfma_f32_16x16x32_bf16 v[72:75], v[40:43], a[60:63], v[72:75]
    v_mfma_f32_16x16x32_bf16 v[80:83], v[40:43], a[116:119], v[80:83]
    v_mfma_f32_16x16x32_bf16 v[88:91], v[40:43], a[172:175], v[88:91]
    v_mfma_f32_16x16x32_bf16 v[96:99], v[40:43], a[228:231], v[96:99]
    v_mfma_f32_16x16x32_bf16 v[104:107], v[40:43], v[204:207], v[104:107]
    v_mfma_f32_16x16x32_bf16 v[112:115], v[40:43], v[124:127], v[112:115]
    s_waitcnt lgkmcnt(3)
    v_mfma_f32_16x16x32_bf16 v[68:71], v[44:47], a[4:7], v[68:71]
    ds_read_b128 v[36:39], v5 offset:6656
    v_mfma_f32_16x16x32_bf16 v[76:79], v[44:47], a[60:63], v[76:79]
    v_mfma_f32_16x16x32_bf16 v[84:87], v[44:47], a[116:119], v[84:87]
    v_mfma_f32_16x16x32_bf16 v[92:95], v[44:47], a[172:175], v[92:95]
    v_mfma_f32_16x16x32_bf16 v[100:103], v[44:47], a[228:231], v[100:103]
    v_mfma_f32_16x16x32_bf16 v[108:111], v[44:47], v[204:207], v[108:111]
    v_mfma_f32_16x16x32_bf16 v[116:119], v[44:47], v[124:127], v[116:119]
    s_waitcnt lgkmcnt(3)
    v_mfma_f32_16x16x32_bf16 v[64:67], v[48:51], a[8:11], v[64:67]
    ds_read_b128 v[40:43], v4 offset:8192
    v_mfma_f32_16x16x32_bf16 v[72:75], v[48:51], a[64:67], v[72:75]
    v_mfma_f32_16x16x32_bf16 v[80:83], v[48:51], a[120:123], v[80:83]
    v_mfma_f32_16x16x32_bf16 v[88:91], v[48:51], a[176:179], v[88:91]
    v_mfma_f32_16x16x32_bf16 v[96:99], v[48:51], a[232:235], v[96:99]
    v_mfma_f32_16x16x32_bf16 v[104:107], v[48:51], v[208:211], v[104:107]
    v_mfma_f32_16x16x32_bf16 v[112:115], v[48:51], v[128:131], v[112:115]
    s_waitcnt lgkmcnt(3)
    v_mfma_f32_16x16x32_bf16 v[68:71], v[52:55], a[8:11], v[68:71]
    ds_read_b128 v[44:47], v5 offset:8704
    v_mfma_f32_16x16x32_bf16 v[76:79], v[52:55], a[64:67], v[76:79]
    v_mfma_f32_16x16x32_bf16 v[84:87], v[52:55], a[120:123], v[84:87]
    v_mfma_f32_16x16x32_bf16 v[92:95], v[52:55], a[176:179], v[92:95]
    v_mfma_f32_16x16x32_bf16 v[100:103], v[52:55], a[232:235], v[100:103]
    v_mfma_f32_16x16x32_bf16 v[108:111], v[52:55], v[208:211], v[108:111]
    v_mfma_f32_16x16x32_bf16 v[116:119], v[52:55], v[128:131], v[116:119]
    s_waitcnt lgkmcnt(3)
    v_mfma_f32_16x16x32_bf16 v[64:67], v[32:35], a[12:15], v[64:67]
    ds_read_b128 v[48:51], v4 offset:10240
    v_mfma_f32_16x16x32_bf16 v[72:75], v[32:35], a[68:71], v[72:75]
    v_mfma_f32_16x16x32_bf16 v[80:83], v[32:35], a[124:127], v[80:83]
    v_mfma_f32_16x16x32_bf16 v[88:91], v[32:35], a[180:183], v[88:91]
    v_mfma_f32_16x16x32_bf16 v[96:99], v[32:35], a[236:239], v[96:99]
    v_mfma_f32_16x16x32_bf16 v[104:107], v[32:35], v[212:215], v[104:107]
    v_mfma_f32_16x16x32_bf16 v[112:115], v[32:35], v[132:135], v[112:115]
    s_waitcnt lgkmcnt(3)
    v_mfma_f32_16x16x32_bf16 v[68:71], v[36:39], a[12:15], v[68:71]
    ds_read_b128 v[52:55], v5 offset:10752
    v_mfma_f32_16x16x32_bf16 v[76:79], v[36:39], a[68:71], v[76:79]
    v_mfma_f32_16x16x32_bf16 v[84:87], v[36:39], a[124:127], v[84:87]
    v_mfma_f32_16x16x32_bf16 v[92:95], v[36:39], a[180:183], v[92:95]
    v_mfma_f32_16x16x32_bf16 v[100:103], v[36:39], a[236:239], v[100:103]
    v_mfma_f32_16x16x32_bf16 v[108:111], v[36:39], v[212:215], v[108:111]
    v_mfma_f32_16x16x32_bf16 v[116:119], v[36:39], v[132:135], v[116:119]
    s_waitcnt lgkmcnt(3)
    v_mfma_f32_16x16x32_bf16 v[64:67], v[40:43], a[16:19], v[64:67]
    ds_read_b128 v[32:35], v4 offset:12288
    v_mfma_f32_16x16x32_bf16 v[72:75], v[40:43], a[72:75], v[72:75]
    v_mfma_f32_16x16x32_bf16 v[80:83], v[40:43], a[128:131], v[80:83]
    v_mfma_f32_16x16x32_bf16 v[88:91], v[40:43], a[184:187], v[88:91]
    v_mfma_f32_16x16x32_bf16 v[96:99], v[40:43], a[240:243], v[96:99]
    v_mfma_f32_16x16x32_bf16 v[104:107], v[40:43], v[216:219], v[104:107]
    v_mfma_f32_16x16x32_bf16 v[112:115], v[40:43], v[136:139], v[112:115]
    s_waitcnt lgkmcnt(3)
    v_mfma_f32_16x16x32_bf16 v[68:71], v[44:47], a[16:19], v[68:71]
    ds_read_b128 v[36:39], v5 offset:12800
    v_mfma_f32_16x16x32_bf16 v[76:79], v[44:47], a[72:75], v[76:79]
    v_mfma_f32_16x16x32_bf16 v[84:87], v[44:47], a[128:131], v[84:87]
    v_mfma_f32_16x16x32_bf16 v[92:95], v[44:47], a[184:187], v[92:95]
    v_mfma_f32_16x16x32_bf16 v[100:103], v[44:47], a[240:243], v[100:103]
    v_mfma_f32_16x16x32_bf16 v[108:111], v[44:47], v[216:219], v[108:111]
    v_mfma_f32_16x16x32_bf16 v[116:119], v[44:47], v[136:139], v[116:119]
    s_waitcnt lgkmcnt(3)
    v_mfma_f32_16x16x32_bf16 v[64:67], v[48:51], a[20:23], v[64:67]
    ds_read_b128 v[40:43], v4 offset:14336
    v_mfma_f32_16x16x32_bf16 v[72:75], v[48:51], a[76:79], v[72:75]
    v_mfma_f32_16x16x32_bf16 v[80:83], v[48:51], a[132:135], v[80:83]
    v_mfma_f32_16x16x32_bf16 v[88:91], v[48:51], a[188:191], v[88:91]
    v_mfma_f32_16x16x32_bf16 v[96:99], v[48:51], a[244:247], v[96:99]
    v_mfma_f32_16x16x32_bf16 v[104:107], v[48:51], v[220:223], v[104:107]
    v_mfma_f32_16x16x32_bf16 v[112:115], v[48:51], v[140:143], v[112:115]
    s_waitcnt lgkmcnt(3)
    v_mfma_f32_16x16x32_bf16 v[68:71], v[52:55], a[20:23], v[68:71]
    ds_read_b128 v[44:47], v5 offset:14848
    v_mfma_f32_16x16x32_bf16 v[76:79], v[52:55], a[76:79], v[76:79]
    v_mfma_f32_16x16x32_bf16 v[84:87], v[52:55], a[132:135], v[84:87]
    v_mfma_f32_16x16x32_bf16 v[92:95], v[52:55], a[188:191], v[92:95]
    v_mfma_f32_16x16x32_bf16 v[100:103], v[52:55], a[244:247], v[100:103]
    v_mfma_f32_16x16x32_bf16 v[108:111], v[52:55], v[220:223], v[108:111]
    v_mfma_f32_16x16x32_bf16 v[116:119], v[52:55], v[140:143], v[116:119]
    s_waitcnt lgkmcnt(3)
    v_mfma_f32_16x16x32_bf16 v[64:67], v[32:35], a[24:27], v[64:67]
    ds_read_b128 v[48:51], v4 offset:16384
    v_mfma_f32_16x16x32_bf16 v[72:75], v[32:35], a[80:83], v[72:75]
    v_mfma_f32_16x16x32_bf16 v[80:83], v[32:35], a[136:139], v[80:83]
    v_mfma_f32_16x16x32_bf16 v[88:91], v[32:35], a[192:195], v[88:91]
    v_mfma_f32_16x16x32_bf16 v[96:99], v[32:35], a[248:251], v[96:99]
    v_mfma_f32_16x16x32_bf16 v[104:107], v[32:35], v[224:227], v[104:107]
    v_mfma_f32_16x16x32_bf16 v[112:115], v[32:35], v[144:147], v[112:115]
    s_waitcnt lgkmcnt(3)
    v_mfma_f32_16x16x32_bf16 v[68:71], v[36:39], a[24:27], v[68:71]
    ds_read_b128 v[52:55], v5 offset:16896
    v_mfma_f32_16x16x32_bf16 v[76:79], v[36:39], a[80:83], v[76:79]
    v_mfma_f32_16x16x32_bf16 v[84:87], v[36:39], a[136:139], v[84:87]
    v_mfma_f32_16x16x32_bf16 v[92:95], v[36:39], a[192:195], v[92:95]
    v_mfma_f32_16x16x32_bf16 v[100:103], v[36:39], a[248:251], v[100:103]
    v_mfma_f32_16x16x32_bf16 v[108:111], v[36:39], v[224:227], v[108:111]
    v_mfma_f32_16x16x32_bf16 v[116:119], v[36:39], v[144:147], v[116:119]
    s_waitcnt lgkmcnt(3)
    v_mfma_f32_16x16x32_bf16 v[64:67], v[40:43], a[28:31], v[64:67]
    ds_read_b128 v[32:35], v4 offset:18432
    v_mfma_f32_16x16x32_bf16 v[72:75], v[40:43], a[84:87], v[72:75]
    v_mfma_f32_16x16x32_bf16 v[80:83], v[40:43], a[140:143], v[80:83]
    v_mfma_f32_16x16x32_bf16 v[88:91], v[40:43], a[196:199], v[88:91]
    v_mfma_f32_16x16x32_bf16 v[96:99], v[40:43], a[252:255], v[96:99]
    v_mfma_f32_16x16x32_bf16 v[104:107], v[40:43], v[228:231], v[104:107]
    v_mfma_f32_16x16x32_bf16 v[112:115], v[40:43], v[148:151], v[112:115]
    s_waitcnt lgkmcnt(3)
    v_mfma_f32_16x16x32_bf16 v[68:71], v[44:47], a[28:31], v[68:71]
    ds_read_b128 v[36:39], v5 offset:18944
    v_mfma_f32_16x16x32_bf16 v[76:79], v[44:47], a[84:87], v[76:79]
    v_mfma_f32_16x16x32_bf16 v[84:87], v[44:47], a[140:143], v[84:87]
    v_mfma_f32_16x16x32_bf16 v[92:95], v[44:47], a[196:199], v[92:95]
    v_mfma_f32_16x16x32_bf16 v[100:103], v[44:47], a[252:255], v[100:103]
    v_mfma_f32_16x16x32_bf16 v[108:111], v[44:47], v[228:231], v[108:111]
    v_mfma_f32_16x16x32_bf16 v[116:119], v[44:47], v[148:151], v[116:119]
    s_waitcnt lgkmcnt(3)
    v_mfma_f32_16x16x32_bf16 v[64:67], v[48:51], a[32:35], v[64:67]
    ds_read_b128 v[40:43], v4 offset:20480
    v_mfma_f32_16x16x32_bf16 v[72:75], v[48:51], a[88:91], v[72:75]
    v_mfma_f32_16x16x32_bf16 v[80:83], v[48:51], a[144:147], v[80:83]
    v_mfma_f32_16x16x32_bf16 v[88:91], v[48:51], a[200:203], v[88:91]
    v_mfma_f32_16x16x32_bf16 v[96:99], v[48:51], v[176:179], v[96:99]
    v_mfma_f32_16x16x32_bf16 v[104:107], v[48:51], v[232:235], v[104:107]
    v_mfma_f32_16x16x32_bf16 v[112:115], v[48:51], v[152:155], v[112:115]
    s_waitcnt lgkmcnt(3)
    v_mfma_f32_16x16x32_bf16 v[68:71], v[52:55], a[32:35], v[68:71]
    ds_read_b128 v[44:47], v5 offset:20992
    v_mfma_f32_16x16x32_bf16 v[76:79], v[52:55], a[88:91], v[76:79]
    v_mfma_f32_16x16x32_bf16 v[84:87], v[52:55], a[144:147], v[84:87]
    v_mfma_f32_16x16x32_bf16 v[92:95], v[52:55], a[200:203], v[92:95]
    v_mfma_f32_16x16x32_bf16 v[100:103], v[52:55], v[176:179], v[100:103]
    v_mfma_f32_16x16x32_bf16 v[108:111], v[52:55], v[232:235], v[108:111]
    v_mfma_f32_16x16x32_bf16 v[116:119], v[52:55], v[152:155], v[116:119]
    s_waitcnt lgkmcnt(3)
    v_mfma_f32_16x16x32_bf16 v[64:67], v[32:35], a[36:39], v[64:67]
    ds_read_b128 v[48:51], v4 offset:22528
    v_mfma_f32_16x16x32_bf16 v[72:75], v[32:35], a[92:95], v[72:75]
    v_mfma_f32_16x16x32_bf16 v[80:83], v[32:35], a[148:151], v[80:83]
    v_mfma_f32_16x16x32_bf16 v[88:91], v[32:35], a[204:207], v[88:91]
    v_mfma_f32_16x16x32_bf16 v[96:99], v[32:35], v[180:183], v[96:99]
    v_mfma_f32_16x16x32_bf16 v[104:107], v[32:35], v[236:239], v[104:107]
    v_mfma_f32_16x16x32_bf16 v[112:115], v[32:35], v[156:159], v[112:115]
    s_waitcnt lgkmcnt(3)
    v_mfma_f32_16x16x32_bf16 v[68:71], v[36:39], a[36:39], v[68:71]
    ds_read_b128 v[52:55], v5 offset:23040
    v_mfma_f32_16x16x32_bf16 v[76:79], v[36:39], a[92:95], v[76:79]
    v_mfma_f32_16x16x32_bf16 v[84:87], v[36:39], a[148:151], v[84:87]
    v_mfma_f32_16x16x32_bf16 v[92:95], v[36:39], a[204:207], v[92:95]
    v_mfma_f32_16x16x32_bf16 v[100:103], v[36:39], v[180:183], v[100:103]
    v_mfma_f32_16x16x32_bf16 v[108:111], v[36:39], v[236:239], v[108:111]
    v_mfma_f32_16x16x32_bf16 v[116:119], v[36:39], v[156:159], v[116:119]
    s_waitcnt lgkmcnt(3)
    v_mfma_f32_16x16x32_bf16 v[64:67], v[40:43], a[40:43], v[64:67]
    ds_read_b128 v[32:35], v4 offset:24576
    v_mfma_f32_16x16x32_bf16 v[72:75], v[40:43], a[96:99], v[72:75]
    v_mfma_f32_16x16x32_bf16 v[80:83], v[40:43], a[152:155], v[80:83]
    v_mfma_f32_16x16x32_bf16 v[88:91], v[40:43], a[208:211], v[88:91]
    v_mfma_f32_16x16x32_bf16 v[96:99], v[40:43], v[184:187], v[96:99]
    v_mfma_f32_16x16x32_bf16 v[104:107], v[40:43], v[240:243], v[104:107]
    v_mfma_f32_16x16x32_bf16 v[112:115], v[40:43], v[160:163], v[112:115]
    s_waitcnt lgkmcnt(3)
    v_mfma_f32_16x16x32_bf16 v[68:71], v[44:47], a[40:43], v[68:71]
    ds_read_b128 v[36:39], v5 offset:25088
    v_mfma_f32_16x16x32_bf16 v[76:79], v[44:47], a[96:99], v[76:79]
    v_mfma_f32_16x16x32_bf16 v[84:87], v[44:47], a[152:155], v[84:87]
    v_mfma_f32_16x16x32_bf16 v[92:95], v[44:47], a[208:211], v[92:95]
    v_mfma_f32_16x16x32_bf16 v[100:103], v[44:47], v[184:187], v[100:103]
    v_mfma_f32_16x16x32_bf16 v[108:111], v[44:47], v[240:243], v[108:111]
    v_mfma_f32_16x16x32_bf16 v[116:119], v[44:47], v[160:163], v[116:119]
    s_waitcnt lgkmcnt(3)
    v_mfma_f32_16x16x32_bf16 v[64:67], v[48:51], a[44:47], v[64:67]
    ds_read_b128 v[40:43], v4 offset:26624
    v_mfma_f32_16x16x32_bf16 v[72:75], v[48:51], a[100:103], v[72:75]
    v_mfma_f32_16x16x32_bf16 v[80:83], v[48:51], a[156:159], v[80:83]
    v_mfma_f32_16x16x32_bf16 v[88:91], v[48:51], a[212:215], v[88:91]
    v_mfma_f32_16x16x32_bf16 v[96:99], v[48:51], v[188:191], v[96:99]
    v_mfma_f32_16x16x32_bf16 v[104:107], v[48:51], v[244:247], v[104:107]
    v_mfma_f32_16x16x32_bf16 v[112:115], v[48:51], v[164:167], v[112:115]
    s_waitcnt lgkmcnt(3)
    v_mfma_f32_16x16x32_bf16 v[68:71], v[52:55], a[44:47], v[68:71]
    ds_read_b128 v[44:47], v5 offset:27136
    v_mfma_f32_16x16x32_bf16 v[76:79], v[52:55], a[100:103], v[76:79]
    v_mfma_f32_16x16x32_bf16 v[84:87], v[52:55], a[156:159], v[84:87]
    v_mfma_f32_16x16x32_bf16 v[92:95], v[52:55], a[212:215], v[92:95]
    v_mfma_f32_16x16x32_bf16 v[100:103], v[52:55], v[188:191], v[100:103]
    v_mfma_f32_16x16x32_bf16 v[108:111], v[52:55], v[244:247], v[108:111]
    v_mfma_f32_16x16x32_bf16 v[116:119], v[52:55], v[164:167], v[116:119]
    s_waitcnt lgkmcnt(3)
    v_mfma_f32_16x16x32_bf16 v[64:67], v[32:35], a[48:51], v[64:67]
    v_mfma_f32_16x16x32_bf16 v[72:75], v[32:35], a[104:107], v[72:75]
    v_mfma_f32_16x16x32_bf16 v[80:83], v[32:35], a[160:163], v[80:83]
    v_mfma_f32_16x16x32_bf16 v[88:91], v[32:35], a[216:219], v[88:91]
    v_mfma_f32_16x16x32_bf16 v[96:99], v[32:35], v[192:195], v[96:99]
    v_mfma_f32_16x16x32_bf16 v[104:107], v[32:35], v[248:251], v[104:107]
    v_mfma_f32_16x16x32_bf16 v[112:115], v[32:35], v[168:171], v[112:115]
    s_waitcnt lgkmcnt(2)
    v_mfma_f32_16x16x32_bf16 v[68:71], v[36:39], a[48:51], v[68:71]
    v_mfma_f32_16x16x32_bf16 v[76:79], v[36:39], a[104:107], v[76:79]
    v_mfma_f32_16x16x32_bf16 v[84:87], v[36:39], a[160:163], v[84:87]
    v_mfma_f32_16x16x32_bf16 v[92:95], v[36:39], a[216:219], v[92:95]
    v_mfma_f32_16x16x32_bf16 v[100:103], v[36:39], v[192:195], v[100:103]
    v_mfma_f32_16x16x32_bf16 v[108:111], v[36:39], v[248:251], v[108:111]
    v_mfma_f32_16x16x32_bf16 v[116:119], v[36:39], v[168:171], v[116:119]
    s_waitcnt lgkmcnt(1)
    v_mfma_f32_16x16x32_bf16 v[64:67], v[40:43], a[52:55], v[64:67]
    v_mfma_f32_16x16x32_bf16 v[72:75], v[40:43], a[108:111], v[72:75]
    v_mfma_f32_16x16x32_bf16 v[80:83], v[40:43], a[164:167], v[80:83]
    v_mfma_f32_16x16x32_bf16 v[88:91], v[40:43], a[220:223], v[88:91]
    v_mfma_f32_16x16x32_bf16 v[96:99], v[40:43], v[196:199], v[96:99]
    v_mfma_f32_16x16x32_bf16 v[104:107], v[40:43], v[252:255], v[104:107]
    v_mfma_f32_16x16x32_bf16 v[112:115], v[40:43], v[172:175], v[112:115]
    s_waitcnt lgkmcnt(0)
    v_mfma_f32_16x16x32_bf16 v[68:71], v[44:47], a[52:55], v[68:71]
    v_mfma_f32_16x16x32_bf16 v[76:79], v[44:47], a[108:111], v[76:79]
    v_mfma_f32_16x16x32_bf16 v[84:87], v[44:47], a[164:167], v[84:87]
    v_mfma_f32_16x16x32_bf16 v[92:95], v[44:47], a[220:223], v[92:95]
    v_mfma_f32_16x16x32_bf16 v[100:103], v[44:47], v[196:199], v[100:103]
    v_mfma_f32_16x16x32_bf16 v[108:111], v[44:47], v[252:255], v[108:111]
    v_mfma_f32_16x16x32_bf16 v[116:119], v[44:47], v[172:175], v[116:119]
    v_xor_b32 v5, 0x8000, v5
    v_xor_b32 v4, 0x8000, v4
    v_cvt_pk_bf16_f32 v8, v64, v65
    v_cvt_pk_bf16_f32 v9, v68, v69
    v_cvt_pk_bf16_f32 v10, v66, v67
    v_cvt_pk_bf16_f32 v11, v70, v71
    global_store_dwordx4 v3, v[8:11], s[12:13] offset:0 sc1
    v_cvt_pk_bf16_f32 v12, v72, v73
    v_cvt_pk_bf16_f32 v13, v76, v77
    v_cvt_pk_bf16_f32 v14, v74, v75
    v_cvt_pk_bf16_f32 v15, v78, v79
    global_store_dwordx4 v3, v[12:15], s[12:13] offset:1024 sc1
    v_cvt_pk_bf16_f32 v16, v80, v81
    v_cvt_pk_bf16_f32 v17, v84, v85
    v_cvt_pk_bf16_f32 v18, v82, v83
    v_cvt_pk_bf16_f32 v19, v86, v87
    s_add_u32 s40, s12, 32768
    s_addc_u32 s41, s13, 0
    global_store_dwordx4 v3, v[16:19], s[40:41] offset:0 sc1
    v_cvt_pk_bf16_f32 v20, v88, v89
    v_cvt_pk_bf16_f32 v21, v92, v93
    v_cvt_pk_bf16_f32 v22, v90, v91
    v_cvt_pk_bf16_f32 v23, v94, v95
    global_store_dwordx4 v3, v[20:23], s[40:41] offset:1024 sc1
    v_cvt_pk_bf16_f32 v8, v96, v97
    v_cvt_pk_bf16_f32 v9, v100, v101
    v_cvt_pk_bf16_f32 v10, v98, v99
    v_cvt_pk_bf16_f32 v11, v102, v103
    s_add_u32 s40, s40, 32768
    s_addc_u32 s41, s41, 0
    global_store_dwordx4 v3, v[8:11], s[40:41] offset:0 sc1
    v_cvt_pk_bf16_f32 v12, v104, v105
    v_cvt_pk_bf16_f32 v13, v108, v109
    v_cvt_pk_bf16_f32 v14, v106, v107
    v_cvt_pk_bf16_f32 v15, v110, v111
    global_store_dwordx4 v3, v[12:15], s[40:41] offset:1024 sc1
    v_cvt_pk_bf16_f32 v16, v112, v113
    v_cvt_pk_bf16_f32 v17, v116, v117
    v_cvt_pk_bf16_f32 v18, v114, v115
    v_cvt_pk_bf16_f32 v19, v118, v119
    global_store_dwordx4 v3, v[16:19], s[14:15] sc1
    s_add_u32 s12, s12, 1835008
    s_addc_u32 s13, s13, 0
    s_add_u32 s14, s14, 1835008
    s_addc_u32 s15, s15, 0
    s_add_u32 s5, s5, 4
    s_branch L_tv_item
L_tv_w:
    s_cmp_lg_u32 s4, 0
    s_cbranch_scc1 L_tw_rb
    s_add_u32 s40, s8, 43982848
    s_addc_u32 s41, s9, 0
    v_lshrrev_b32 v8, 1, v0
    v_and_b32 v9, 1, v0
    v_lshlrev_b32 v9, 4, v9
    v_lshl_add_u32 v8, v8, 7, v9
    s_mov_b32 s42, 0
L_tw_rp:
    global_load_dwordx4 v[10:13], v8, s[40:41] sc1
    s_add_u32 s42, s42, 1
    s_cmp_gt_u32 s42, 1048576
    s_cbranch_scc1 L_bail
    s_waitcnt vmcnt(0)
    v_min_u32 v10, v10, v11
    v_min_u32 v10, v10, v12
    v_min_u32 v10, v10, v13
    v_cmp_eq_u32 vcc, 0, v10
    s_cbranch_vccz L_tw_rb
    s_sleep 2
    s_branch L_tw_rp
L_tw_rb:
    s_barrier
    s_mul_i32 s40, s4, 1792
    v_add_u32 v56, s40, v3
    v_min_u32 v57, 47, v0
    v_lshlrev_b32 v57, 4, v57
    v_add3_u32 v57, v57, s40, s40
    v_subrev_u32 v57, s40, v57
    v_add_u32 v57, 1024, v57
    s_and_b32 s46, s4, 1
    s_lshr_b32 s41, s4, 1
    s_mul_i32 s41, s41, 7
    s_lshl_b32 s40, s46, 2
    s_add_u32 s40, s40, s41
    s_add_u32 s41, s41, 3
    s_sub_u32 s24, 0, s46
    s_mov_b32 s25, s24
    s_mov_b32 s5, s22
    v_lshrrev_b32 v8, 1, v2
    v_lshlrev_b32 v8, 7, v8
    v_and_b32 v9, 7, v0
    v_lshl_add_u32 v8, v9, 4, v8
    v_and_b32 v9, 1, v2
    v_lshl_add_u32 v8, v9, 3, v8
    v_add_u32 v58, 57344, v8
    s_and_b32 s42, s3, 3
    s_lshl_b32 s42, s42, 8
    v_lshl_add_u32 v8, v1, 4, s42
    v_lshl_add_u32 v59, v9, 3, v8
    s_mul_i32 s42, s22, 114688
    s_lshr_b32 s43, s3, 2
    s_mul_i32 s43, s43, 28672
    s_add_u32 s42, s42, s43
    s_lshl_b32 s43, s40, 11
    s_add_u32 s43, s43, s42
    s_lshl_b32 s44, s41, 11
    s_add_u32 s44, s44, s42
    s_and_b32 s45, s4, 1
    s_lshl_b32 s45, s45, 10
    s_add_u32 s44, s44, s45
    s_add_u32 s12, s8, 54013952
    s_addc_u32 s13, s9, 0
    s_add_u32 s14, s12, s44
    s_addc_u32 s15, s13, 0
    s_add_u32 s12, s12, s43
    s_addc_u32 s13, s13, 0
    s_lshl_b32 s42, s22, 10
    s_lshr_b32 s43, s3, 2
    s_lshl_b32 s43, s43, 7
    s_add_u32 s42, s42, s43
    s_and_b32 s43, s3, 3
    s_lshl_b32 s43, s43, 2
    s_add_u32 s42, s42, s43
    s_add_u32 s16, s8, 43987456
    s_addc_u32 s17, s9, 0
    s_add_u32 s16, s16, s42
    s_addc_u32 s17, s17, 0
    s_mul_i32 s42, s22, 7168
    s_add_u32 s18, s8, 42778624
    s_addc_u32 s19, s9, 0
    s_add_u32 s18, s18, s42
    s_addc_u32 s19, s19, 0
L_tw_item:
    s_cmp_lg_u32 s4, 0
    s_cbranch_scc1 L_tw_mh
    v_mov_b32 v8, 4000
L_tw_ml:
    global_load_dword v9, v8, s[18:19] sc1
    s_add_u32 s6, s6, 1
    s_cmp_gt_u32 s6, 1048576
    s_cbranch_scc1 L_bail
    s_waitcnt vmcnt(0)
    v_cmp_eq_u32 vcc, s7, v9
    s_cbranch_vccz L_tw_mh
    s_sleep 2
    s_branch L_tw_ml
L_tw_mh:
    s_barrier
L_tw_mf:
    global_load_dwordx4 v[8:11], v56, s[18:19] sc1
    global_load_dwordx4 v[12:15], v57, s[18:19] sc1
    s_add_u32 s6, s6, 1
    s_cmp_gt_u32 s6, 1048576
    s_cbranch_scc1 L_bail
    s_waitcnt vmcnt(0)
    v_max3_u32 v16, v8, v9, v10
    v_max3_u32 v16, v16, v11, v12
    v_max3_u32 v16, v16, v13, v14
    v_max_u32 v16, v16, v15
    v_cmp_eq_u32 vcc, s7, v16
    s_cbranch_vccnz L_tw_mf
    ds_write_b128 v56, v[8:11] offset:57344
    ds_write_b128 v57, v[12:15] offset:57344
    s_waitcnt lgkmcnt(0)
    s_barrier
    ds_read2_b64 v[64:67], v58 offset0:0 offset1:32
    ds_read2_b64 v[68:71], v58 offset0:64 offset1:96
    ds_read2_b64 v[72:75], v58 offset0:128 offset1:160
    v_add_u32 v58, 1536, v58
    ds_read2_b64 v[76:79], v58 offset0:0 offset1:32
    ds_read2_b64 v[80:83], v58 offset0:64 offset1:96
    ds_read2_b64 v[84:87], v58 offset0:128 offset1:160
    v_add_u32 v58, 1536, v58
    ds_read2_b64 v[88:91], v58 offset0:0 offset1:32
    ds_read2_b64 v[92:95], v58 offset0:64 offset1:96
    ds_read2_b64 v[96:99], v58 offset0:128 offset1:160
    v_add_u32 v58, 1536, v58
    ds_read2_b64 v[100:103], v58 offset0:0 offset1:32
    ds_read2_b64 v[104:107], v58 offset0:64 offset1:96
    ds_read2_b64 v[108:111], v58 offset0:128 offset1:160
    v_add_u32 v58, 1536, v58
    ds_read2_b64 v[112:115], v58 offset0:0 offset1:32
    ds_read2_b64 v[116:119], v58 offset0:64 offset1:96
    v_subrev_u32 v58, 6144, v58
    s_add_u32 s40, s12, 4096
    s_addc_u32 s41, s13, 0
    s_waitcnt lgkmcnt(13)
    v_mfma_f32_16x16x32_bf16 v[32:35], v[64:67], a[0:3], 0
    s_waitcnt lgkmcnt(12)
    v_mfma_f32_16x16x32_bf16 v[32:35], v[68:71], a[4:7], v[32:35]
    s_waitcnt lgkmcnt(11)
    v_mfma_f32_16x16x32_bf16 v[32:35], v[72:75], a[8:11], v[32:35]
    s_waitcnt lgkmcnt(10)
    v_mfma_f32_16x16x32_bf16 v[32:35], v[76:79], a[12:15], v[32:35]
    s_waitcnt lgkmcnt(9)
    v_mfma_f32_16x16x32_bf16 v[32:35], v[80:83], a[16:19], v[32:35]
    s_waitcnt lgkmcnt(8)
    v_mfma_f32_16x16x32_bf16 v[32:35], v[84:87], a[20:23], v[32:35]
    s_waitcnt lgkmcnt(7)
    v_mfma_f32_16x16x32_bf16 v[32:35], v[88:91], a[24:27], v[32:35]
    s_waitcnt lgkmcnt(6)
    v_mfma_f32_16x16x32_bf16 v[32:35], v[92:95], a[28:31], v[32:35]
    s_waitcnt lgkmcnt(5)
    v_mfma_f32_16x16x32_bf16 v[32:35], v[96:99], a[32:35], v[32:35]
    s_waitcnt lgkmcnt(4)
    v_mfma_f32_16x16x32_bf16 v[32:35], v[100:103], a[36:39], v[32:35]
    s_waitcnt lgkmcnt(3)
    v_mfma_f32_16x16x32_bf16 v[32:35], v[104:107], a[40:43], v[32:35]
    s_waitcnt lgkmcnt(2)
    v_mfma_f32_16x16x32_bf16 v[32:35], v[108:111], a[44:47], v[32:35]
    s_waitcnt lgkmcnt(1)
    v_mfma_f32_16x16x32_bf16 v[32:35], v[112:115], a[48:51], v[32:35]
    s_waitcnt lgkmcnt(0)
    v_mfma_f32_16x16x32_bf16 v[32:35], v[116:119], a[52:55], v[32:35]
    v_mfma_f32_16x16x32_bf16 v[36:39], v[64:67], a[56:59], 0
    v_mfma_f32_16x16x32_bf16 v[36:39], v[68:71], a[60:63], v[36:39]
    v_mfma_f32_16x16x32_bf16 v[36:39], v[72:75], a[64:67], v[36:39]
    v_cvt_pk_bf16_f32 v8, v32, v33
    v_cvt_pk_bf16_f32 v9, v34, v35
    s_mov_b32 exec_hi, 0
    global_store_dwordx2 v59, v[8:9], s[12:13] offset:0 sc1
    s_mov_b64 exec, -1
    v_mfma_f32_16x16x32_bf16 v[36:39], v[76:79], a[68:71], v[36:39]
    v_mfma_f32_16x16x32_bf16 v[36:39], v[80:83], a[72:75], v[36:39]
    v_mfma_f32_16x16x32_bf16 v[36:39], v[84:87], a[76:79], v[36:39]
    v_mfma_f32_16x16x32_bf16 v[36:39], v[88:91], a[80:83], v[36:39]
    v_mfma_f32_16x16x32_bf16 v[36:39], v[92:95], a[84:87], v[36:39]
    v_mfma_f32_16x16x32_bf16 v[36:39], v[96:99], a[88:91], v[36:39]
    v_mfma_f32_16x16x32_bf16 v[36:39], v[100:103], a[92:95], v[36:39]
    v_mfma_f32_16x16x32_bf16 v[36:39], v[104:107], a[96:99], v[36:39]
    v_mfma_f32_16x16x32_bf16 v[36:39], v[108:111], a[100:103], v[36:39]
    v_mfma_f32_16x16x32_bf16 v[36:39], v[112:115], a[104:107], v[36:39]
    v_mfma_f32_16x16x32_bf16 v[36:39], v[116:119], a[108:111], v[36:39]
    v_mfma_f32_16x16x32_bf16 v[32:35], v[64:67], a[112:115], 0
    v_mfma_f32_16x16x32_bf16 v[32:35], v[68:71], a[116:119], v[32:35]
    v_mfma_f32_16x16x32_bf16 v[32:35], v[72:75], a[120:123], v[32:35]
    v_cvt_pk_bf16_f32 v10, v36, v37
    v_cvt_pk_bf16_f32 v11, v38, v39
    s_mov_b32 exec_hi, 0
    global_store_dwordx2 v59, v[10:11], s[12:13] offset:1024 sc1
    s_mov_b64 exec, -1
    v_mfma_f32_16x16x32_bf16 v[32:35], v[76:79], a[124:127], v[32:35]
    v_mfma_f32_16x16x32_bf16 v[32:35], v[80:83], a[128:131], v[32:35]
    v_mfma_f32_16x16x32_bf16 v[32:35], v[84:87], a[132:135], v[32:35]
    v_mfma_f32_16x16x32_bf16 v[32:35], v[88:91], a[136:139], v[32:35]
    v_mfma_f32_16x16x32_bf16 v[32:35], v[92:95], a[140:143], v[32:35]
    v_mfma_f32_16x16x32_bf16 v[32:35], v[96:99], a[144:147], v[32:35]
    v_mfma_f32_16x16x32_bf16 v[32:35], v[100:103], a[148:151], v[32:35]
    v_mfma_f32_16x16x32_bf16 v[32:35], v[104:107], a[152:155], v[32:35]
    v_mfma_f32_16x16x32_bf16 v[32:35], v[108:111], a[156:159], v[32:35]
    v_mfma_f32_16x16x32_bf16 v[32:35], v[112:115], a[160:163], v[32:35]
    v_mfma_f32_16x16x32_bf16 v[32:35], v[116:119], a[164:167], v[32:35]
    v_mfma_f32_16x16x32_bf16 v[36:39], v[64:67], a[168:171], 0
    v_mfma_f32_16x16x32_bf16 v[36:39], v[68:71], a[172:175], v[36:39]
    v_mfma_f32_16x16x32_bf16 v[36:39], v[72:75], a[176:179], v[36:39]
    v_cvt_pk_bf16_f32 v12, v32, v33
    v_cvt_pk_bf16_f32 v13, v34, v35
    s_mov_b32 exec_hi, 0
    global_store_dwordx2 v59, v[12:13], s[12:13] offset:2048 sc1
    s_mov_b64 exec, -1
    v_mfma_f32_16x16x32_bf16 v[36:39], v[76:79], a[180:183], v[36:39]
    v_mfma_f32_16x16x32_bf16 v[36:39], v[80:83], a[184:187], v[36:39]
    v_mfma_f32_16x16x32_bf16 v[36:39], v[84:87], a[188:191], v[36:39]
    v_mfma_f32_16x16x32_bf16 v[36:39], v[88:91], a[192:195], v[36:39]
    v_mfma_f32_16x16x32_bf16 v[36:39], v[92:95], a[196:199], v[36:39]
    v_mfma_f32_16x16x32_bf16 v[36:39], v[96:99], a[200:203], v[36:39]
    v_mfma_f32_16x16x32_bf16 v[36:39], v[100:103], a[204:207], v[36:39]
    v_mfma_f32_16x16x32_bf16 v[36:39], v[104:107], a[208:211], v[36:39]
    v_mfma_f32_16x16x32_bf16 v[36:39], v[108:111], a[212:215], v[36:39]
    v_mfma_f32_16x16x32_bf16 v[36:39], v[112:115], a[216:219], v[36:39]
    v_mfma_f32_16x16x32_bf16 v[36:39], v[116:119], a[220:223], v[36:39]
    v_mfma_f32_16x16x32_bf16 v[32:35], v[64:67], a[224:227], 0
    v_mfma_f32_16x16x32_bf16 v[32:35], v[68:71], a[228:231], v[32:35]
    v_mfma_f32_16x16x32_bf16 v[32:35], v[72:75], a[232:235], v[32:35]
    v_cvt_pk_bf16_f32 v14, v36, v37
    v_cvt_pk_bf16_f32 v15, v38, v39
    s_mov_b32 exec_hi, 0
    global_store_dwordx2 v59, v[14:15], s[12:13] offset:3072 sc1
    s_mov_b64 exec, -1
    v_mfma_f32_16x16x32_bf16 v[32:35], v[76:79], a[236:239], v[32:35]
    v_mfma_f32_16x16x32_bf16 v[32:35], v[80:83], a[240:243], v[32:35]
    v_mfma_f32_16x16x32_bf16 v[32:35], v[84:87], a[244:247], v[32:35]
    v_mfma_f32_16x16x32_bf16 v[32:35], v[88:91], a[248:251], v[32:35]
    v_mfma_f32_16x16x32_bf16 v[32:35], v[92:95], a[252:255], v[32:35]
    v_mfma_f32_16x16x32_bf16 v[32:35], v[96:99], v[176:179], v[32:35]
    v_mfma_f32_16x16x32_bf16 v[32:35], v[100:103], v[180:183], v[32:35]
    v_mfma_f32_16x16x32_bf16 v[32:35], v[104:107], v[184:187], v[32:35]
    v_mfma_f32_16x16x32_bf16 v[32:35], v[108:111], v[188:191], v[32:35]
    v_mfma_f32_16x16x32_bf16 v[32:35], v[112:115], v[192:195], v[32:35]
    v_mfma_f32_16x16x32_bf16 v[32:35], v[116:119], v[196:199], v[32:35]
    v_mfma_f32_16x16x32_bf16 v[36:39], v[64:67], v[200:203], 0
    v_mfma_f32_16x16x32_bf16 v[36:39], v[68:71], v[204:207], v[36:39]
    v_mfma_f32_16x16x32_bf16 v[36:39], v[72:75], v[208:211], v[36:39]
    v_cvt_pk_bf16_f32 v16, v32, v33
    v_cvt_pk_bf16_f32 v17, v34, v35
    s_mov_b32 exec_hi, 0
    global_store_dwordx2 v59, v[16:17], s[40:41] offset:0 sc1
    s_mov_b64 exec, -1
    v_mfma_f32_16x16x32_bf16 v[36:39], v[76:79], v[212:215], v[36:39]
    v_mfma_f32_16x16x32_bf16 v[36:39], v[80:83], v[216:219], v[36:39]
    v_mfma_f32_16x16x32_bf16 v[36:39], v[84:87], v[220:223], v[36:39]
    v_mfma_f32_16x16x32_bf16 v[36:39], v[88:91], v[224:227], v[36:39]
    v_mfma_f32_16x16x32_bf16 v[36:39], v[92:95], v[228:231], v[36:39]
    v_mfma_f32_16x16x32_bf16 v[36:39], v[96:99], v[232:235], v[36:39]
    v_mfma_f32_16x16x32_bf16 v[36:39], v[100:103], v[236:239], v[36:39]
    v_mfma_f32_16x16x32_bf16 v[36:39], v[104:107], v[240:243], v[36:39]
    v_mfma_f32_16x16x32_bf16 v[36:39], v[108:111], v[244:247], v[36:39]
    v_mfma_f32_16x16x32_bf16 v[36:39], v[112:115], v[248:251], v[36:39]
    v_mfma_f32_16x16x32_bf16 v[36:39], v[116:119], v[252:255], v[36:39]
    v_mfma_f32_16x16x32_bf16 v[32:35], v[64:67], v[120:123], 0
    v_mfma_f32_16x16x32_bf16 v[32:35], v[68:71], v[124:127], v[32:35]
    v_mfma_f32_16x16x32_bf16 v[32:35], v[72:75], v[128:131], v[32:35]
    v_cvt_pk_bf16_f32 v18, v36, v37
    v_cvt_pk_bf16_f32 v19, v38, v39
    s_mov_b32 exec_hi, 0
    global_store_dwordx2 v59, v[18:19], s[40:41] offset:1024 sc1
    s_mov_b64 exec, -1
    v_mfma_f32_16x16x32_bf16 v[32:35], v[76:79], v[132:135], v[32:35]
    v_mfma_f32_16x16x32_bf16 v[32:35], v[80:83], v[136:139], v[32:35]
    v_mfma_f32_16x16x32_bf16 v[32:35], v[84:87], v[140:143], v[32:35]
    v_mfma_f32_16x16x32_bf16 v[32:35], v[88:91], v[144:147], v[32:35]
    v_mfma_f32_16x16x32_bf16 v[32:35], v[92:95], v[148:151], v[32:35]
    v_mfma_f32_16x16x32_bf16 v[32:35], v[96:99], v[152:155], v[32:35]
    v_mfma_f32_16x16x32_bf16 v[32:35], v[100:103], v[156:159], v[32:35]
    v_mfma_f32_16x16x32_bf16 v[32:35], v[104:107], v[160:163], v[32:35]
    v_mfma_f32_16x16x32_bf16 v[32:35], v[108:111], v[164:167], v[32:35]
    v_mfma_f32_16x16x32_bf16 v[32:35], v[112:115], v[168:171], v[32:35]
    v_mfma_f32_16x16x32_bf16 v[32:35], v[116:119], v[172:175], v[32:35]
    s_nop 7
    v_cvt_pk_bf16_f32 v20, v32, v33
    v_cvt_pk_bf16_f32 v21, v34, v35
    s_mov_b32 exec_hi, 0
    global_store_dwordx2 v59, v[20:21], s[14:15] sc1
    s_mov_b64 exec, -1
    s_mov_b64 exec, -1
    s_waitcnt vmcnt(0)
    s_barrier
    s_cmp_lg_u32 s4, 0
    s_cbranch_scc1 L_fs2
    global_store_dword v7, v6, s[16:17] sc1
L_fs2:
    s_add_u32 s16, s16, 4096
    s_addc_u32 s17, s17, 0
    s_add_u32 s18, s18, 28672
    s_addc_u32 s19, s19, 0
    s_add_u32 s12, s12, 458752
    s_addc_u32 s13, s13, 0
    s_add_u32 s14, s14, 458752
    s_addc_u32 s15, s15, 0
    s_add_u32 s5, s5, 4
    s_cmp_lt_u32 s5, 63
    s_cbranch_scc1 L_tw_item
    s_endpgm
L_tokt:
    v_lshlrev_b32 v3, 4, v0
    s_mov_b32 s6, 0
    s_mov_b32 s7, 4290772927
    s_cmp_lg_u32 s4, 0
    s_cbranch_scc1 L_tua_rb
    s_add_u32 s40, s8, 43982848
    s_addc_u32 s41, s9, 0
    v_lshrrev_b32 v8, 1, v0
    v_and_b32 v9, 1, v0
    v_lshlrev_b32 v9, 4, v9
    v_lshl_add_u32 v8, v8, 7, v9
    s_mov_b32 s42, 0
L_tua_rp:
    global_load_dwordx4 v[10:13], v8, s[40:41] sc1
    s_add_u32 s42, s42, 1
    s_cmp_gt_u32 s42, 1048576
    s_cbranch_scc1 L_bail
    s_waitcnt vmcnt(0)
    v_min_u32 v10, v10, v11
    v_min_u32 v10, v10, v12
    v_min_u32 v10, v10, v13
    v_cmp_eq_u32 vcc, 0, v10
    s_cbranch_vccz L_tua_rb
    s_sleep 8
    s_branch L_tua_rp
L_tua_rb:
    s_barrier
    s_cmp_lg_u32 s4, 0
    s_cbranch_scc1 L_tt_rb
    s_add_u32 s40, s8, 43978752
    s_addc_u32 s41, s9, 0
    v_bfe_u32 v8, v0, 3, 1
    v_lshlrev_b32 v8, 11, v8
    v_and_b32 v9, 7, v0
    v_lshl_add_u32 v8, v9, 2, v8
    s_lshl_b32 s43, s3, 7
    v_add_u32 v8, s43, v8
    s_mov_b32 s42, 0
L_tt_rp:
    global_load_dword v10, v8, s[40:41] sc1
    s_add_u32 s42, s42, 1
    s_cmp_gt_u32 s42, 1048576
    s_cbranch_scc1 L_bail
    s_waitcnt vmcnt(0)
    v_cmp_eq_u32 vcc, 0, v10
    s_cbranch_vccz L_tt_rb
    s_sleep 8
    s_branch L_tt_rp
L_tt_rb:
    s_barrier
    s_and_b32 s46, s4, 1
    s_lshr_b32 s41, s4, 1
    s_mul_i32 s41, s41, 7
    s_lshl_b32 s40, s46, 2
    s_add_u32 s40, s40, s41
    s_add_u32 s41, s41, 3
    s_sub_u32 s24, 0, s46
    s_mov_b32 s25, s24
    s_mul_i32 s42, s3, 401408
    s_mul_i32 s43, s40, 28672
    s_add_u32 s43, s43, s42
    s_mul_i32 s44, s41, 28672
    s_add_u32 s44, s44, s42
    s_add_u32 s10, s8, 0
    s_addc_u32 s11, s9, 0
    s_add_u32 s12, s10, s44
    s_addc_u32 s13, s11, 0
    s_add_u32 s10, s10, s43
    s_addc_u32 s11, s11, 0
    global_load_dwordx4 v[32:35], v3, s[10:11] offset:0 sc1
    global_load_dwordx4 v[36:39], v3, s[10:11] offset:1024 sc1
    global_load_dwordx4 v[40:43], v3, s[10:11] offset:2048 sc1
    global_load_dwordx4 v[44:47], v3, s[10:11] offset:3072 sc1
    s_add_u32 s10, s10, 4096
    s_addc_u32 s11, s11, 0
    global_load_dwordx4 v[48:51], v3, s[10:11] offset:0 sc1
    global_load_dwordx4 v[52:55], v3, s[10:11] offset:1024 sc1
    global_load_dwordx4 v[56:59], v3, s[10:11] offset:2048 sc1
    global_load_dwordx4 v[60:63], v3, s[10:11] offset:3072 sc1
    s_add_u32 s10, s10, 4096
    s_addc_u32 s11, s11, 0
    global_load_dwordx4 v[64:67], v3, s[10:11] offset:0 sc1
    global_load_dwordx4 v[68:71], v3, s[10:11] offset:1024 sc1
    global_load_dwordx4 v[72:75], v3, s[10:11] offset:2048 sc1
    global_load_dwordx4 v[76:79], v3, s[10:11] offset:3072 sc1
    s_add_u32 s10, s10, 4096
    s_addc_u32 s11, s11, 0
    global_load_dwordx4 v[80:83], v3, s[10:11] offset:0 sc1
    global_load_dwordx4 v[84:87], v3, s[10:11] offset:1024 sc1
    global_load_dwordx4 v[88:91], v3, s[10:11] offset:2048 sc1
    global_load_dwordx4 v[92:95], v3, s[10:11] offset:3072 sc1
    s_add_u32 s10, s10, 4096
    s_addc_u32 s11, s11, 0
    global_load_dwordx4 v[96:99], v3, s[10:11] offset:0 sc1
    global_load_dwordx4 v[100:103], v3, s[10:11] offset:1024 sc1
    global_load_dwordx4 v[104:107], v3, s[10:11] offset:2048 sc1
    global_load_dwordx4 v[108:111], v3, s[10:11] offset:3072 sc1
    s_add_u32 s10, s10, 4096
    s_addc_u32 s11, s11, 0
    global_load_dwordx4 v[112:115], v3, s[10:11] offset:0 sc1
    global_load_dwordx4 v[116:119], v3, s[10:11] offset:1024 sc1
    s_waitcnt vmcnt(20)
    v_accvgpr_write_b32 a0, v32
    v_accvgpr_write_b32 a56, v33
    v_accvgpr_write_b32 a1, v34
    v_accvgpr_write_b32 a57, v35
    v_accvgpr_write_b32 a2, v36
    v_accvgpr_write_b32 a58, v37
    v_accvgpr_write_b32 a3, v38
    v_accvgpr_write_b32 a59, v39
    global_load_dwordx4 v[32:35], v3, s[10:11] offset:2048 sc1
    global_load_dwordx4 v[36:39], v3, s[10:11] offset:3072 sc1
    s_add_u32 s10, s10, 4096
    s_addc_u32 s11, s11, 0
    s_waitcnt vmcnt(20)
    v_accvgpr_write_b32 a4, v40
    v_accvgpr_write_b32 a60, v41
    v_accvgpr_write_b32 a5, v42
    v_accvgpr_write_b32 a61, v43
    v_accvgpr_write_b32 a6, v44
    v_accvgpr_write_b32 a62, v45
    v_accvgpr_write_b32 a7, v46
    v_accvgpr_write_b32 a63, v47
    global_load_dwordx4 v[40:43], v3, s[10:11] offset:0 sc1
    global_load_dwordx4 v[44:47], v3, s[10:11] offset:1024 sc1
    s_waitcnt vmcnt(20)
    v_accvgpr_write_b32 a8, v48
    v_accvgpr_write_b32 a64, v49
    v_accvgpr_write_b32 a9, v50
    v_accvgpr_write_b32 a65, v51
    v_accvgpr_write_b32 a10, v52
    v_accvgpr_write_b32 a66, v53
    v_accvgpr_write_b32 a11, v54
    v_accvgpr_write_b32 a67, v55
    global_load_dwordx4 v[48:51], v3, s[10:11] offset:2048 sc1
    global_load_dwordx4 v[52:55], v3, s[10:11] offset:3072 sc1
    s_add_u32 s10, s10, 4096
    s_addc_u32 s11, s11, 0
    s_waitcnt vmcnt(20)
    v_accvgpr_write_b32 a12, v56
    v_accvgpr_write_b32 a68, v57
    v_accvgpr_write_b32 a13, v58
    v_accvgpr_write_b32 a69, v59
    v_accvgpr_write_b32 a14, v60
    v_accvgpr_write_b32 a70, v61
    v_accvgpr_write_b32 a15, v62
    v_accvgpr_write_b32 a71, v63
    global_load_dwordx4 v[56:59], v3, s[10:11] offset:0 sc1
    global_load_dwordx4 v[60:63], v3, s[10:11] offset:1024 sc1
    s_waitcnt vmcnt(20)
    v_accvgpr_write_b32 a16, v64
    v_accvgpr_write_b32 a72, v65
    v_accvgpr_write_b32 a17, v66
    v_accvgpr_write_b32 a73, v67
    v_accvgpr_write_b32 a18, v68
    v_accvgpr_write_b32 a74, v69
    v_accvgpr_write_b32 a19, v70
    v_accvgpr_write_b32 a75, v71
    global_load_dwordx4 v[64:67], v3, s[10:11] offset:2048 sc1
    global_load_dwordx4 v[68:71], v3, s[10:11] offset:3072 sc1
    s_add_u32 s10, s10, 4096
    s_addc_u32 s11, s11, 0
    s_waitcnt vmcnt(20)
    v_accvgpr_write_b32 a20, v72
    v_accvgpr_write_b32 a76, v73
    v_accvgpr_write_b32 a21, v74
    v_accvgpr_write_b32 a77, v75
    v_accvgpr_write_b32 a22, v76
    v_accvgpr_write_b32 a78, v77
    v_accvgpr_write_b32 a23, v78
    v_accvgpr_write_b32 a79, v79
    global_load_dwordx4 v[72:75], v3, s[10:11] offset:0 sc1
    global_load_dwordx4 v[76:79], v3, s[10:11] offset:1024 sc1
    s_waitcnt vmcnt(20)
    v_accvgpr_write_b32 a24, v80
    v_accvgpr_write_b32 a80, v81
    v_accvgpr_write_b32 a25, v82
    v_accvgpr_write_b32 a81, v83
    v_accvgpr_write_b32 a26, v84
    v_accvgpr_write_b32 a82, v85
    v_accvgpr_write_b32 a27, v86
    v_accvgpr_write_b32 a83, v87
    global_load_dwordx4 v[80:83], v3, s[10:11] offset:2048 sc1
    global_load_dwordx4 v[84:87], v3, s[10:11] offset:3072 sc1
    s_add_u32 s10, s10, 4096
    s_addc_u32 s11, s11, 0
    s_waitcnt vmcnt(20)
    v_accvgpr_write_b32 a28, v88
    v_accvgpr_write_b32 a84, v89
    v_accvgpr_write_b32 a29, v90
    v_accvgpr_write_b32 a85, v91
    v_accvgpr_write_b32 a30, v92
    v_accvgpr_write_b32 a86, v93
    v_accvgpr_write_b32 a31, v94
    v_accvgpr_write_b32 a87, v95
    global_load_dwordx4 v[88:91], v3, s[10:11] offset:0 sc1
    global_load_dwordx4 v[92:95], v3, s[10:11] offset:1024 sc1
    s_waitcnt vmcnt(20)
    v_accvgpr_write_b32 a32, v96
    v_accvgpr_write_b32 a88, v97
    v_accvgpr_write_b32 a33, v98
    v_accvgpr_write_b32 a89, v99
    v_accvgpr_write_b32 a34, v100
    v_accvgpr_write_b32 a90, v101
    v_accvgpr_write_b32 a35, v102
    v_accvgpr_write_b32 a91, v103
    global_load_dwordx4 v[96:99], v3, s[10:11] offset:2048 sc1
    global_load_dwordx4 v[100:103], v3, s[10:11] offset:3072 sc1
    s_add_u32 s10, s10, 4096
    s_addc_u32 s11, s11, 0
    s_waitcnt vmcnt(20)
    v_accvgpr_write_b32 a36, v104
    v_accvgpr_write_b32 a92, v105
    v_accvgpr_write_b32 a37, v106
    v_accvgpr_write_b32 a93, v107
    v_accvgpr_write_b32 a38, v108
    v_accvgpr_write_b32 a94, v109
    v_accvgpr_write_b32 a39, v110
    v_accvgpr_write_b32 a95, v111
    global_load_dwordx4 v[104:107], v3, s[10:11] offset:0 sc1
    global_load_dwordx4 v[108:111], v3, s[10:11] offset:1024 sc1
    s_waitcnt vmcnt(20)
    v_accvgpr_write_b32 a40, v112
    v_accvgpr_write_b32 a96, v113
    v_accvgpr_write_b32 a41, v114
    v_accvgpr_write_b32 a97, v115
    v_accvgpr_write_b32 a42, v116
    v_accvgpr_write_b32 a98, v117
    v_accvgpr_write_b32 a43, v118
    v_accvgpr_write_b32 a99, v119
    global_load_dwordx4 v[112:115], v3, s[10:11] offset:2048 sc1
    global_load_dwordx4 v[116:119], v3, s[10:11] offset:3072 sc1
    s_add_u32 s10, s10, 4096
    s_addc_u32 s11, s11, 0
    s_waitcnt vmcnt(20)
    v_accvgpr_write_b32 a44, v32
    v_accvgpr_write_b32 a100, v33
    v_accvgpr_write_b32 a45, v34
    v_accvgpr_write_b32 a101, v35
    v_accvgpr_write_b32 a46, v36
    v_accvgpr_write_b32 a102, v37
    v_accvgpr_write_b32 a47, v38
    v_accvgpr_write_b32 a103, v39
    global_load_dwordx4 v[32:35], v3, s[10:11] offset:0 sc1
    global_load_dwordx4 v[36:39], v3, s[10:11] offset:1024 sc1
    s_waitcnt vmcnt(20)
    v_accvgpr_write_b32 a48, v40
    v_accvgpr_write_b32 a104, v41
    v_accvgpr_write_b32 a49, v42
    v_accvgpr_write_b32 a105, v43
    v_accvgpr_write_b32 a50, v44
    v_accvgpr_write_b32 a106, v45
    v_accvgpr_write_b32 a51, v46
    v_accvgpr_write_b32 a107, v47
    global_load_dwordx4 v[40:43], v3, s[10:11] offset:2048 sc1
    global_load_dwordx4 v[44:47], v3, s[10:11] offset:3072 sc1
    s_add_u32 s10, s10, 4096
    s_addc_u32 s11, s11, 0
    s_waitcnt vmcnt(20)
    v_accvgpr_write_b32 a52, v48
    v_accvgpr_write_b32 a108, v49
    v_accvgpr_write_b32 a53, v50
    v_accvgpr_write_b32 a109, v51
    v_accvgpr_write_b32 a54, v52
    v_accvgpr_write_b32 a110, v53
    v_accvgpr_write_b32 a55, v54
    v_accvgpr_write_b32 a111, v55
    global_load_dwordx4 v[48:51], v3, s[10:11] offset:0 sc1
    global_load_dwordx4 v[52:55], v3, s[10:11] offset:1024 sc1
    s_waitcnt vmcnt(20)
    v_accvgpr_write_b32 a112, v56
    v_accvgpr_write_b32 a168, v57
    v_accvgpr_write_b32 a113, v58
    v_accvgpr_write_b32 a169, v59
    v_accvgpr_write_b32 a114, v60
    v_accvgpr_write_b32 a170, v61
    v_accvgpr_write_b32 a115, v62
    v_accvgpr_write_b32 a171, v63
    global_load_dwordx4 v[56:59], v3, s[10:11] offset:2048 sc1
    global_load_dwordx4 v[60:63], v3, s[10:11] offset:3072 sc1
    s_add_u32 s10, s10, 4096
    s_addc_u32 s11, s11, 0
    s_waitcnt vmcnt(20)
    v_accvgpr_write_b32 a116, v64
    v_accvgpr_write_b32 a172, v65
    v_accvgpr_write_b32 a117, v66
    v_accvgpr_write_b32 a173, v67
    v_accvgpr_write_b32 a118, v68
    v_accvgpr_write_b32 a174, v69
    v_accvgpr_write_b32 a119, v70
    v_accvgpr_write_b32 a175, v71
    global_load_dwordx4 v[64:67], v3, s[10:11] offset:0 sc1
    global_load_dwordx4 v[68:71], v3, s[10:11] offset:1024 sc1
    s_waitcnt vmcnt(20)
    v_accvgpr_write_b32 a120, v72
    v_accvgpr_write_b32 a176, v73
    v_accvgpr_write_b32 a121, v74
    v_accvgpr_write_b32 a177, v75
    v_accvgpr_write_b32 a122, v76
    v_accvgpr_write_b32 a178, v77
    v_accvgpr_write_b32 a123, v78
    v_accvgpr_write_b32 a179, v79
    global_load_dwordx4 v[72:75], v3, s[10:11] offset:2048 sc1
    global_load_dwordx4 v[76:79], v3, s[10:11] offset:3072 sc1
    s_add_u32 s10, s10, 4096
    s_addc_u32 s11, s11, 0
    s_waitcnt vmcnt(20)
    v_accvgpr_write_b32 a124, v80
    v_accvgpr_write_b32 a180, v81
    v_accvgpr_write_b32 a125, v82
    v_accvgpr_write_b32 a181, v83
    v_accvgpr_write_b32 a126, v84
    v_accvgpr_write_b32 a182, v85
    v_accvgpr_write_b32 a127, v86
    v_accvgpr_write_b32 a183, v87
    global_load_dwordx4 v[80:83], v3, s[10:11] offset:0 sc1
    global_load_dwordx4 v[84:87], v3, s[10:11] offset:1024 sc1
    s_waitcnt vmcnt(20)
    v_accvgpr_write_b32 a128, v88
    v_accvgpr_write_b32 a184, v89
    v_accvgpr_write_b32 a129, v90
    v_accvgpr_write_b32 a185, v91
    v_accvgpr_write_b32 a130, v92
    v_accvgpr_write_b32 a186, v93
    v_accvgpr_write_b32 a131, v94
    v_accvgpr_write_b32 a187, v95
    global_load_dwordx4 v[88:91], v3, s[10:11] offset:2048 sc1
    global_load_dwordx4 v[92:95], v3, s[10:11] offset:3072 sc1
    s_add_u32 s10, s10, 4096
    s_addc_u32 s11, s11, 0
    s_waitcnt vmcnt(20)
    v_accvgpr_write_b32 a132, v96
    v_accvgpr_write_b32 a188, v97
    v_accvgpr_write_b32 a133, v98
    v_accvgpr_write_b32 a189, v99
    v_accvgpr_write_b32 a134, v100
    v_accvgpr_write_b32 a190, v101
    v_accvgpr_write_b32 a135, v102
    v_accvgpr_write_b32 a191, v103
    global_load_dwordx4 v[96:99], v3, s[10:11] offset:0 sc1
    global_load_dwordx4 v[100:103], v3, s[10:11] offset:1024 sc1
    s_waitcnt vmcnt(20)
    v_accvgpr_write_b32 a136, v104
    v_accvgpr_write_b32 a192, v105
    v_accvgpr_write_b32 a137, v106
    v_accvgpr_write_b32 a193, v107
    v_accvgpr_write_b32 a138, v108
    v_accvgpr_write_b32 a194, v109
    v_accvgpr_write_b32 a139, v110
    v_accvgpr_write_b32 a195, v111
    global_load_dwordx4 v[104:107], v3, s[10:11] offset:2048 sc1
    global_load_dwordx4 v[108:111], v3, s[10:11] offset:3072 sc1
    s_add_u32 s10, s10, 4096
    s_addc_u32 s11, s11, 0
    s_waitcnt vmcnt(20)
    v_accvgpr_write_b32 a140, v112
    v_accvgpr_write_b32 a196, v113
    v_accvgpr_write_b32 a141, v114
    v_accvgpr_write_b32 a197, v115
    v_accvgpr_write_b32 a142, v116
    v_accvgpr_write_b32 a198, v117
    v_accvgpr_write_b32 a143, v118
    v_accvgpr_write_b32 a199, v119
    global_load_dwordx4 v[112:115], v3, s[10:11] offset:0 sc1
    global_load_dwordx4 v[116:119], v3, s[10:11] offset:1024 sc1
    s_waitcnt vmcnt(20)
    v_accvgpr_write_b32 a144, v32
    v_accvgpr_write_b32 a200, v33
    v_accvgpr_write_b32 a145, v34
    v_accvgpr_write_b32 a201, v35
    v_accvgpr_write_b32 a146, v36
    v_accvgpr_write_b32 a202, v37
    v_accvgpr_write_b32 a147, v38
    v_accvgpr_write_b32 a203, v39
    global_load_dwordx4 v[32:35], v3, s[10:11] offset:2048 sc1
    global_load_dwordx4 v[36:39], v3, s[10:11] offset:3072 sc1
    s_add_u32 s10, s10, 4096
    s_addc_u32 s11, s11, 0
    s_waitcnt vmcnt(20)
    v_accvgpr_write_b32 a148, v40
    v_accvgpr_write_b32 a204, v41
    v_accvgpr_write_b32 a149, v42
    v_accvgpr_write_b32 a205, v43
    v_accvgpr_write_b32 a150, v44
    v_accvgpr_write_b32 a206, v45
    v_accvgpr_write_b32 a151, v46
    v_accvgpr_write_b32 a207, v47
    global_load_dwordx4 v[40:43], v3, s[10:11] offset:0 sc1
    global_load_dwordx4 v[44:47], v3, s[10:11] offset:1024 sc1
    s_waitcnt vmcnt(20)
    v_accvgpr_write_b32 a152, v48
    v_accvgpr_write_b32 a208, v49
    v_accvgpr_write_b32 a153, v50
    v_accvgpr_write_b32 a209, v51
    v_accvgpr_write_b32 a154, v52
    v_accvgpr_write_b32 a210, v53
    v_accvgpr_write_b32 a155, v54
    v_accvgpr_write_b32 a211, v55
    global_load_dwordx4 v[48:51], v3, s[10:11] offset:2048 sc1
    global_load_dwordx4 v[52:55], v3, s[10:11] offset:3072 sc1
    s_add_u32 s10, s10, 4096
    s_addc_u32 s11, s11, 0
    s_waitcnt vmcnt(20)
    v_accvgpr_write_b32 a156, v56
    v_accvgpr_write_b32 a212, v57
    v_accvgpr_write_b32 a157, v58
    v_accvgpr_write_b32 a213, v59
    v_accvgpr_write_b32 a158, v60
    v_accvgpr_write_b32 a214, v61
    v_accvgpr_write_b32 a159, v62
    v_accvgpr_write_b32 a215, v63
    global_load_dwordx4 v[56:59], v3, s[10:11] offset:0 sc1
    global_load_dwordx4 v[60:63], v3, s[10:11] offset:1024 sc1
    s_waitcnt vmcnt(20)
    v_accvgpr_write_b32 a160, v64
    v_accvgpr_write_b32 a216, v65
    v_accvgpr_write_b32 a161, v66
    v_accvgpr_write_b32 a217, v67
    v_accvgpr_write_b32 a162, v68
    v_accvgpr_write_b32 a218, v69
    v_accvgpr_write_b32 a163, v70
    v_accvgpr_write_b32 a219, v71
    global_load_dwordx4 v[64:67], v3, s[10:11] offset:2048 sc1
    global_load_dwordx4 v[68:71], v3, s[10:11] offset:3072 sc1
    s_add_u32 s10, s10, 4096
    s_addc_u32 s11, s11, 0
    s_waitcnt vmcnt(20)
    v_accvgpr_write_b32 a164, v72
    v_accvgpr_write_b32 a220, v73
    v_accvgpr_write_b32 a165, v74
    v_accvgpr_write_b32 a221, v75
    v_accvgpr_write_b32 a166, v76
    v_accvgpr_write_b32 a222, v77
    v_accvgpr_write_b32 a167, v78
    v_accvgpr_write_b32 a223, v79
    global_load_dwordx4 v[72:75], v3, s[10:11] offset:0 sc1
    global_load_dwordx4 v[76:79], v3, s[10:11] offset:1024 sc1
    s_waitcnt vmcnt(20)
    v_accvgpr_write_b32 a224, v80
    v_mov_b32 v200, v81
    v_accvgpr_write_b32 a225, v82
    v_mov_b32 v201, v83
    v_accvgpr_write_b32 a226, v84
    v_mov_b32 v202, v85
    v_accvgpr_write_b32 a227, v86
    v_mov_b32 v203, v87
    global_load_dwordx4 v[80:83], v3, s[10:11] offset:2048 sc1
    global_load_dwordx4 v[84:87], v3, s[10:11] offset:3072 sc1
    s_add_u32 s10, s10, 4096
    s_addc_u32 s11, s11, 0
    s_waitcnt vmcnt(20)
    v_accvgpr_write_b32 a228, v88
    v_mov_b32 v204, v89
    v_accvgpr_write_b32 a229, v90
    v_mov_b32 v205, v91
    v_accvgpr_write_b32 a230, v92
    v_mov_b32 v206, v93
    v_accvgpr_write_b32 a231, v94
    v_mov_b32 v207, v95
    global_load_dwordx4 v[88:91], v3, s[10:11] offset:0 sc1
    global_load_dwordx4 v[92:95], v3, s[10:11] offset:1024 sc1
    s_waitcnt vmcnt(20)
    v_accvgpr_write_b32 a232, v96
    v_mov_b32 v208, v97
    v_accvgpr_write_b32 a233, v98
    v_mov_b32 v209, v99
    v_accvgpr_write_b32 a234, v100
    v_mov_b32 v210, v101
    v_accvgpr_write_b32 a235, v102
    v_mov_b32 v211, v103
    global_load_dwordx4 v[96:99], v3, s[10:11] offset:2048 sc1
    global_load_dwordx4 v[100:103], v3, s[10:11] offset:3072 sc1
    s_add_u32 s10, s10, 4096
    s_addc_u32 s11, s11, 0
    s_waitcnt vmcnt(20)
    v_accvgpr_write_b32 a236, v104
    v_mov_b32 v212, v105
    v_accvgpr_write_b32 a237, v106
    v_mov_b32 v213, v107
    v_accvgpr_write_b32 a238, v108
    v_mov_b32 v214, v109
    v_accvgpr_write_b32 a239, v110
    v_mov_b32 v215, v111
    global_load_dwordx4 v[104:107], v3, s[12:13] offset:0 sc1
    global_load_dwordx4 v[108:111], v3, s[12:13] offset:1024 sc1
    s_waitcnt vmcnt(20)
    v_accvgpr_write_b32 a240, v112
    v_mov_b32 v216, v113
    v_accvgpr_write_b32 a241, v114
    v_mov_b32 v217, v115
    v_accvgpr_write_b32 a242, v116
    v_mov_b32 v218, v117
    v_accvgpr_write_b32 a243, v118
    v_mov_b32 v219, v119
    global_load_dwordx4 v[112:115], v3, s[12:13] offset:2048 sc1
    global_load_dwordx4 v[116:119], v3, s[12:13] offset:3072 sc1
    s_add_u32 s12, s12, 4096
    s_addc_u32 s13, s13, 0
    s_waitcnt vmcnt(20)
    v_accvgpr_write_b32 a244, v32
    v_mov_b32 v220, v33
    v_accvgpr_write_b32 a245, v34
    v_mov_b32 v221, v35
    v_accvgpr_write_b32 a246, v36
    v_mov_b32 v222, v37
    v_accvgpr_write_b32 a247, v38
    v_mov_b32 v223, v39
    global_load_dwordx4 v[32:35], v3, s[12:13] offset:0 sc1
    global_load_dwordx4 v[36:39], v3, s[12:13] offset:1024 sc1
    s_waitcnt vmcnt(20)
    v_accvgpr_write_b32 a248, v40
    v_mov_b32 v224, v41
    v_accvgpr_write_b32 a249, v42
    v_mov_b32 v225, v43
    v_accvgpr_write_b32 a250, v44
    v_mov_b32 v226, v45
    v_accvgpr_write_b32 a251, v46
    v_mov_b32 v227, v47
    global_load_dwordx4 v[40:43], v3, s[12:13] offset:2048 sc1
    global_load_dwordx4 v[44:47], v3, s[12:13] offset:3072 sc1
    s_add_u32 s12, s12, 4096
    s_addc_u32 s13, s13, 0
    s_waitcnt vmcnt(20)
    v_accvgpr_write_b32 a252, v48
    v_mov_b32 v228, v49
    v_accvgpr_write_b32 a253, v50
    v_mov_b32 v229, v51
    v_accvgpr_write_b32 a254, v52
    v_mov_b32 v230, v53
    v_accvgpr_write_b32 a255, v54
    v_mov_b32 v231, v55
    global_load_dwordx4 v[48:51], v3, s[12:13] offset:0 sc1
    global_load_dwordx4 v[52:55], v3, s[12:13] offset:1024 sc1
    s_waitcnt vmcnt(20)
    v_mov_b32 v176, v56
    v_mov_b32 v232, v57
    v_mov_b32 v177, v58
    v_mov_b32 v233, v59
    v_mov_b32 v178, v60
    v_mov_b32 v234, v61
    v_mov_b32 v179, v62
    v_mov_b32 v235, v63
    global_load_dwordx4 v[56:59], v3, s[12:13] offset:2048 sc1
    global_load_dwordx4 v[60:63], v3, s[12:13] offset:3072 sc1
    s_add_u32 s12, s12, 4096
    s_addc_u32 s13, s13, 0
    s_waitcnt vmcnt(20)
    v_mov_b32 v180, v64
    v_mov_b32 v236, v65
    v_mov_b32 v181, v66
    v_mov_b32 v237, v67
    v_mov_b32 v182, v68
    v_mov_b32 v238, v69
    v_mov_b32 v183, v70
    v_mov_b32 v239, v71
    global_load_dwordx4 v[64:67], v3, s[12:13] offset:0 sc1
    global_load_dwordx4 v[68:71], v3, s[12:13] offset:1024 sc1
    s_waitcnt vmcnt(20)
    v_mov_b32 v184, v72
    v_mov_b32 v240, v73
    v_mov_b32 v185, v74
    v_mov_b32 v241, v75
    v_mov_b32 v186, v76
    v_mov_b32 v242, v77
    v_mov_b32 v187, v78
    v_mov_b32 v243, v79
    global_load_dwordx4 v[72:75], v3, s[12:13] offset:2048 sc1
    global_load_dwordx4 v[76:79], v3, s[12:13] offset:3072 sc1
    s_add_u32 s12, s12, 4096
    s_addc_u32 s13, s13, 0
    s_waitcnt vmcnt(20)
    v_mov_b32 v188, v80
    v_mov_b32 v244, v81
    v_mov_b32 v189, v82
    v_mov_b32 v245, v83
    v_mov_b32 v190, v84
    v_mov_b32 v246, v85
    v_mov_b32 v191, v86
    v_mov_b32 v247, v87
    global_load_dwordx4 v[80:83], v3, s[12:13] offset:0 sc1
    global_load_dwordx4 v[84:87], v3, s[12:13] offset:1024 sc1
    s_waitcnt vmcnt(20)
    v_mov_b32 v192, v88
    v_mov_b32 v248, v89
    v_mov_b32 v193, v90
    v_mov_b32 v249, v91
    v_mov_b32 v194, v92
    v_mov_b32 v250, v93
    v_mov_b32 v195, v94
    v_mov_b32 v251, v95
    global_load_dwordx4 v[88:91], v3, s[12:13] offset:2048 sc1
    global_load_dwordx4 v[92:95], v3, s[12:13] offset:3072 sc1
    s_add_u32 s12, s12, 4096
    s_addc_u32 s13, s13, 0
    s_waitcnt vmcnt(20)
    v_mov_b32 v196, v96
    v_mov_b32 v252, v97
    v_mov_b32 v197, v98
    v_mov_b32 v253, v99
    v_mov_b32 v198, v100
    v_mov_b32 v254, v101
    v_mov_b32 v199, v102
    v_mov_b32 v255, v103
    global_load_dwordx4 v[96:99], v3, s[12:13] offset:0 sc1
    global_load_dwordx4 v[100:103], v3, s[12:13] offset:1024 sc1
    s_waitcnt vmcnt(20)
    v_cndmask_b32 v120, v104, v105, s[24:25]
    v_cndmask_b32 v121, v106, v107, s[24:25]
    v_cndmask_b32 v122, v108, v109, s[24:25]
    v_cndmask_b32 v123, v110, v111, s[24:25]
    global_load_dwordx4 v[104:107], v3, s[12:13] offset:2048 sc1
    global_load_dwordx4 v[108:111], v3, s[12:13] offset:3072 sc1
    s_add_u32 s12, s12, 4096
    s_addc_u32 s13, s13, 0
    s_waitcnt vmcnt(20)
    v_cndmask_b32 v124, v112, v113, s[24:25]
    v_cndmask_b32 v125, v114, v115, s[24:25]
    v_cndmask_b32 v126, v116, v117, s[24:25]
    v_cndmask_b32 v127, v118, v119, s[24:25]
    global_load_dwordx4 v[112:115], v3, s[12:13] offset:0 sc1
    global_load_dwordx4 v[116:119], v3, s[12:13] offset:1024 sc1
    s_waitcnt vmcnt(20)
    v_cndmask_b32 v128, v32, v33, s[24:25]
    v_cndmask_b32 v129, v34, v35, s[24:25]
    v_cndmask_b32 v130, v36, v37, s[24:25]
    v_cndmask_b32 v131, v38, v39, s[24:25]
    global_load_dwordx4 v[32:35], v3, s[12:13] offset:2048 sc1
    global_load_dwordx4 v[36:39], v3, s[12:13] offset:3072 sc1
    s_add_u32 s12, s12, 4096
    s_addc_u32 s13, s13, 0
    s_waitcnt vmcnt(20)
    v_cndmask_b32 v132, v40, v41, s[24:25]
    v_cndmask_b32 v133, v42, v43, s[24:25]
    v_cndmask_b32 v134, v44, v45, s[24:25]
    v_cndmask_b32 v135, v46, v47, s[24:25]
    s_waitcnt vmcnt(18)
    v_cndmask_b32 v136, v48, v49, s[24:25]
    v_cndmask_b32 v137, v50, v51, s[24:25]
    v_cndmask_b32 v138, v52, v53, s[24:25]
    v_cndmask_b32 v139, v54, v55, s[24:25]
    s_waitcnt vmcnt(16)
    v_cndmask_b32 v140, v56, v57, s[24:25]
    v_cndmask_b32 v141, v58, v59, s[24:25]
    v_cndmask_b32 v142, v60, v61, s[24:25]
    v_cndmask_b32 v143, v62, v63, s[24:25]
    s_waitcnt vmcnt(14)
    v_cndmask_b32 v144, v64, v65, s[24:25]
    v_cndmask_b32 v145, v66, v67, s[24:25]
    v_cndmask_b32 v146, v68, v69, s[24:25]
    v_cndmask_b32 v147, v70, v71, s[24:25]
    s_waitcnt vmcnt(12)
    v_cndmask_b32 v148, v72, v73, s[24:25]
    v_cndmask_b32 v149, v74, v75, s[24:25]
    v_cndmask_b32 v150, v76, v77, s[24:25]
    v_cndmask_b32 v151, v78, v79, s[24:25]
    s_waitcnt vmcnt(10)
    v_cndmask_b32 v152, v80, v81, s[24:25]
    v_cndmask_b32 v153, v82, v83, s[24:25]
    v_cndmask_b32 v154, v84, v85, s[24:25]
    v_cndmask_b32 v155, v86, v87, s[24:25]
    s_waitcnt vmcnt(8)
    v_cndmask_b32 v156, v88, v89, s[24:25]
    v_cndmask_b32 v157, v90, v91, s[24:25]
    v_cndmask_b32 v158, v92, v93, s[24:25]
    v_cndmask_b32 v159, v94, v95, s[24:25]
    s_waitcnt vmcnt(6)
    v_cndmask_b32 v160, v96, v97, s[24:25]
    v_cndmask_b32 v161, v98, v99, s[24:25]
    v_cndmask_b32 v162, v100, v101, s[24:25]
    v_cndmask_b32 v163, v102, v103, s[24:25]
    s_waitcnt vmcnt(4)
    v_cndmask_b32 v164, v104, v105, s[24:25]
    v_cndmask_b32 v165, v106, v107, s[24:25]
    v_cndmask_b32 v166, v108, v109, s[24:25]
    v_cndmask_b32 v167, v110, v111, s[24:25]
    s_waitcnt vmcnt(2)
    v_cndmask_b32 v168, v112, v113, s[24:25]
    v_cndmask_b32 v169, v114, v115, s[24:25]
    v_cndmask_b32 v170, v116, v117, s[24:25]
    v_cndmask_b32 v171, v118, v119, s[24:25]
    s_waitcnt vmcnt(0)
    v_cndmask_b32 v172, v32, v33, s[24:25]
    v_cndmask_b32 v173, v34, v35, s[24:25]
    v_cndmask_b32 v174, v36, v37, s[24:25]
    v_cndmask_b32 v175, v38, v39, s[24:25]
    s_load_dwordx2 s[10:11], s[0:1], 0
    s_waitcnt lgkmcnt(0)
    s_mul_i32 s23, s4, 7168
    s_mul_i32 s40, s22, 28672
    s_mov_b32 s5, s22
    v_lshrrev_b32 v8, 2, v0
    v_mul_u32_u24 v8, 896, v8
    v_lshrrev_b32 v9, 5, v0
    v_lshlrev_b32 v9, 1, v9
    v_and_b32 v21, 3, v0
    v_xor_b32 v9, v9, v21
    v_lshl_add_u32 v21, v9, 4, v8
    v_lshrrev_b32 v8, 3, v1
    v_lshlrev_b32 v8, 1, v8
    v_xor_b32 v8, v8, v2
    v_lshl_add_u32 v8, v1, 2, v8
    v_lshlrev_b32 v5, 4, v8
    s_add_u32 s10, s10, s40
    s_addc_u32 s11, s11, 0
    s_mul_i32 s40, s4, 7
    s_add_u32 s40, s40, 0
    s_and_b32 s41, s40, 1
    s_mul_i32 s41, s41, 14336
    s_lshr_b32 s40, s40, 1
    s_lshl_b32 s40, s40, 6
    s_add_u32 s80, s40, s41
    s_mul_i32 s40, s4, 7
    s_add_u32 s40, s40, 1
    s_and_b32 s41, s40, 1
    s_mul_i32 s41, s41, 14336
    s_lshr_b32 s40, s40, 1
    s_lshl_b32 s40, s40, 6
    s_add_u32 s81, s40, s41
    s_mul_i32 s40, s4, 7
    s_add_u32 s40, s40, 2
    s_and_b32 s41, s40, 1
    s_mul_i32 s41, s41, 14336
    s_lshr_b32 s40, s40, 1
    s_lshl_b32 s40, s40, 6
    s_add_u32 s82, s40, s41
    s_mul_i32 s40, s4, 7
    s_add_u32 s40, s40, 3
    s_and_b32 s41, s40, 1
    s_mul_i32 s41, s41, 14336
    s_lshr_b32 s40, s40, 1
    s_lshl_b32 s40, s40, 6
    s_add_u32 s83, s40, s41
    s_mul_i32 s40, s4, 7
    s_add_u32 s40, s40, 4
    s_and_b32 s41, s40, 1
    s_mul_i32 s41, s41, 14336
    s_lshr_b32 s40, s40, 1
    s_lshl_b32 s40, s40, 6
    s_add_u32 s84, s40, s41
    s_mul_i32 s40, s4, 7
    s_add_u32 s40, s40, 5
    s_and_b32 s41, s40, 1
    s_mul_i32 s41, s41, 14336
    s_lshr_b32 s40, s40, 1
    s_lshl_b32 s40, s40, 6
    s_add_u32 s85, s40, s41
    s_mul_i32 s40, s4, 7
    s_add_u32 s40, s40, 6
    s_and_b32 s41, s40, 1
    s_mul_i32 s41, s41, 14336
    s_lshr_b32 s40, s40, 1
    s_lshl_b32 s40, s40, 6
    s_add_u32 s86, s40, s41
    s_cmp_eq_u32 s22, 3
    s_cselect_b32 s5, 63, s5
    s_cselect_b32 s44, 1720320, 0
    s_cselect_b32 s45, 1835008, 0
    s_add_u32 s10, s10, s44
    s_addc_u32 s11, s11, 0
    s_add_u32 s40, s10, s80
    s_addc_u32 s41, s11, 0
    s_add_u32 m0, s23, 0
    s_nop 0
    global_load_lds_dwordx4 v21, s[40:41]
    s_add_u32 s40, s10, s81
    s_addc_u32 s41, s11, 0
    s_add_u32 m0, s23, 1024
    s_nop 0
    global_load_lds_dwordx4 v21, s[40:41]
    s_add_u32 s40, s10, s82
    s_addc_u32 s41, s11, 0
    s_add_u32 m0, s23, 2048
    s_nop 0
    global_load_lds_dwordx4 v21, s[40:41]
    s_add_u32 s40, s10, s83
    s_addc_u32 s41, s11, 0
    s_add_u32 m0, s23, 3072
    s_nop 0
    global_load_lds_dwordx4 v21, s[40:41]
    s_add_u32 s40, s10, s84
    s_addc_u32 s41, s11, 0
    s_add_u32 m0, s23, 4096
    s_nop 0
    global_load_lds_dwordx4 v21, s[40:41]
    s_add_u32 s40, s10, s85
    s_addc_u32 s41, s11, 0
    s_add_u32 m0, s23, 5120
    s_nop 0
    global_load_lds_dwordx4 v21, s[40:41]
    s_add_u32 s40, s10, s86
    s_addc_u32 s41, s11, 0
    s_add_u32 m0, s23, 6144
    s_nop 0
    global_load_lds_dwordx4 v21, s[40:41]
    s_add_u32 s10, s10, 114688
    s_addc_u32 s11, s11, 0
    s_sub_u32 s10, s10, s45
    s_subb_u32 s11, s11, 0
    s_mul_i32 s40, s4, 1792
    v_add_u32 v56, s40, v3
    v_min_u32 v57, 47, v0
    v_lshlrev_b32 v57, 4, v57
    v_add3_u32 v57, v57, s40, s40
    v_subrev_u32 v57, s40, v57
    v_add_u32 v57, 1024, v57
    s_and_b32 s46, s4, 1
    s_lshr_b32 s41, s4, 1
    s_mul_i32 s41, s41, 7
    s_lshl_b32 s40, s46, 2
    s_add_u32 s40, s40, s41
    s_add_u32 s41, s41, 3
    s_sub_u32 s24, 0, s46
    s_mov_b32 s25, s24
    s_and_b32 s45, s4, 1
    s_lshl_b32 s45, s45, 3
    v_and_b32 v9, 7, v0
    v_lshlrev_b32 v8, 7, v2
    v_lshl_add_u32 v8, v9, 4, v8
    s_lshl_b32 s42, s40, 9
    s_add_u32 s42, s42, 61440
    v_add_u32 v58, s42, v8
    s_lshl_b32 s42, s41, 9
    s_add_u32 s42, s42, s45
    s_add_u32 s42, s42, 61440
    v_add_u32 v59, s42, v8
    s_mul_i32 s42, s4, 5632
    s_add_u32 s42, s42, 69632
    v_mul_u32_u24 v8, 176, v1
    v_lshl_add_u32 v8, v2, 4, v8
    v_add_u32 v60, s42, v8
    v_lshrrev_b32 v10, 3, v0
    v_lshl_add_u32 v10, s4, 3, v10
    v_min_u32 v11, 4, v9
    v_subrev_u32 v11, 1, v11
    v_lshrrev_b32 v12, 1, v11
    v_and_b32 v13, 1, v11
    v_lshlrev_b32 v13, 2, v13
    v_lshl_add_u32 v13, v12, 4, v13
    v_lshlrev_b32 v14, 2, v13
    v_add_u32 v14, 32, v14
    v_add_u32 v15, 32, v14
    v_cmp_eq_u32 s[34:35], 0, v9
    s_nop 1
    v_cndmask_b32 v14, v14, 0, s[34:35]
    v_cndmask_b32 v15, v15, 16, s[34:35]
    v_mul_u32_u24 v8, 176, v10
    v_add_u32 v8, 69632, v8
    v_add_u32 v61, v8, v14
    v_add_u32 v62, v8, v15
    v_cmp_gt_u32 s[32:33], 5, v9
    v_add_u32 v8, 0, v13
    v_cmp_le_u32 vcc, v8, v10
    s_or_b64 vcc, vcc, s[34:35]
    s_and_b64 s[48:49], vcc, s[32:33]
    v_add_u32 v8, 1, v13
    v_cmp_le_u32 vcc, v8, v10
    s_or_b64 vcc, vcc, s[34:35]
    s_and_b64 s[50:51], vcc, s[32:33]
    v_add_u32 v8, 2, v13
    v_cmp_le_u32 vcc, v8, v10
    s_or_b64 vcc, vcc, s[34:35]
    s_and_b64 s[52:53], vcc, s[32:33]
    v_add_u32 v8, 3, v13
    v_cmp_le_u32 vcc, v8, v10
    s_or_b64 vcc, vcc, s[34:35]
    s_and_b64 s[54:55], vcc, s[32:33]
    v_add_u32 v8, 8, v13
    v_cmp_le_u32 vcc, v8, v10
    s_or_b64 vcc, vcc, s[34:35]
    s_and_b64 s[56:57], vcc, s[32:33]
    v_add_u32 v8, 9, v13
    v_cmp_le_u32 vcc, v8, v10
    s_or_b64 vcc, vcc, s[34:35]
    s_and_b64 s[58:59], vcc, s[32:33]
    v_add_u32 v8, 10, v13
    v_cmp_le_u32 vcc, v8, v10
    s_or_b64 vcc, vcc, s[34:35]
    s_and_b64 s[60:61], vcc, s[32:33]
    v_add_u32 v8, 11, v13
    v_cmp_le_u32 vcc, v8, v10
    s_or_b64 vcc, vcc, s[34:35]
    s_and_b64 s[62:63], vcc, s[32:33]
    s_and_b32 s42, s3, 3
    v_mov_b32 v8, s42
    v_cndmask_b32 v12, v11, v8, s[34:35]
    v_cndmask_b32 v8, v8, 4, s[34:35]
    v_lshrrev_b32 v14, 4, v10
    v_lshl_add_u32 v8, v8, 1, v14
    v_lshlrev_b32 v8, 10, v8
    v_and_b32 v14, 15, v10
    v_lshl_add_u32 v14, v12, 4, v14
    v_lshl_add_u32 v14, v14, 4, v8
    s_lshr_b32 s43, s3, 2
    s_mul_i32 s43, s43, 10240
    v_add_u32 v63, s43, v14
    v_mov_b32 v6, 0x01010101
    v_mov_b32 v7, 0
    v_lshrrev_b32 v8, 3, v1
    v_xor_b32 v8, v8, v2
    v_and_b32 v8, 1, v8
    v_lshlrev_b32 v8, 5, v8
    v_lshl_add_u32 v8, v1, 6, v8
    v_lshrrev_b32 v9, 1, v2
    v_lshl_add_u32 v8, v9, 3, v8
    s_lshl_b32 s42, s40, 11
    v_add_u32 v4, s42, v8
    s_lshl_b32 s42, s41, 11
    s_and_b32 s45, s4, 1
    s_lshl_b32 s45, s45, 4
    s_add_u32 s42, s42, s45
    v_add_u32 v1, s42, v8
    v_mov_b32 v2, v21
    s_mul_i32 s42, s22, 40960
    s_add_u32 s14, s8, 51392512
    s_addc_u32 s15, s9, 0
    s_add_u32 s14, s14, s42
    s_addc_u32 s15, s15, 0
    s_lshl_b32 s42, s22, 10
    s_lshr_b32 s43, s3, 2
    s_lshl_b32 s43, s43, 7
    s_add_u32 s42, s42, s43
    s_and_b32 s43, s3, 3
    s_lshl_b32 s43, s43, 2
    s_add_u32 s42, s42, s43
    s_add_u32 s16, s8, 43986944
    s_addc_u32 s17, s9, 0
    s_add_u32 s16, s16, s42
    s_addc_u32 s17, s17, 0
    s_mul_i32 s42, s22, 7168
    s_add_u32 s18, s8, 42778624
    s_addc_u32 s19, s9, 0
    s_add_u32 s18, s18, s42
    s_addc_u32 s19, s19, 0
L_tt_item:
    s_waitcnt vmcnt(0)
    s_barrier
    s_xor_b32 s23, s23, 0x8000
    s_sub_u32 s40, s5, 59
    s_cmp_lt_u32 s40, 4
    s_cbranch_scc1 L_tt_nox
    s_add_u32 s40, s10, s80
    s_addc_u32 s41, s11, 0
    s_add_u32 m0, s23, 0
    s_nop 0
    global_load_lds_dwordx4 v2, s[40:41]
    s_add_u32 s40, s10, s81
    s_addc_u32 s41, s11, 0
    s_add_u32 m0, s23, 1024
    s_nop 0
    global_load_lds_dwordx4 v2, s[40:41]
    s_add_u32 s40, s10, s82
    s_addc_u32 s41, s11, 0
    s_add_u32 m0, s23, 2048
    s_nop 0
    global_load_lds_dwordx4 v2, s[40:41]
    s_add_u32 s40, s10, s83
    s_addc_u32 s41, s11, 0
    s_add_u32 m0, s23, 3072
    s_nop 0
    global_load_lds_dwordx4 v2, s[40:41]
    s_add_u32 s40, s10, s84
    s_addc_u32 s41, s11, 0
    s_add_u32 m0, s23, 4096
    s_nop 0
    global_load_lds_dwordx4 v2, s[40:41]
    s_add_u32 s40, s10, s85
    s_addc_u32 s41, s11, 0
    s_add_u32 m0, s23, 5120
    s_nop 0
    global_load_lds_dwordx4 v2, s[40:41]
    s_add_u32 s40, s10, s86
    s_addc_u32 s41, s11, 0
    s_add_u32 m0, s23, 6144
    s_nop 0
    global_load_lds_dwordx4 v2, s[40:41]
    s_add_u32 s10, s10, 114688
    s_addc_u32 s11, s11, 0
L_tt_nox:
    ds_read_b128 v[32:35], v5 offset:0
    ds_read_b128 v[36:39], v5 offset:1024
    ds_read_b128 v[40:43], v5 offset:2048
    ds_read_b128 v[44:47], v5 offset:3072
    s_waitcnt lgkmcnt(3)
    v_mfma_f32_16x16x32_bf16 v[64:67], a[0:3], v[32:35], 0
    ds_read_b128 v[48:51], v5 offset:4096
    v_mfma_f32_16x16x32_bf16 v[72:75], a[56:59], v[32:35], 0
    v_mfma_f32_16x16x32_bf16 v[80:83], a[112:115], v[32:35], 0
    v_mfma_f32_16x16x32_bf16 v[88:91], a[168:171], v[32:35], 0
    v_mfma_f32_16x16x32_bf16 v[96:99], a[224:227], v[32:35], 0
    v_mfma_f32_16x16x32_bf16 v[104:107], v[200:203], v[32:35], 0
    v_mfma_f32_16x16x32_bf16 v[112:115], v[120:123], v[32:35], 0
    s_waitcnt lgkmcnt(3)
    v_mfma_f32_16x16x32_bf16 v[68:71], a[0:3], v[36:39], 0
    ds_read_b128 v[52:55], v5 offset:5120
    v_mfma_f32_16x16x32_bf16 v[76:79], a[56:59], v[36:39], 0
    v_mfma_f32_16x16x32_bf16 v[84:87], a[112:115], v[36:39], 0
    v_mfma_f32_16x16x32_bf16 v[92:95], a[168:171], v[36:39], 0
    v_mfma_f32_16x16x32_bf16 v[100:103], a[224:227], v[36:39], 0
    v_mfma_f32_16x16x32_bf16 v[108:111], v[200:203], v[36:39], 0
    v_mfma_f32_16x16x32_bf16 v[116:119], v[120:123], v[36:39], 0
    s_waitcnt lgkmcnt(3)
    v_mfma_f32_16x16x32_bf16 v[64:67], a[4:7], v[40:43], v[64:67]
    ds_read_b128 v[32:35], v5 offset:6144
    v_mfma_f32_16x16x32_bf16 v[72:75], a[60:63], v[40:43], v[72:75]
    v_mfma_f32_16x16x32_bf16 v[80:83], a[116:119], v[40:43], v[80:83]
    v_mfma_f32_16x16x32_bf16 v[88:91], a[172:175], v[40:43], v[88:91]
    v_mfma_f32_16x16x32_bf16 v[96:99], a[228:231], v[40:43], v[96:99]
    v_mfma_f32_16x16x32_bf16 v[104:107], v[204:207], v[40:43], v[104:107]
    v_mfma_f32_16x16x32_bf16 v[112:115], v[124:127], v[40:43], v[112:115]
    s_waitcnt lgkmcnt(3)
    v_mfma_f32_16x16x32_bf16 v[68:71], a[4:7], v[44:47], v[68:71]
    ds_read_b128 v[36:39], v5 offset:7168
    v_mfma_f32_16x16x32_bf16 v[76:79], a[60:63], v[44:47], v[76:79]
    v_mfma_f32_16x16x32_bf16 v[84:87], a[116:119], v[44:47], v[84:87]
    v_mfma_f32_16x16x32_bf16 v[92:95], a[172:175], v[44:47], v[92:95]
    v_mfma_f32_16x16x32_bf16 v[100:103], a[228:231], v[44:47], v[100:103]
    v_mfma_f32_16x16x32_bf16 v[108:111], v[204:207], v[44:47], v[108:111]
    v_mfma_f32_16x16x32_bf16 v[116:119], v[124:127], v[44:47], v[116:119]
    s_waitcnt lgkmcnt(3)
    v_mfma_f32_16x16x32_bf16 v[64:67], a[8:11], v[48:51], v[64:67]
    ds_read_b128 v[40:43], v5 offset:8192
    v_mfma_f32_16x16x32_bf16 v[72:75], a[64:67], v[48:51], v[72:75]
    v_mfma_f32_16x16x32_bf16 v[80:83], a[120:123], v[48:51], v[80:83]
    v_mfma_f32_16x16x32_bf16 v[88:91], a[176:179], v[48:51], v[88:91]
    v_mfma_f32_16x16x32_bf16 v[96:99], a[232:235], v[48:51], v[96:99]
    v_mfma_f32_16x16x32_bf16 v[104:107], v[208:211], v[48:51], v[104:107]
    v_mfma_f32_16x16x32_bf16 v[112:115], v[128:131], v[48:51], v[112:115]
    s_waitcnt lgkmcnt(3)
    v_mfma_f32_16x16x32_bf16 v[68:71], a[8:11], v[52:55], v[68:71]
    ds_read_b128 v[44:47], v5 offset:9216
    v_mfma_f32_16x16x32_bf16 v[76:79], a[64:67], v[52:55], v[76:79]
    v_mfma_f32_16x16x32_bf16 v[84:87], a[120:123], v[52:55], v[84:87]
    v_mfma_f32_16x16x32_bf16 v[92:95], a[176:179], v[52:55], v[92:95]
    v_mfma_f32_16x16x32_bf16 v[100:103], a[232:235], v[52:55], v[100:103]
    v_mfma_f32_16x16x32_bf16 v[108:111], v[208:211], v[52:55], v[108:111]
    v_mfma_f32_16x16x32_bf16 v[116:119], v[128:131], v[52:55], v[116:119]
    s_waitcnt lgkmcnt(3)
    v_mfma_f32_16x16x32_bf16 v[64:67], a[12:15], v[32:35], v[64:67]
    ds_read_b128 v[48:51], v5 offset:10240
    v_mfma_f32_16x16x32_bf16 v[72:75], a[68:71], v[32:35], v[72:75]
    v_mfma_f32_16x16x32_bf16 v[80:83], a[124:127], v[32:35], v[80:83]
    v_mfma_f32_16x16x32_bf16 v[88:91], a[180:183], v[32:35], v[88:91]
    v_mfma_f32_16x16x32_bf16 v[96:99], a[236:239], v[32:35], v[96:99]
    v_mfma_f32_16x16x32_bf16 v[104:107], v[212:215], v[32:35], v[104:107]
    v_mfma_f32_16x16x32_bf16 v[112:115], v[132:135], v[32:35], v[112:115]
    s_waitcnt lgkmcnt(3)
    v_mfma_f32_16x16x32_bf16 v[68:71], a[12:15], v[36:39], v[68:71]
    ds_read_b128 v[52:55], v5 offset:11264
    v_mfma_f32_16x16x32_bf16 v[76:79], a[68:71], v[36:39], v[76:79]
    v_mfma_f32_16x16x32_bf16 v[84:87], a[124:127], v[36:39], v[84:87]
    v_mfma_f32_16x16x32_bf16 v[92:95], a[180:183], v[36:39], v[92:95]
    v_mfma_f32_16x16x32_bf16 v[100:103], a[236:239], v[36:39], v[100:103]
    v_mfma_f32_16x16x32_bf16 v[108:111], v[212:215], v[36:39], v[108:111]
    v_mfma_f32_16x16x32_bf16 v[116:119], v[132:135], v[36:39], v[116:119]
    s_waitcnt lgkmcnt(3)
    v_mfma_f32_16x16x32_bf16 v[64:67], a[16:19], v[40:43], v[64:67]
    ds_read_b128 v[32:35], v5 offset:12288
    v_mfma_f32_16x16x32_bf16 v[72:75], a[72:75], v[40:43], v[72:75]
    v_mfma_f32_16x16x32_bf16 v[80:83], a[128:131], v[40:43], v[80:83]
    v_mfma_f32_16x16x32_bf16 v[88:91], a[184:187], v[40:43], v[88:91]
    v_mfma_f32_16x16x32_bf16 v[96:99], a[240:243], v[40:43], v[96:99]
    v_mfma_f32_16x16x32_bf16 v[104:107], v[216:219], v[40:43], v[104:107]
    v_mfma_f32_16x16x32_bf16 v[112:115], v[136:139], v[40:43], v[112:115]
    s_waitcnt lgkmcnt(3)
    v_mfma_f32_16x16x32_bf16 v[68:71], a[16:19], v[44:47], v[68:71]
    ds_read_b128 v[36:39], v5 offset:13312
    v_mfma_f32_16x16x32_bf16 v[76:79], a[72:75], v[44:47], v[76:79]
    v_mfma_f32_16x16x32_bf16 v[84:87], a[128:131], v[44:47], v[84:87]
    v_mfma_f32_16x16x32_bf16 v[92:95], a[184:187], v[44:47], v[92:95]
    v_mfma_f32_16x16x32_bf16 v[100:103], a[240:243], v[44:47], v[100:103]
    v_mfma_f32_16x16x32_bf16 v[108:111], v[216:219], v[44:47], v[108:111]
    v_mfma_f32_16x16x32_bf16 v[116:119], v[136:139], v[44:47], v[116:119]
    s_waitcnt lgkmcnt(3)
    v_mfma_f32_16x16x32_bf16 v[64:67], a[20:23], v[48:51], v[64:67]
    ds_read_b128 v[40:43], v5 offset:14336
    v_mfma_f32_16x16x32_bf16 v[72:75], a[76:79], v[48:51], v[72:75]
    v_mfma_f32_16x16x32_bf16 v[80:83], a[132:135], v[48:51], v[80:83]
    v_mfma_f32_16x16x32_bf16 v[88:91], a[188:191], v[48:51], v[88:91]
    v_mfma_f32_16x16x32_bf16 v[96:99], a[244:247], v[48:51], v[96:99]
    v_mfma_f32_16x16x32_bf16 v[104:107], v[220:223], v[48:51], v[104:107]
    v_mfma_f32_16x16x32_bf16 v[112:115], v[140:143], v[48:51], v[112:115]
    s_waitcnt lgkmcnt(3)
    v_mfma_f32_16x16x32_bf16 v[68:71], a[20:23], v[52:55], v[68:71]
    ds_read_b128 v[44:47], v5 offset:15360
    v_mfma_f32_16x16x32_bf16 v[76:79], a[76:79], v[52:55], v[76:79]
    v_mfma_f32_16x16x32_bf16 v[84:87], a[132:135], v[52:55], v[84:87]
    v_mfma_f32_16x16x32_bf16 v[92:95], a[188:191], v[52:55], v[92:95]
    v_mfma_f32_16x16x32_bf16 v[100:103], a[244:247], v[52:55], v[100:103]
    v_mfma_f32_16x16x32_bf16 v[108:111], v[220:223], v[52:55], v[108:111]
    v_mfma_f32_16x16x32_bf16 v[116:119], v[140:143], v[52:55], v[116:119]
    s_waitcnt lgkmcnt(3)
    v_mfma_f32_16x16x32_bf16 v[64:67], a[24:27], v[32:35], v[64:67]
    ds_read_b128 v[48:51], v5 offset:16384
    v_mfma_f32_16x16x32_bf16 v[72:75], a[80:83], v[32:35], v[72:75]
    v_mfma_f32_16x16x32_bf16 v[80:83], a[136:139], v[32:35], v[80:83]
    v_mfma_f32_16x16x32_bf16 v[88:91], a[192:195], v[32:35], v[88:91]
    v_mfma_f32_16x16x32_bf16 v[96:99], a[248:251], v[32:35], v[96:99]
    v_mfma_f32_16x16x32_bf16 v[104:107], v[224:227], v[32:35], v[104:107]
    v_mfma_f32_16x16x32_bf16 v[112:115], v[144:147], v[32:35], v[112:115]
    s_waitcnt lgkmcnt(3)
    v_mfma_f32_16x16x32_bf16 v[68:71], a[24:27], v[36:39], v[68:71]
    ds_read_b128 v[52:55], v5 offset:17408
    v_mfma_f32_16x16x32_bf16 v[76:79], a[80:83], v[36:39], v[76:79]
    v_mfma_f32_16x16x32_bf16 v[84:87], a[136:139], v[36:39], v[84:87]
    v_mfma_f32_16x16x32_bf16 v[92:95], a[192:195], v[36:39], v[92:95]
    v_mfma_f32_16x16x32_bf16 v[100:103], a[248:251], v[36:39], v[100:103]
    v_mfma_f32_16x16x32_bf16 v[108:111], v[224:227], v[36:39], v[108:111]
    v_mfma_f32_16x16x32_bf16 v[116:119], v[144:147], v[36:39], v[116:119]
    s_waitcnt lgkmcnt(3)
    v_mfma_f32_16x16x32_bf16 v[64:67], a[28:31], v[40:43], v[64:67]
    ds_read_b128 v[32:35], v5 offset:18432
    v_mfma_f32_16x16x32_bf16 v[72:75], a[84:87], v[40:43], v[72:75]
    v_mfma_f32_16x16x32_bf16 v[80:83], a[140:143], v[40:43], v[80:83]
    v_mfma_f32_16x16x32_bf16 v[88:91], a[196:199], v[40:43], v[88:91]
    v_mfma_f32_16x16x32_bf16 v[96:99], a[252:255], v[40:43], v[96:99]
    v_mfma_f32_16x16x32_bf16 v[104:107], v[228:231], v[40:43], v[104:107]
    v_mfma_f32_16x16x32_bf16 v[112:115], v[148:151], v[40:43], v[112:115]
    s_waitcnt lgkmcnt(3)
    v_mfma_f32_16x16x32_bf16 v[68:71], a[28:31], v[44:47], v[68:71]
    ds_read_b128 v[36:39], v5 offset:19456
    v_mfma_f32_16x16x32_bf16 v[76:79], a[84:87], v[44:47], v[76:79]
    v_mfma_f32_16x16x32_bf16 v[84:87], a[140:143], v[44:47], v[84:87]
    v_mfma_f32_16x16x32_bf16 v[92:95], a[196:199], v[44:47], v[92:95]
    v_mfma_f32_16x16x32_bf16 v[100:103], a[252:255], v[44:47], v[100:103]
    v_mfma_f32_16x16x32_bf16 v[108:111], v[228:231], v[44:47], v[108:111]
    v_mfma_f32_16x16x32_bf16 v[116:119], v[148:151], v[44:47], v[116:119]
    s_waitcnt lgkmcnt(3)
    v_mfma_f32_16x16x32_bf16 v[64:67], a[32:35], v[48:51], v[64:67]
    ds_read_b128 v[40:43], v5 offset:20480
    v_mfma_f32_16x16x32_bf16 v[72:75], a[88:91], v[48:51], v[72:75]
    v_mfma_f32_16x16x32_bf16 v[80:83], a[144:147], v[48:51], v[80:83]
    v_mfma_f32_16x16x32_bf16 v[88:91], a[200:203], v[48:51], v[88:91]
    v_mfma_f32_16x16x32_bf16 v[96:99], v[176:179], v[48:51], v[96:99]
    v_mfma_f32_16x16x32_bf16 v[104:107], v[232:235], v[48:51], v[104:107]
    v_mfma_f32_16x16x32_bf16 v[112:115], v[152:155], v[48:51], v[112:115]
    s_waitcnt lgkmcnt(3)
    v_mfma_f32_16x16x32_bf16 v[68:71], a[32:35], v[52:55], v[68:71]
    ds_read_b128 v[44:47], v5 offset:21504
    v_mfma_f32_16x16x32_bf16 v[76:79], a[88:91], v[52:55], v[76:79]
    v_mfma_f32_16x16x32_bf16 v[84:87], a[144:147], v[52:55], v[84:87]
    v_mfma_f32_16x16x32_bf16 v[92:95], a[200:203], v[52:55], v[92:95]
    v_mfma_f32_16x16x32_bf16 v[100:103], v[176:179], v[52:55], v[100:103]
    v_mfma_f32_16x16x32_bf16 v[108:111], v[232:235], v[52:55], v[108:111]
    v_mfma_f32_16x16x32_bf16 v[116:119], v[152:155], v[52:55], v[116:119]
    s_waitcnt lgkmcnt(3)
    v_mfma_f32_16x16x32_bf16 v[64:67], a[36:39], v[32:35], v[64:67]
    ds_read_b128 v[48:51], v5 offset:22528
    v_mfma_f32_16x16x32_bf16 v[72:75], a[92:95], v[32:35], v[72:75]
    v_mfma_f32_16x16x32_bf16 v[80:83], a[148:151], v[32:35], v[80:83]
    v_mfma_f32_16x16x32_bf16 v[88:91], a[204:207], v[32:35], v[88:91]
    v_mfma_f32_16x16x32_bf16 v[96:99], v[180:183], v[32:35], v[96:99]
    v_mfma_f32_16x16x32_bf16 v[104:107], v[236:239], v[32:35], v[104:107]
    v_mfma_f32_16x16x32_bf16 v[112:115], v[156:159], v[32:35], v[112:115]
    s_waitcnt lgkmcnt(3)
    v_mfma_f32_16x16x32_bf16 v[68:71], a[36:39], v[36:39], v[68:71]
    ds_read_b128 v[52:55], v5 offset:23552
    v_mfma_f32_16x16x32_bf16 v[76:79], a[92:95], v[36:39], v[76:79]
    v_mfma_f32_16x16x32_bf16 v[84:87], a[148:151], v[36:39], v[84:87]
    v_mfma_f32_16x16x32_bf16 v[92:95], a[204:207], v[36:39], v[92:95]
    v_mfma_f32_16x16x32_bf16 v[100:103], v[180:183], v[36:39], v[100:103]
    v_mfma_f32_16x16x32_bf16 v[108:111], v[236:239], v[36:39], v[108:111]
    v_mfma_f32_16x16x32_bf16 v[116:119], v[156:159], v[36:39], v[116:119]
    s_waitcnt lgkmcnt(3)
    v_mfma_f32_16x16x32_bf16 v[64:67], a[40:43], v[40:43], v[64:67]
    ds_read_b128 v[32:35], v5 offset:24576
    v_mfma_f32_16x16x32_bf16 v[72:75], a[96:99], v[40:43], v[72:75]
    v_mfma_f32_16x16x32_bf16 v[80:83], a[152:155], v[40:43], v[80:83]
    v_mfma_f32_16x16x32_bf16 v[88:91], a[208:211], v[40:43], v[88:91]
    v_mfma_f32_16x16x32_bf16 v[96:99], v[184:187], v[40:43], v[96:99]
    v_mfma_f32_16x16x32_bf16 v[104:107], v[240:243], v[40:43], v[104:107]
    v_mfma_f32_16x16x32_bf16 v[112:115], v[160:163], v[40:43], v[112:115]
    s_waitcnt lgkmcnt(3)
    v_mfma_f32_16x16x32_bf16 v[68:71], a[40:43], v[44:47], v[68:71]
    ds_read_b128 v[36:39], v5 offset:25600
    v_mfma_f32_16x16x32_bf16 v[76:79], a[96:99], v[44:47], v[76:79]
    v_mfma_f32_16x16x32_bf16 v[84:87], a[152:155], v[44:47], v[84:87]
    v_mfma_f32_16x16x32_bf16 v[92:95], a[208:211], v[44:47], v[92:95]
    v_mfma_f32_16x16x32_bf16 v[100:103], v[184:187], v[44:47], v[100:103]
    v_mfma_f32_16x16x32_bf16 v[108:111], v[240:243], v[44:47], v[108:111]
    v_mfma_f32_16x16x32_bf16 v[116:119], v[160:163], v[44:47], v[116:119]
    s_waitcnt lgkmcnt(3)
    v_mfma_f32_16x16x32_bf16 v[64:67], a[44:47], v[48:51], v[64:67]
    ds_read_b128 v[40:43], v5 offset:26624
    v_mfma_f32_16x16x32_bf16 v[72:75], a[100:103], v[48:51], v[72:75]
    v_mfma_f32_16x16x32_bf16 v[80:83], a[156:159], v[48:51], v[80:83]
    v_mfma_f32_16x16x32_bf16 v[88:91], a[212:215], v[48:51], v[88:91]
    v_mfma_f32_16x16x32_bf16 v[96:99], v[188:191], v[48:51], v[96:99]
    v_mfma_f32_16x16x32_bf16 v[104:107], v[244:247], v[48:51], v[104:107]
    v_mfma_f32_16x16x32_bf16 v[112:115], v[164:167], v[48:51], v[112:115]
    s_waitcnt lgkmcnt(3)
    v_mfma_f32_16x16x32_bf16 v[68:71], a[44:47], v[52:55], v[68:71]
    ds_read_b128 v[44:47], v5 offset:27648
    v_mfma_f32_16x16x32_bf16 v[76:79], a[100:103], v[52:55], v[76:79]
    v_mfma_f32_16x16x32_bf16 v[84:87], a[156:159], v[52:55], v[84:87]
    v_mfma_f32_16x16x32_bf16 v[92:95], a[212:215], v[52:55], v[92:95]
    v_mfma_f32_16x16x32_bf16 v[100:103], v[188:191], v[52:55], v[100:103]
    v_mfma_f32_16x16x32_bf16 v[108:111], v[244:247], v[52:55], v[108:111]
    v_mfma_f32_16x16x32_bf16 v[116:119], v[164:167], v[52:55], v[116:119]
    s_waitcnt lgkmcnt(3)
    v_mfma_f32_16x16x32_bf16 v[64:67], a[48:51], v[32:35], v[64:67]
    v_mfma_f32_16x16x32_bf16 v[72:75], a[104:107], v[32:35], v[72:75]
    v_mfma_f32_16x16x32_bf16 v[80:83], a[160:163], v[32:35], v[80:83]
    v_mfma_f32_16x16x32_bf16 v[88:91], a[216:219], v[32:35], v[88:91]
    v_mfma_f32_16x16x32_bf16 v[96:99], v[192:195], v[32:35], v[96:99]
    v_mfma_f32_16x16x32_bf16 v[104:107], v[248:251], v[32:35], v[104:107]
    v_mfma_f32_16x16x32_bf16 v[112:115], v[168:171], v[32:35], v[112:115]
    s_waitcnt lgkmcnt(2)
    v_mfma_f32_16x16x32_bf16 v[68:71], a[48:51], v[36:39], v[68:71]
    v_mfma_f32_16x16x32_bf16 v[76:79], a[104:107], v[36:39], v[76:79]
    v_mfma_f32_16x16x32_bf16 v[84:87], a[160:163], v[36:39], v[84:87]
    v_mfma_f32_16x16x32_bf16 v[92:95], a[216:219], v[36:39], v[92:95]
    v_mfma_f32_16x16x32_bf16 v[100:103], v[192:195], v[36:39], v[100:103]
    v_mfma_f32_16x16x32_bf16 v[108:111], v[248:251], v[36:39], v[108:111]
    v_mfma_f32_16x16x32_bf16 v[116:119], v[168:171], v[36:39], v[116:119]
    s_waitcnt lgkmcnt(1)
    v_mfma_f32_16x16x32_bf16 v[64:67], a[52:55], v[40:43], v[64:67]
    v_mfma_f32_16x16x32_bf16 v[72:75], a[108:111], v[40:43], v[72:75]
    v_mfma_f32_16x16x32_bf16 v[80:83], a[164:167], v[40:43], v[80:83]
    v_mfma_f32_16x16x32_bf16 v[88:91], a[220:223], v[40:43], v[88:91]
    v_mfma_f32_16x16x32_bf16 v[96:99], v[196:199], v[40:43], v[96:99]
    v_mfma_f32_16x16x32_bf16 v[104:107], v[252:255], v[40:43], v[104:107]
    v_mfma_f32_16x16x32_bf16 v[112:115], v[172:175], v[40:43], v[112:115]
    s_waitcnt lgkmcnt(0)
    v_mfma_f32_16x16x32_bf16 v[68:71], a[52:55], v[44:47], v[68:71]
    v_mfma_f32_16x16x32_bf16 v[76:79], a[108:111], v[44:47], v[76:79]
    v_mfma_f32_16x16x32_bf16 v[84:87], a[164:167], v[44:47], v[84:87]
    v_mfma_f32_16x16x32_bf16 v[92:95], a[220:223], v[44:47], v[92:95]
    v_mfma_f32_16x16x32_bf16 v[100:103], v[196:199], v[44:47], v[100:103]
    v_mfma_f32_16x16x32_bf16 v[108:111], v[252:255], v[44:47], v[108:111]
    v_mfma_f32_16x16x32_bf16 v[116:119], v[172:175], v[44:47], v[116:119]
    v_xor_b32 v5, 0x8000, v5
    v_cvt_pk_bf16_f32 v8, v64, v65
    v_cvt_pk_bf16_f32 v9, v66, v67
    v_cvt_pk_bf16_f32 v10, v72, v73
    v_cvt_pk_bf16_f32 v11, v74, v75
    v_cvt_pk_bf16_f32 v16, v80, v81
    v_cvt_pk_bf16_f32 v17, v82, v83
    v_cvt_pk_bf16_f32 v18, v88, v89
    v_cvt_pk_bf16_f32 v19, v90, v91
    v_cvt_pk_bf16_f32 v24, v96, v97
    v_cvt_pk_bf16_f32 v25, v98, v99
    v_cvt_pk_bf16_f32 v26, v104, v105
    v_cvt_pk_bf16_f32 v27, v106, v107
    v_cvt_pk_bf16_f32 v32, v112, v113
    v_cvt_pk_bf16_f32 v33, v114, v115
    v_cvt_pk_bf16_f32 v12, v68, v69
    v_cvt_pk_bf16_f32 v13, v70, v71
    v_cvt_pk_bf16_f32 v14, v76, v77
    v_cvt_pk_bf16_f32 v15, v78, v79
    v_cvt_pk_bf16_f32 v20, v84, v85
    v_cvt_pk_bf16_f32 v21, v86, v87
    v_cvt_pk_bf16_f32 v22, v92, v93
    v_cvt_pk_bf16_f32 v23, v94, v95
    v_cvt_pk_bf16_f32 v28, v100, v101
    v_cvt_pk_bf16_f32 v29, v102, v103
    v_cvt_pk_bf16_f32 v30, v108, v109
    v_cvt_pk_bf16_f32 v31, v110, v111
    v_cvt_pk_bf16_f32 v34, v116, v117
    v_cvt_pk_bf16_f32 v35, v118, v119
    ds_read2_b64 v[64:67], v4 offset0:0 offset1:2
    ds_read2_b64 v[68:71], v4 offset0:128 offset1:130
    v_add_u32 v4, 2048, v4
    ds_read2_b64 v[72:75], v4 offset0:0 offset1:2
    ds_read2_b64 v[76:79], v4 offset0:128 offset1:130
    v_add_u32 v4, 2048, v4
    ds_read2_b64 v[80:83], v4 offset0:0 offset1:2
    ds_read2_b64 v[84:87], v4 offset0:128 offset1:130
    v_add_u32 v4, 4294963200, v4
    ds_read_b64 v[88:89], v1 offset:0
    ds_read_b64 v[90:91], v1 offset:1024
    v_xor_b32 v4, 0x8000, v4
    v_xor_b32 v1, 0x8000, v1
    s_waitcnt lgkmcnt(0)
    v_mfma_f32_16x16x32_bf16 v[96:99], v[64:67], v[8:11], 0
    v_mfma_f32_16x16x32_bf16 v[96:99], v[72:75], v[16:19], v[96:99]
    v_mfma_f32_16x16x32_bf16 v[96:99], v[80:83], v[24:27], v[96:99]
    s_nop 5
    v_mfma_f32_16x16x16_bf16 v[96:99], v[88:89], v[32:33], v[96:99]
    v_mfma_f32_16x16x32_bf16 v[100:103], v[64:67], v[12:15], 0
    v_mfma_f32_16x16x32_bf16 v[100:103], v[72:75], v[20:23], v[100:103]
    v_mfma_f32_16x16x32_bf16 v[100:103], v[80:83], v[28:31], v[100:103]
    s_nop 5
    v_mfma_f32_16x16x16_bf16 v[100:103], v[88:89], v[34:35], v[100:103]
    v_mfma_f32_16x16x32_bf16 v[104:107], v[68:71], v[12:15], 0
    v_mfma_f32_16x16x32_bf16 v[104:107], v[76:79], v[20:23], v[104:107]
    v_mfma_f32_16x16x32_bf16 v[104:107], v[84:87], v[28:31], v[104:107]
    s_nop 5
    v_mfma_f32_16x16x16_bf16 v[104:107], v[90:91], v[34:35], v[104:107]
    s_cmp_eq_u32 s5, 63
    s_cbranch_scc1 L_tt_exp
    s_waitcnt lgkmcnt(0)
    s_nop 4
    ds_write_b128 v60, v[96:99] offset:32
    ds_write_b128 v60, v[100:103] offset:2848
    ds_write_b128 v60, v[104:107] offset:2912
    s_cmp_lg_u32 s4, 0
    s_cbranch_scc1 L_tt_mh
    v_mov_b32 v64, 4000
L_tt_ml:
    global_load_dword v65, v64, s[18:19] sc1
    s_add_u32 s6, s6, 1
    s_cmp_gt_u32 s6, 1048576
    s_cbranch_scc1 L_bail
    s_waitcnt vmcnt(0)
    v_cmp_eq_u32 vcc, s7, v65
    s_cbranch_vccz L_tt_mh
    s_sleep 2
    s_branch L_tt_ml
L_tt_mh:
    s_barrier
L_tt_mf:
    global_load_dwordx4 v[64:67], v56, s[18:19] sc1
    global_load_dwordx4 v[68:71], v57, s[18:19] sc1
    s_add_u32 s6, s6, 1
    s_cmp_gt_u32 s6, 1048576
    s_cbranch_scc1 L_bail
    s_waitcnt vmcnt(0)
    v_max3_u32 v72, v64, v65, v66
    v_max3_u32 v72, v72, v67, v68
    v_max3_u32 v72, v72, v69, v70
    v_max_u32 v72, v72, v71
    v_cmp_eq_u32 vcc, s7, v72
    s_cbranch_vccnz L_tt_mf
    ds_write_b128 v56, v[64:67] offset:61440
    ds_write_b128 v57, v[68:71] offset:61440
    s_waitcnt lgkmcnt(0)
    s_barrier
    ds_read_b128 v[36:39], v58 offset:0
    ds_read_b128 v[40:43], v58 offset:512
    ds_read_b128 v[44:47], v58 offset:1024
    ds_read_b64 v[48:49], v59
    s_waitcnt lgkmcnt(1)
    v_mfma_f32_16x16x32_bf16 v[108:111], v[36:39], v[8:11], 0
    v_mfma_f32_16x16x32_bf16 v[112:115], v[36:39], v[12:15], 0
    v_mfma_f32_16x16x32_bf16 v[108:111], v[40:43], v[16:19], v[108:111]
    v_mfma_f32_16x16x32_bf16 v[112:115], v[40:43], v[20:23], v[112:115]
    v_mfma_f32_16x16x32_bf16 v[108:111], v[44:47], v[24:27], v[108:111]
    v_mfma_f32_16x16x32_bf16 v[112:115], v[44:47], v[28:31], v[112:115]
    s_waitcnt lgkmcnt(0)
    v_mfma_f32_16x16x16_bf16 v[108:111], v[48:49], v[32:33], v[108:111]
    v_mfma_f32_16x16x16_bf16 v[112:115], v[48:49], v[34:35], v[112:115]
    s_mov_b32 exec_hi, 0
    s_nop 2
    ds_write_b128 v60, v[108:111]
    s_nop 2
    ds_write_b128 v60, v[112:115] offset:2816
    s_mov_b64 exec, -1
    s_waitcnt lgkmcnt(0)
    s_barrier
    ds_read_b128 v[64:67], v61 offset:0
    ds_read_b128 v[68:71], v62 offset:0
    ds_read_b128 v[72:75], v61 offset:5632
    ds_read_b128 v[76:79], v62 offset:5632
    ds_read_b128 v[80:83], v61 offset:11264
    ds_read_b128 v[84:87], v62 offset:11264
    ds_read_b128 v[88:91], v61 offset:16896
    ds_read_b128 v[92:95], v62 offset:16896
    v_mov_b32 v37, 0xff800000
    s_waitcnt lgkmcnt(0)
    v_pk_add_f32 v[64:65], v[64:65], v[72:73]
    v_pk_add_f32 v[66:67], v[66:67], v[74:75]
    v_pk_add_f32 v[68:69], v[68:69], v[76:77]
    v_pk_add_f32 v[70:71], v[70:71], v[78:79]
    v_pk_add_f32 v[80:81], v[80:81], v[88:89]
    v_pk_add_f32 v[82:83], v[82:83], v[90:91]
    v_pk_add_f32 v[84:85], v[84:85], v[92:93]
    v_pk_add_f32 v[86:87], v[86:87], v[94:95]
    v_pk_add_f32 v[64:65], v[64:65], v[80:81]
    v_pk_add_f32 v[66:67], v[66:67], v[82:83]
    v_pk_add_f32 v[68:69], v[68:69], v[84:85]
    v_pk_add_f32 v[70:71], v[70:71], v[86:87]
    v_cndmask_b32 v64, v37, v64, s[48:49]
    v_cndmask_b32 v65, v37, v65, s[50:51]
    v_cndmask_b32 v66, v37, v66, s[52:53]
    v_cndmask_b32 v67, v37, v67, s[54:55]
    v_cndmask_b32 v68, v37, v68, s[56:57]
    v_cndmask_b32 v69, v37, v69, s[58:59]
    v_cndmask_b32 v70, v37, v70, s[60:61]
    v_cndmask_b32 v71, v37, v71, s[62:63]
    v_max3_f32 v36, v64, v65, v66
    v_max3_f32 v36, v36, v67, v68
    v_max3_f32 v36, v36, v69, v70
    v_max_f32 v36, v36, v71
    s_nop 1
    v_max_f32_dpp v36, v36, v36 quad_perm:[1,0,3,2] row_mask:0xf bank_mask:0xf
    s_nop 1
    v_max_f32_dpp v36, v36, v36 quad_perm:[2,3,0,1] row_mask:0xf bank_mask:0xf
    s_nop 1
    v_max_f32_dpp v36, v36, v36 row_half_mirror row_mask:0xf bank_mask:0xf
    v_sub_f32 v64, v64, v36
    v_sub_f32 v65, v65, v36
    v_sub_f32 v66, v66, v36
    v_sub_f32 v67, v67, v36
    v_sub_f32 v68, v68, v36
    v_sub_f32 v69, v69, v36
    v_sub_f32 v70, v70, v36
    v_sub_f32 v71, v71, v36
    v_exp_f32 v64, v64
    v_exp_f32 v65, v65
    v_exp_f32 v66, v66
    v_exp_f32 v67, v67
    v_exp_f32 v68, v68
    v_exp_f32 v69, v69
    v_exp_f32 v70, v70
    v_exp_f32 v71, v71
    v_pk_add_f32 v[36:37], v[64:65], v[66:67]
    v_pk_add_f32 v[38:39], v[68:69], v[70:71]
    v_pk_add_f32 v[36:37], v[36:37], v[38:39]
    v_add_f32 v36, v36, v37
    s_nop 1
    v_add_f32_dpp v36, v36, v36 quad_perm:[1,0,3,2] row_mask:0xf bank_mask:0xf
    s_nop 1
    v_add_f32_dpp v36, v36, v36 quad_perm:[2,3,0,1] row_mask:0xf bank_mask:0xf
    s_nop 1
    v_add_f32_dpp v36, v36, v36 row_half_mirror row_mask:0xf bank_mask:0xf
    v_rcp_f32 v36, v36
    s_nop 0
    v_pk_mul_f32 v[64:65], v[64:65], v[36:37] op_sel_hi:[1,0]
    v_pk_mul_f32 v[66:67], v[66:67], v[36:37] op_sel_hi:[1,0]
    v_pk_mul_f32 v[68:69], v[68:69], v[36:37] op_sel_hi:[1,0]
    v_pk_mul_f32 v[70:71], v[70:71], v[36:37] op_sel_hi:[1,0]
    v_cvt_pk_bf16_f32 v72, v64, v65
    v_cvt_pk_bf16_f32 v76, v66, v67
    v_cvt_pk_bf16_f32 v77, v68, v69
    v_cvt_pk_bf16_f32 v75, v70, v71
    v_cndmask_b32 v73, v77, v76, s[34:35]
    v_cndmask_b32 v74, v76, v77, s[34:35]
    s_mov_b64 exec, s[32:33]
    global_store_dwordx4 v63, v[72:75], s[14:15] sc1
    s_mov_b64 exec, -1
    s_waitcnt vmcnt(0)
    s_barrier
    s_cmp_lg_u32 s4, 0
    s_cbranch_scc1 L_fs3
    global_store_dword v7, v6, s[16:17] sc1
L_fs3:
    s_add_u32 s16, s16, 4096
    s_addc_u32 s17, s17, 0
    s_add_u32 s18, s18, 28672
    s_addc_u32 s19, s19, 0
    s_add_u32 s14, s14, 163840
    s_addc_u32 s15, s15, 0
    s_add_u32 s5, s5, 4
    s_cmp_lt_u32 s5, 63
    s_cbranch_scc1 L_tt_item
    s_endpgm
L_tt_exp:
    s_lshl_b32 s42, s3, 2
    s_add_u32 s42, s42, s4
    s_mul_i32 s42, s42, 10240
    s_add_u32 s40, s8, 61353984
    s_addc_u32 s41, s9, 0
    s_add_u32 s40, s40, s42
    s_addc_u32 s41, s41, 0
    global_store_dwordx4 v3, v[8:11], s[40:41] offset:0 sc1
    global_store_dwordx4 v3, v[12:15], s[40:41] offset:1024 sc1
    global_store_dwordx4 v3, v[16:19], s[40:41] offset:2048 sc1
    global_store_dwordx4 v3, v[20:23], s[40:41] offset:3072 sc1
    s_add_u32 s40, s40, 4096
    s_addc_u32 s41, s41, 0
    global_store_dwordx4 v3, v[24:27], s[40:41] offset:0 sc1
    global_store_dwordx4 v3, v[28:31], s[40:41] offset:1024 sc1
    global_store_dwordx4 v3, v[32:35], s[40:41] offset:2048 sc1
    global_store_dwordx4 v3, v[96:99], s[40:41] offset:3072 sc1
    s_add_u32 s40, s40, 4096
    s_addc_u32 s41, s41, 0
    global_store_dwordx4 v3, v[100:103], s[40:41] offset:0 sc1
    global_store_dwordx4 v3, v[104:107], s[40:41] offset:1024 sc1
    v_mov_b32 v64, s7
    v_mov_b32 v65, s7
    v_mov_b32 v66, s7
    v_mov_b32 v67, s7
    s_add_u32 s40, s14, 2457600
    s_addc_u32 s41, s15, 0
    s_lshl_b32 s44, s3, 2
    s_add_u32 s42, s8, 43978560
    s_addc_u32 s43, s9, 0
    s_add_u32 s42, s42, s44
    s_addc_u32 s43, s43, 0
    s_mov_b64 exec, s[32:33]
    global_store_dwordx4 v63, v[64:67], s[40:41] sc1
    s_mov_b64 exec, -1
    s_waitcnt vmcnt(0)
    s_barrier
    s_cmp_lg_u32 s4, 0
    s_cbranch_scc1 L_fs4
    global_store_dword v7, v6, s[42:43] sc1
L_fs4:
    s_mov_b32 s5, 3
    s_branch L_tt_item
L_ffn1:
    s_load_dwordx2 s[12:13], s[0:1], 64
    s_load_dwordx2 s[10:11], s[0:1], 0
    s_load_dwordx2 s[20:21], s[0:1], 80
    v_lshlrev_b32 v3, 4, v0
    s_mov_b32 s6, 0
    s_mov_b32 s7, 4290772927
    s_lshl_b32 s40, s3, 9
    s_lshl_b32 s41, s4, 7
    s_add_u32 s40, s40, s41
    s_waitcnt lgkmcnt(0)
    s_add_u32 s12, s12, s40
    s_addc_u32 s13, s13, 0
    s_cmp_lg_u32 s4, 0
    s_cbranch_scc1 L_f1a_rb
    s_add_u32 s40, s8, 43982848
    s_addc_u32 s41, s9, 0
    v_lshrrev_b32 v8, 1, v0
    v_and_b32 v9, 1, v0
    v_lshlrev_b32 v9, 4, v9
    v_lshl_add_u32 v8, v8, 7, v9
    s_mov_b32 s42, 0
L_f1a_rp:
    global_load_dwordx4 v[10:13], v8, s[40:41] sc1
    s_add_u32 s42, s42, 1
    s_cmp_gt_u32 s42, 1048576
    s_cbranch_scc1 L_bail
    s_waitcnt vmcnt(0)
    v_min_u32 v10, v10, v11
    v_min_u32 v10, v10, v12
    v_min_u32 v10, v10, v13
    v_cmp_eq_u32 vcc, 0, v10
    s_cbranch_vccz L_f1a_rb
    s_sleep 8
    s_branch L_f1a_rp
L_f1a_rb:
    s_barrier
    v_lshlrev_b32 v8, 4, v2
    global_load_dwordx4 v[120:123], v8, s[20:21] offset:0
    global_load_dwordx4 v[124:127], v8, s[20:21] offset:64
    global_load_dwordx4 v[128:131], v8, s[20:21] offset:128
    global_load_dwordx4 v[132:135], v8, s[20:21] offset:192
    global_load_dwordx4 v[136:139], v8, s[20:21] offset:256
    global_load_dwordx4 v[140:143], v8, s[20:21] offset:320
    global_load_dwordx4 v[144:147], v8, s[20:21] offset:384
    global_load_dwordx4 v[148:151], v8, s[20:21] offset:448
    global_load_dwordx4 v[152:155], v8, s[20:21] offset:512
    global_load_dwordx4 v[156:159], v8, s[20:21] offset:576
    global_load_dwordx4 v[160:163], v8, s[20:21] offset:640
    global_load_dwordx4 v[164:167], v8, s[20:21] offset:704
    global_load_dwordx4 v[168:171], v8, s[20:21] offset:768
    global_load_dwordx4 v[172:175], v8, s[20:21] offset:832
    s_mul_i32 s42, s4, 28672
    v_lshrrev_b32 v10, 3, v0
    v_and_b32 v11, 7, v0
    v_bfe_u32 v12, v0, 4, 1
    v_lshlrev_b32 v12, 1, v12
    v_xor_b32 v11, v11, v12
    v_mul_u32_u24 v10, 3584, v10
    v_lshl_add_u32 v8, v11, 4, v10
    v_xor_b32 v11, 4, v11
    v_lshl_add_u32 v9, v11, 4, v10
    v_bfe_u32 v10, v0, 2, 2
    v_lshl_add_u32 v11, v2, 3, v10
    v_lshlrev_b32 v11, 7, v11
    v_and_b32 v12, 1, v0
    v_lshl_add_u32 v11, v12, 3, v11
    v_add_u32 v11, s42, v11
    v_and_b32 v10, 2, v10
    v_and_b32 v12, 1, v2
    v_lshl_add_u32 v10, v12, 2, v10
    v_bfe_u32 v12, v0, 1, 1
    v_xor_b32 v10, v10, v12
    v_xor_b32 v12, 0, v10
    v_lshl_add_u32 v13, v12, 4, v11
    v_xor_b32 v12, 2, v10
    v_lshl_add_u32 v14, v12, 4, v11
    v_xor_b32 v12, 4, v10
    v_lshl_add_u32 v15, v12, 4, v11
    v_xor_b32 v12, 6, v10
    v_lshl_add_u32 v16, v12, 4, v11
    s_add_u32 m0, s42, 0
    s_nop 0
    global_load_lds_dwordx4 v8, s[12:13]
    s_add_u32 s12, s12, 28672
    s_addc_u32 s13, s13, 0
    s_add_u32 m0, s42, 1024
    s_nop 0
    global_load_lds_dwordx4 v9, s[12:13]
    s_add_u32 s12, s12, 28672
    s_addc_u32 s13, s13, 0
    s_add_u32 m0, s42, 2048
    s_nop 0
    global_load_lds_dwordx4 v8, s[12:13]
    s_add_u32 s12, s12, 28672
    s_addc_u32 s13, s13, 0
    s_add_u32 m0, s42, 3072
    s_nop 0
    global_load_lds_dwordx4 v9, s[12:13]
    s_add_u32 s12, s12, 28672
    s_addc_u32 s13, s13, 0
    s_add_u32 m0, s42, 4096
    s_nop 0
    global_load_lds_dwordx4 v8, s[12:13]
    s_add_u32 s12, s12, 28672
    s_addc_u32 s13, s13, 0
    s_add_u32 m0, s42, 5120
    s_nop 0
    global_load_lds_dwordx4 v9, s[12:13]
    s_add_u32 s12, s12, 28672
    s_addc_u32 s13, s13, 0
    s_add_u32 m0, s42, 6144
    s_nop 0
    global_load_lds_dwordx4 v8, s[12:13]
    s_add_u32 s12, s12, 28672
    s_addc_u32 s13, s13, 0
    s_add_u32 m0, s42, 7168
    s_nop 0
    global_load_lds_dwordx4 v9, s[12:13]
    s_add_u32 s12, s12, 28672
    s_addc_u32 s13, s13, 0
    s_add_u32 m0, s42, 8192
    s_nop 0
    global_load_lds_dwordx4 v8, s[12:13]
    s_add_u32 s12, s12, 28672
    s_addc_u32 s13, s13, 0
    s_add_u32 m0, s42, 9216
    s_nop 0
    global_load_lds_dwordx4 v9, s[12:13]
    s_add_u32 s12, s12, 28672
    s_addc_u32 s13, s13, 0
    s_add_u32 m0, s42, 10240
    s_nop 0
    global_load_lds_dwordx4 v8, s[12:13]
    s_add_u32 s12, s12, 28672
    s_addc_u32 s13, s13, 0
    s_add_u32 m0, s42, 11264
    s_nop 0
    global_load_lds_dwordx4 v9, s[12:13]
    s_add_u32 s12, s12, 28672
    s_addc_u32 s13, s13, 0
    s_add_u32 m0, s42, 12288
    s_nop 0
    global_load_lds_dwordx4 v8, s[12:13]
    s_add_u32 s12, s12, 28672
    s_addc_u32 s13, s13, 0
    s_add_u32 m0, s42, 13312
    s_nop 0
    global_load_lds_dwordx4 v9, s[12:13]
    s_add_u32 s12, s12, 28672
    s_addc_u32 s13, s13, 0
    s_add_u32 m0, s42, 14336
    s_nop 0
    global_load_lds_dwordx4 v8, s[12:13]
    s_add_u32 s12, s12, 28672
    s_addc_u32 s13, s13, 0
    s_add_u32 m0, s42, 15360
    s_nop 0
    global_load_lds_dwordx4 v9, s[12:13]
    s_add_u32 s12, s12, 28672
    s_addc_u32 s13, s13, 0
    s_add_u32 m0, s42, 16384
    s_nop 0
    global_load_lds_dwordx4 v8, s[12:13]
    s_add_u32 s12, s12, 28672
    s_addc_u32 s13, s13, 0
    s_add_u32 m0, s42, 17408
    s_nop 0
    global_load_lds_dwordx4 v9, s[12:13]
    s_add_u32 s12, s12, 28672
    s_addc_u32 s13, s13, 0
    s_add_u32 m0, s42, 18432
    s_nop 0
    global_load_lds_dwordx4 v8, s[12:13]
    s_add_u32 s12, s12, 28672
    s_addc_u32 s13, s13, 0
    s_add_u32 m0, s42, 19456
    s_nop 0
    global_load_lds_dwordx4 v9, s[12:13]
    s_add_u32 s12, s12, 28672
    s_addc_u32 s13, s13, 0
    s_add_u32 m0, s42, 20480
    s_nop 0
    global_load_lds_dwordx4 v8, s[12:13]
    s_add_u32 s12, s12, 28672
    s_addc_u32 s13, s13, 0
    s_add_u32 m0, s42, 21504
    s_nop 0
    global_load_lds_dwordx4 v9, s[12:13]
    s_add_u32 s12, s12, 28672
    s_addc_u32 s13, s13, 0
    s_add_u32 m0, s42, 22528
    s_nop 0
    global_load_lds_dwordx4 v8, s[12:13]
    s_add_u32 s12, s12, 28672
    s_addc_u32 s13, s13, 0
    s_add_u32 m0, s42, 23552
    s_nop 0
    global_load_lds_dwordx4 v9, s[12:13]
    s_add_u32 s12, s12, 28672
    s_addc_u32 s13, s13, 0
    s_add_u32 m0, s42, 24576
    s_nop 0
    global_load_lds_dwordx4 v8, s[12:13]
    s_add_u32 s12, s12, 28672
    s_addc_u32 s13, s13, 0
    s_add_u32 m0, s42, 25600
    s_nop 0
    global_load_lds_dwordx4 v9, s[12:13]
    s_add_u32 s12, s12, 28672
    s_addc_u32 s13, s13, 0
    s_add_u32 m0, s42, 26624
    s_nop 0
    global_load_lds_dwordx4 v8, s[12:13]
    s_add_u32 s12, s12, 28672
    s_addc_u32 s13, s13, 0
    s_add_u32 m0, s42, 27648
    s_nop 0
    global_load_lds_dwordx4 v9, s[12:13]
    s_add_u32 s12, s12, 28672
    s_addc_u32 s13, s13, 0
    s_waitcnt vmcnt(0)
    ds_read_b64_tr_b16 a[0:1], v13 offset:0
    ds_read_b64_tr_b16 a[2:3], v13 offset:512
    ds_read_b64_tr_b16 a[56:57], v14 offset:0
    ds_read_b64_tr_b16 a[58:59], v14 offset:512
    ds_read_b64_tr_b16 a[112:113], v15 offset:0
    ds_read_b64_tr_b16 a[114:115], v15 offset:512
    ds_read_b64_tr_b16 a[168:169], v16 offset:0
    ds_read_b64_tr_b16 a[170:171], v16 offset:512
    s_waitcnt lgkmcnt(0)
    ds_read_b64_tr_b16 a[4:5], v13 offset:4096
    ds_read_b64_tr_b16 a[6:7], v13 offset:4608
    ds_read_b64_tr_b16 a[60:61], v14 offset:4096
    ds_read_b64_tr_b16 a[62:63], v14 offset:4608
    ds_read_b64_tr_b16 a[116:117], v15 offset:4096
    ds_read_b64_tr_b16 a[118:119], v15 offset:4608
    ds_read_b64_tr_b16 a[172:173], v16 offset:4096
    ds_read_b64_tr_b16 a[174:175], v16 offset:4608
    s_waitcnt lgkmcnt(0)
    ds_read_b64_tr_b16 a[8:9], v13 offset:8192
    ds_read_b64_tr_b16 a[10:11], v13 offset:8704
    ds_read_b64_tr_b16 a[64:65], v14 offset:8192
    ds_read_b64_tr_b16 a[66:67], v14 offset:8704
    ds_read_b64_tr_b16 a[120:121], v15 offset:8192
    ds_read_b64_tr_b16 a[122:123], v15 offset:8704
    ds_read_b64_tr_b16 a[176:177], v16 offset:8192
    ds_read_b64_tr_b16 a[178:179], v16 offset:8704
    s_waitcnt lgkmcnt(0)
    ds_read_b64_tr_b16 a[12:13], v13 offset:12288
    ds_read_b64_tr_b16 a[14:15], v13 offset:12800
    ds_read_b64_tr_b16 a[68:69], v14 offset:12288
    ds_read_b64_tr_b16 a[70:71], v14 offset:12800
    ds_read_b64_tr_b16 a[124:125], v15 offset:12288
    ds_read_b64_tr_b16 a[126:127], v15 offset:12800
    ds_read_b64_tr_b16 a[180:181], v16 offset:12288
    ds_read_b64_tr_b16 a[182:183], v16 offset:12800
    s_waitcnt lgkmcnt(0)
    ds_read_b64_tr_b16 a[16:17], v13 offset:16384
    ds_read_b64_tr_b16 a[18:19], v13 offset:16896
    ds_read_b64_tr_b16 a[72:73], v14 offset:16384
    ds_read_b64_tr_b16 a[74:75], v14 offset:16896
    ds_read_b64_tr_b16 a[128:129], v15 offset:16384
    ds_read_b64_tr_b16 a[130:131], v15 offset:16896
    ds_read_b64_tr_b16 a[184:185], v16 offset:16384
    ds_read_b64_tr_b16 a[186:187], v16 offset:16896
    s_waitcnt lgkmcnt(0)
    ds_read_b64_tr_b16 a[20:21], v13 offset:20480
    ds_read_b64_tr_b16 a[22:23], v13 offset:20992
    ds_read_b64_tr_b16 a[76:77], v14 offset:20480
    ds_read_b64_tr_b16 a[78:79], v14 offset:20992
    ds_read_b64_tr_b16 a[132:133], v15 offset:20480
    ds_read_b64_tr_b16 a[134:135], v15 offset:20992
    ds_read_b64_tr_b16 a[188:189], v16 offset:20480
    ds_read_b64_tr_b16 a[190:191], v16 offset:20992
    s_waitcnt lgkmcnt(0)
    ds_read_b64_tr_b16 a[24:25], v13 offset:24576
    ds_read_b64_tr_b16 a[26:27], v13 offset:25088
    ds_read_b64_tr_b16 a[80:81], v14 offset:24576
    ds_read_b64_tr_b16 a[82:83], v14 offset:25088
    ds_read_b64_tr_b16 a[136:137], v15 offset:24576
    ds_read_b64_tr_b16 a[138:139], v15 offset:25088
    ds_read_b64_tr_b16 a[192:193], v16 offset:24576
    ds_read_b64_tr_b16 a[194:195], v16 offset:25088
    s_waitcnt lgkmcnt(0)
    s_add_u32 m0, s42, 0
    s_nop 0
    global_load_lds_dwordx4 v8, s[12:13]
    s_add_u32 s12, s12, 28672
    s_addc_u32 s13, s13, 0
    s_add_u32 m0, s42, 1024
    s_nop 0
    global_load_lds_dwordx4 v9, s[12:13]
    s_add_u32 s12, s12, 28672
    s_addc_u32 s13, s13, 0
    s_add_u32 m0, s42, 2048
    s_nop 0
    global_load_lds_dwordx4 v8, s[12:13]
    s_add_u32 s12, s12, 28672
    s_addc_u32 s13, s13, 0
    s_add_u32 m0, s42, 3072
    s_nop 0
    global_load_lds_dwordx4 v9, s[12:13]
    s_add_u32 s12, s12, 28672
    s_addc_u32 s13, s13, 0
    s_add_u32 m0, s42, 4096
    s_nop 0
    global_load_lds_dwordx4 v8, s[12:13]
    s_add_u32 s12, s12, 28672
    s_addc_u32 s13, s13, 0
    s_add_u32 m0, s42, 5120
    s_nop 0
    global_load_lds_dwordx4 v9, s[12:13]
    s_add_u32 s12, s12, 28672
    s_addc_u32 s13, s13, 0
    s_add_u32 m0, s42, 6144
    s_nop 0
    global_load_lds_dwordx4 v8, s[12:13]
    s_add_u32 s12, s12, 28672
    s_addc_u32 s13, s13, 0
    s_add_u32 m0, s42, 7168
    s_nop 0
    global_load_lds_dwordx4 v9, s[12:13]
    s_add_u32 s12, s12, 28672
    s_addc_u32 s13, s13, 0
    s_add_u32 m0, s42, 8192
    s_nop 0
    global_load_lds_dwordx4 v8, s[12:13]
    s_add_u32 s12, s12, 28672
    s_addc_u32 s13, s13, 0
    s_add_u32 m0, s42, 9216
    s_nop 0
    global_load_lds_dwordx4 v9, s[12:13]
    s_add_u32 s12, s12, 28672
    s_addc_u32 s13, s13, 0
    s_add_u32 m0, s42, 10240
    s_nop 0
    global_load_lds_dwordx4 v8, s[12:13]
    s_add_u32 s12, s12, 28672
    s_addc_u32 s13, s13, 0
    s_add_u32 m0, s42, 11264
    s_nop 0
    global_load_lds_dwordx4 v9, s[12:13]
    s_add_u32 s12, s12, 28672
    s_addc_u32 s13, s13, 0
    s_add_u32 m0, s42, 12288
    s_nop 0
    global_load_lds_dwordx4 v8, s[12:13]
    s_add_u32 s12, s12, 28672
    s_addc_u32 s13, s13, 0
    s_add_u32 m0, s42, 13312
    s_nop 0
    global_load_lds_dwordx4 v9, s[12:13]
    s_add_u32 s12, s12, 28672
    s_addc_u32 s13, s13, 0
    s_add_u32 m0, s42, 14336
    s_nop 0
    global_load_lds_dwordx4 v8, s[12:13]
    s_add_u32 s12, s12, 28672
    s_addc_u32 s13, s13, 0
    s_add_u32 m0, s42, 15360
    s_nop 0
    global_load_lds_dwordx4 v9, s[12:13]
    s_add_u32 s12, s12, 28672
    s_addc_u32 s13, s13, 0
    s_add_u32 m0, s42, 16384
    s_nop 0
    global_load_lds_dwordx4 v8, s[12:13]
    s_add_u32 s12, s12, 28672
    s_addc_u32 s13, s13, 0
    s_add_u32 m0, s42, 17408
    s_nop 0
    global_load_lds_dwordx4 v9, s[12:13]
    s_add_u32 s12, s12, 28672
    s_addc_u32 s13, s13, 0
    s_add_u32 m0, s42, 18432
    s_nop 0
    global_load_lds_dwordx4 v8, s[12:13]
    s_add_u32 s12, s12, 28672
    s_addc_u32 s13, s13, 0
    s_add_u32 m0, s42, 19456
    s_nop 0
    global_load_lds_dwordx4 v9, s[12:13]
    s_add_u32 s12, s12, 28672
    s_addc_u32 s13, s13, 0
    s_add_u32 m0, s42, 20480
    s_nop 0
    global_load_lds_dwordx4 v8, s[12:13]
    s_add_u32 s12, s12, 28672
    s_addc_u32 s13, s13, 0
    s_add_u32 m0, s42, 21504
    s_nop 0
    global_load_lds_dwordx4 v9, s[12:13]
    s_add_u32 s12, s12, 28672
    s_addc_u32 s13, s13, 0
    s_add_u32 m0, s42, 22528
    s_nop 0
    global_load_lds_dwordx4 v8, s[12:13]
    s_add_u32 s12, s12, 28672
    s_addc_u32 s13, s13, 0
    s_add_u32 m0, s42, 23552
    s_nop 0
    global_load_lds_dwordx4 v9, s[12:13]
    s_add_u32 s12, s12, 28672
    s_addc_u32 s13, s13, 0
    s_add_u32 m0, s42, 24576
    s_nop 0
    global_load_lds_dwordx4 v8, s[12:13]
    s_add_u32 s12, s12, 28672
    s_addc_u32 s13, s13, 0
    s_add_u32 m0, s42, 25600
    s_nop 0
    global_load_lds_dwordx4 v9, s[12:13]
    s_add_u32 s12, s12, 28672
    s_addc_u32 s13, s13, 0
    s_add_u32 m0, s42, 26624
    s_nop 0
    global_load_lds_dwordx4 v8, s[12:13]
    s_add_u32 s12, s12, 28672
    s_addc_u32 s13, s13, 0
    s_add_u32 m0, s42, 27648
    s_nop 0
    global_load_lds_dwordx4 v9, s[12:13]
    s_add_u32 s12, s12, 28672
    s_addc_u32 s13, s13, 0
    s_waitcnt vmcnt(0)
    ds_read_b64_tr_b16 a[28:29], v13 offset:0
    ds_read_b64_tr_b16 a[30:31], v13 offset:512
    ds_read_b64_tr_b16 a[84:85], v14 offset:0
    ds_read_b64_tr_b16 a[86:87], v14 offset:512
    ds_read_b64_tr_b16 a[140:141], v15 offset:0
    ds_read_b64_tr_b16 a[142:143], v15 offset:512
    ds_read_b64_tr_b16 a[196:197], v16 offset:0
    ds_read_b64_tr_b16 a[198:199], v16 offset:512
    s_waitcnt lgkmcnt(0)
    ds_read_b64_tr_b16 a[32:33], v13 offset:4096
    ds_read_b64_tr_b16 a[34:35], v13 offset:4608
    ds_read_b64_tr_b16 a[88:89], v14 offset:4096
    ds_read_b64_tr_b16 a[90:91], v14 offset:4608
    ds_read_b64_tr_b16 a[144:145], v15 offset:4096
    ds_read_b64_tr_b16 a[146:147], v15 offset:4608
    ds_read_b64_tr_b16 a[200:201], v16 offset:4096
    ds_read_b64_tr_b16 a[202:203], v16 offset:4608
    s_waitcnt lgkmcnt(0)
    ds_read_b64_tr_b16 a[36:37], v13 offset:8192
    ds_read_b64_tr_b16 a[38:39], v13 offset:8704
    ds_read_b64_tr_b16 a[92:93], v14 offset:8192
    ds_read_b64_tr_b16 a[94:95], v14 offset:8704
    ds_read_b64_tr_b16 a[148:149], v15 offset:8192
    ds_read_b64_tr_b16 a[150:151], v15 offset:8704
    ds_read_b64_tr_b16 a[204:205], v16 offset:8192
    ds_read_b64_tr_b16 a[206:207], v16 offset:8704
    s_waitcnt lgkmcnt(0)
    ds_read_b64_tr_b16 a[40:41], v13 offset:12288
    ds_read_b64_tr_b16 a[42:43], v13 offset:12800
    ds_read_b64_tr_b16 a[96:97], v14 offset:12288
    ds_read_b64_tr_b16 a[98:99], v14 offset:12800
    ds_read_b64_tr_b16 a[152:153], v15 offset:12288
    ds_read_b64_tr_b16 a[154:155], v15 offset:12800
    ds_read_b64_tr_b16 a[208:209], v16 offset:12288
    ds_read_b64_tr_b16 a[210:211], v16 offset:12800
    s_waitcnt lgkmcnt(0)
    ds_read_b64_tr_b16 a[44:45], v13 offset:16384
    ds_read_b64_tr_b16 a[46:47], v13 offset:16896
    ds_read_b64_tr_b16 a[100:101], v14 offset:16384
    ds_read_b64_tr_b16 a[102:103], v14 offset:16896
    ds_read_b64_tr_b16 a[156:157], v15 offset:16384
    ds_read_b64_tr_b16 a[158:159], v15 offset:16896
    ds_read_b64_tr_b16 a[212:213], v16 offset:16384
    ds_read_b64_tr_b16 a[214:215], v16 offset:16896
    s_waitcnt lgkmcnt(0)
    ds_read_b64_tr_b16 a[48:49], v13 offset:20480
    ds_read_b64_tr_b16 a[50:51], v13 offset:20992
    ds_read_b64_tr_b16 a[104:105], v14 offset:20480
    ds_read_b64_tr_b16 a[106:107], v14 offset:20992
    ds_read_b64_tr_b16 a[160:161], v15 offset:20480
    ds_read_b64_tr_b16 a[162:163], v15 offset:20992
    ds_read_b64_tr_b16 a[216:217], v16 offset:20480
    ds_read_b64_tr_b16 a[218:219], v16 offset:20992
    s_waitcnt lgkmcnt(0)
    ds_read_b64_tr_b16 a[52:53], v13 offset:24576
    ds_read_b64_tr_b16 a[54:55], v13 offset:25088
    ds_read_b64_tr_b16 a[108:109], v14 offset:24576
    ds_read_b64_tr_b16 a[110:111], v14 offset:25088
    ds_read_b64_tr_b16 a[164:165], v15 offset:24576
    ds_read_b64_tr_b16 a[166:167], v15 offset:25088
    ds_read_b64_tr_b16 a[220:221], v16 offset:24576
    ds_read_b64_tr_b16 a[222:223], v16 offset:25088
    s_waitcnt lgkmcnt(0)
    s_barrier
    s_mul_i32 s23, s4, 7168
    s_mul_i32 s40, s22, 28672
    s_mov_b32 s5, s22
    v_lshrrev_b32 v8, 2, v0
    v_mul_u32_u24 v8, 896, v8
    v_lshrrev_b32 v9, 5, v0
    v_lshlrev_b32 v9, 1, v9
    v_and_b32 v58, 3, v0
    v_xor_b32 v9, v9, v58
    v_lshl_add_u32 v58, v9, 4, v8
    v_lshrrev_b32 v8, 3, v1
    v_lshlrev_b32 v8, 1, v8
    v_xor_b32 v8, v8, v2
    v_lshl_add_u32 v8, v1, 2, v8
    v_lshlrev_b32 v5, 4, v8
    s_add_u32 s10, s10, s40
    s_addc_u32 s11, s11, 0
    s_mul_i32 s40, s4, 7
    s_add_u32 s40, s40, 0
    s_and_b32 s41, s40, 1
    s_mul_i32 s41, s41, 14336
    s_lshr_b32 s40, s40, 1
    s_lshl_b32 s40, s40, 6
    s_add_u32 s80, s40, s41
    s_mul_i32 s40, s4, 7
    s_add_u32 s40, s40, 1
    s_and_b32 s41, s40, 1
    s_mul_i32 s41, s41, 14336
    s_lshr_b32 s40, s40, 1
    s_lshl_b32 s40, s40, 6
    s_add_u32 s81, s40, s41
    s_mul_i32 s40, s4, 7
    s_add_u32 s40, s40, 2
    s_and_b32 s41, s40, 1
    s_mul_i32 s41, s41, 14336
    s_lshr_b32 s40, s40, 1
    s_lshl_b32 s40, s40, 6
    s_add_u32 s82, s40, s41
    s_mul_i32 s40, s4, 7
    s_add_u32 s40, s40, 3
    s_and_b32 s41, s40, 1
    s_mul_i32 s41, s41, 14336
    s_lshr_b32 s40, s40, 1
    s_lshl_b32 s40, s40, 6
    s_add_u32 s83, s40, s41
    s_mul_i32 s40, s4, 7
    s_add_u32 s40, s40, 4
    s_and_b32 s41, s40, 1
    s_mul_i32 s41, s41, 14336
    s_lshr_b32 s40, s40, 1
    s_lshl_b32 s40, s40, 6
    s_add_u32 s84, s40, s41
    s_mul_i32 s40, s4, 7
    s_add_u32 s40, s40, 5
    s_and_b32 s41, s40, 1
    s_mul_i32 s41, s41, 14336
    s_lshr_b32 s40, s40, 1
    s_lshl_b32 s40, s40, 6
    s_add_u32 s85, s40, s41
    s_mul_i32 s40, s4, 7
    s_add_u32 s40, s40, 6
    s_and_b32 s41, s40, 1
    s_mul_i32 s41, s41, 14336
    s_lshr_b32 s40, s40, 1
    s_lshl_b32 s40, s40, 6
    s_add_u32 s86, s40, s41
    s_add_u32 s40, s10, s80
    s_addc_u32 s41, s11, 0
    s_add_u32 m0, s23, 0
    s_nop 0
    global_load_lds_dwordx4 v58, s[40:41]
    s_add_u32 s40, s10, s81
    s_addc_u32 s41, s11, 0
    s_add_u32 m0, s23, 1024
    s_nop 0
    global_load_lds_dwordx4 v58, s[40:41]
    s_add_u32 s40, s10, s82
    s_addc_u32 s41, s11, 0
    s_add_u32 m0, s23, 2048
    s_nop 0
    global_load_lds_dwordx4 v58, s[40:41]
    s_add_u32 s40, s10, s83
    s_addc_u32 s41, s11, 0
    s_add_u32 m0, s23, 3072
    s_nop 0
    global_load_lds_dwordx4 v58, s[40:41]
    s_add_u32 s40, s10, s84
    s_addc_u32 s41, s11, 0
    s_add_u32 m0, s23, 4096
    s_nop 0
    global_load_lds_dwordx4 v58, s[40:41]
    s_add_u32 s40, s10, s85
    s_addc_u32 s41, s11, 0
    s_add_u32 m0, s23, 5120
    s_nop 0
    global_load_lds_dwordx4 v58, s[40:41]
    s_add_u32 s40, s10, s86
    s_addc_u32 s41, s11, 0
    s_add_u32 m0, s23, 6144
    s_nop 0
    global_load_lds_dwordx4 v58, s[40:41]
    s_add_u32 s10, s10, 57344
    s_addc_u32 s11, s11, 0
    v_mov_b32 v6, 0x01010101
    v_mov_b32 v7, 0
    v_lshlrev_b32 v4, 2, v1
    s_mul_i32 s42, s22, 114688
    s_lshl_b32 s43, s3, 14
    s_add_u32 s42, s42, s43
    s_lshl_b32 s43, s4, 12
    s_add_u32 s42, s42, s43
    s_add_u32 s14, s8, 44052480
    s_addc_u32 s15, s9, 0
    s_add_u32 s14, s14, s42
    s_addc_u32 s15, s15, 0
    s_lshl_b32 s42, s22, 8
    s_lshl_b32 s43, s3, 2
    s_add_u32 s42, s42, s43
    s_add_u32 s16, s8, 43962560
    s_addc_u32 s17, s9, 0
    s_add_u32 s16, s16, s42
    s_addc_u32 s17, s17, 0
    s_lshl_b32 s42, s22, 7
    s_add_u32 s18, s8, 43954176
    s_addc_u32 s19, s9, 0
    s_add_u32 s18, s18, s42
    s_addc_u32 s19, s19, 0
L_f1_item:
    s_waitcnt vmcnt(0)
    s_barrier
    s_cmp_lt_u32 s5, 2
    s_cbranch_scc1 L_f1_nofl
    s_cmp_lg_u32 s4, 0
    s_cbranch_scc1 L_fs5
    global_store_dword v7, v6, s[16:17] sc1
L_fs5:
    s_add_u32 s16, s16, 512
    s_addc_u32 s17, s17, 0
L_f1_nofl:
    s_cmp_ge_u32 s5, 64
    s_cbranch_scc1 L_f1_end
    s_xor_b32 s23, s23, 0x8000
    s_cmp_ge_u32 s5, 62
    s_cbranch_scc1 L_f1_nox
    s_add_u32 s40, s10, s80
    s_addc_u32 s41, s11, 0
    s_add_u32 m0, s23, 0
    s_nop 0
    global_load_lds_dwordx4 v58, s[40:41]
    s_add_u32 s40, s10, s81
    s_addc_u32 s41, s11, 0
    s_add_u32 m0, s23, 1024
    s_nop 0
    global_load_lds_dwordx4 v58, s[40:41]
    s_add_u32 s40, s10, s82
    s_addc_u32 s41, s11, 0
    s_add_u32 m0, s23, 2048
    s_nop 0
    global_load_lds_dwordx4 v58, s[40:41]
    s_add_u32 s40, s10, s83
    s_addc_u32 s41, s11, 0
    s_add_u32 m0, s23, 3072
    s_nop 0
    global_load_lds_dwordx4 v58, s[40:41]
    s_add_u32 s40, s10, s84
    s_addc_u32 s41, s11, 0
    s_add_u32 m0, s23, 4096
    s_nop 0
    global_load_lds_dwordx4 v58, s[40:41]
    s_add_u32 s40, s10, s85
    s_addc_u32 s41, s11, 0
    s_add_u32 m0, s23, 5120
    s_nop 0
    global_load_lds_dwordx4 v58, s[40:41]
    s_add_u32 s40, s10, s86
    s_addc_u32 s41, s11, 0
    s_add_u32 m0, s23, 6144
    s_nop 0
    global_load_lds_dwordx4 v58, s[40:41]
    s_add_u32 s10, s10, 57344
    s_addc_u32 s11, s11, 0
L_f1_nox:
    ds_read_b128 v[32:35], v5 offset:0
    ds_read_b128 v[36:39], v5 offset:1024
    ds_read_b128 v[40:43], v5 offset:2048
    ds_read_b128 v[44:47], v5 offset:3072
    s_waitcnt lgkmcnt(3)
    v_mfma_f32_16x16x32_bf16 v[64:67], a[0:3], v[32:35], 0
    ds_read_b128 v[48:51], v5 offset:4096
    v_mfma_f32_16x16x32_bf16 v[72:75], a[56:59], v[32:35], 0
    v_mfma_f32_16x16x32_bf16 v[80:83], a[112:115], v[32:35], 0
    v_mfma_f32_16x16x32_bf16 v[88:91], a[168:171], v[32:35], 0
    v_mfma_f32_16x16x32_bf16 v[96:99], v[120:123], v[32:35], 0
    s_waitcnt lgkmcnt(3)
    v_mfma_f32_16x16x32_bf16 v[68:71], a[0:3], v[36:39], 0
    ds_read_b128 v[52:55], v5 offset:5120
    v_mfma_f32_16x16x32_bf16 v[76:79], a[56:59], v[36:39], 0
    v_mfma_f32_16x16x32_bf16 v[84:87], a[112:115], v[36:39], 0
    v_mfma_f32_16x16x32_bf16 v[92:95], a[168:171], v[36:39], 0
    v_mfma_f32_16x16x32_bf16 v[100:103], v[120:123], v[36:39], 0
    s_waitcnt lgkmcnt(3)
    v_mfma_f32_16x16x32_bf16 v[64:67], a[4:7], v[40:43], v[64:67]
    ds_read_b128 v[32:35], v5 offset:6144
    v_mfma_f32_16x16x32_bf16 v[72:75], a[60:63], v[40:43], v[72:75]
    v_mfma_f32_16x16x32_bf16 v[80:83], a[116:119], v[40:43], v[80:83]
    v_mfma_f32_16x16x32_bf16 v[88:91], a[172:175], v[40:43], v[88:91]
    v_mfma_f32_16x16x32_bf16 v[96:99], v[124:127], v[40:43], v[96:99]
    s_waitcnt lgkmcnt(3)
    v_mfma_f32_16x16x32_bf16 v[68:71], a[4:7], v[44:47], v[68:71]
    ds_read_b128 v[36:39], v5 offset:7168
    v_mfma_f32_16x16x32_bf16 v[76:79], a[60:63], v[44:47], v[76:79]
    v_mfma_f32_16x16x32_bf16 v[84:87], a[116:119], v[44:47], v[84:87]
    v_mfma_f32_16x16x32_bf16 v[92:95], a[172:175], v[44:47], v[92:95]
    v_mfma_f32_16x16x32_bf16 v[100:103], v[124:127], v[44:47], v[100:103]
    s_waitcnt lgkmcnt(3)
    v_mfma_f32_16x16x32_bf16 v[64:67], a[8:11], v[48:51], v[64:67]
    ds_read_b128 v[40:43], v5 offset:8192
    v_mfma_f32_16x16x32_bf16 v[72:75], a[64:67], v[48:51], v[72:75]
    v_mfma_f32_16x16x32_bf16 v[80:83], a[120:123], v[48:51], v[80:83]
    v_mfma_f32_16x16x32_bf16 v[88:91], a[176:179], v[48:51], v[88:91]
    v_mfma_f32_16x16x32_bf16 v[96:99], v[128:131], v[48:51], v[96:99]
    s_waitcnt lgkmcnt(3)
    v_mfma_f32_16x16x32_bf16 v[68:71], a[8:11], v[52:55], v[68:71]
    ds_read_b128 v[44:47], v5 offset:9216
    v_mfma_f32_16x16x32_bf16 v[76:79], a[64:67], v[52:55], v[76:79]
    v_mfma_f32_16x16x32_bf16 v[84:87], a[120:123], v[52:55], v[84:87]
    v_mfma_f32_16x16x32_bf16 v[92:95], a[176:179], v[52:55], v[92:95]
    v_mfma_f32_16x16x32_bf16 v[100:103], v[128:131], v[52:55], v[100:103]
    s_waitcnt lgkmcnt(3)
    v_mfma_f32_16x16x32_bf16 v[64:67], a[12:15], v[32:35], v[64:67]
    ds_read_b128 v[48:51], v5 offset:10240
    v_mfma_f32_16x16x32_bf16 v[72:75], a[68:71], v[32:35], v[72:75]
    v_mfma_f32_16x16x32_bf16 v[80:83], a[124:127], v[32:35], v[80:83]
    v_mfma_f32_16x16x32_bf16 v[88:91], a[180:183], v[32:35], v[88:91]
    v_mfma_f32_16x16x32_bf16 v[96:99], v[132:135], v[32:35], v[96:99]
    s_waitcnt lgkmcnt(3)
    v_mfma_f32_16x16x32_bf16 v[68:71], a[12:15], v[36:39], v[68:71]
    ds_read_b128 v[52:55], v5 offset:11264
    v_mfma_f32_16x16x32_bf16 v[76:79], a[68:71], v[36:39], v[76:79]
    v_mfma_f32_16x16x32_bf16 v[84:87], a[124:127], v[36:39], v[84:87]
    v_mfma_f32_16x16x32_bf16 v[92:95], a[180:183], v[36:39], v[92:95]
    v_mfma_f32_16x16x32_bf16 v[100:103], v[132:135], v[36:39], v[100:103]
    s_waitcnt lgkmcnt(3)
    v_mfma_f32_16x16x32_bf16 v[64:67], a[16:19], v[40:43], v[64:67]
    ds_read_b128 v[32:35], v5 offset:12288
    v_mfma_f32_16x16x32_bf16 v[72:75], a[72:75], v[40:43], v[72:75]
    v_mfma_f32_16x16x32_bf16 v[80:83], a[128:131], v[40:43], v[80:83]
    v_mfma_f32_16x16x32_bf16 v[88:91], a[184:187], v[40:43], v[88:91]
    v_mfma_f32_16x16x32_bf16 v[96:99], v[136:139], v[40:43], v[96:99]
    s_waitcnt lgkmcnt(3)
    v_mfma_f32_16x16x32_bf16 v[68:71], a[16:19], v[44:47], v[68:71]
    ds_read_b128 v[36:39], v5 offset:13312
    v_mfma_f32_16x16x32_bf16 v[76:79], a[72:75], v[44:47], v[76:79]
    v_mfma_f32_16x16x32_bf16 v[84:87], a[128:131], v[44:47], v[84:87]
    v_mfma_f32_16x16x32_bf16 v[92:95], a[184:187], v[44:47], v[92:95]
    v_mfma_f32_16x16x32_bf16 v[100:103], v[136:139], v[44:47], v[100:103]
    s_waitcnt lgkmcnt(3)
    v_mfma_f32_16x16x32_bf16 v[64:67], a[20:23], v[48:51], v[64:67]
    ds_read_b128 v[40:43], v5 offset:14336
    v_mfma_f32_16x16x32_bf16 v[72:75], a[76:79], v[48:51], v[72:75]
    v_mfma_f32_16x16x32_bf16 v[80:83], a[132:135], v[48:51], v[80:83]
    v_mfma_f32_16x16x32_bf16 v[88:91], a[188:191], v[48:51], v[88:91]
    v_mfma_f32_16x16x32_bf16 v[96:99], v[140:143], v[48:51], v[96:99]
    s_waitcnt lgkmcnt(3)
    v_mfma_f32_16x16x32_bf16 v[68:71], a[20:23], v[52:55], v[68:71]
    ds_read_b128 v[44:47], v5 offset:15360
    v_mfma_f32_16x16x32_bf16 v[76:79], a[76:79], v[52:55], v[76:79]
    v_mfma_f32_16x16x32_bf16 v[84:87], a[132:135], v[52:55], v[84:87]
    v_mfma_f32_16x16x32_bf16 v[92:95], a[188:191], v[52:55], v[92:95]
    v_mfma_f32_16x16x32_bf16 v[100:103], v[140:143], v[52:55], v[100:103]
    s_waitcnt lgkmcnt(3)
    v_mfma_f32_16x16x32_bf16 v[64:67], a[24:27], v[32:35], v[64:67]
    ds_read_b128 v[48:51], v5 offset:16384
    v_mfma_f32_16x16x32_bf16 v[72:75], a[80:83], v[32:35], v[72:75]
    v_mfma_f32_16x16x32_bf16 v[80:83], a[136:139], v[32:35], v[80:83]
    v_mfma_f32_16x16x32_bf16 v[88:91], a[192:195], v[32:35], v[88:91]
    v_mfma_f32_16x16x32_bf16 v[96:99], v[144:147], v[32:35], v[96:99]
    s_waitcnt lgkmcnt(3)
    v_mfma_f32_16x16x32_bf16 v[68:71], a[24:27], v[36:39], v[68:71]
    ds_read_b128 v[52:55], v5 offset:17408
    v_mfma_f32_16x16x32_bf16 v[76:79], a[80:83], v[36:39], v[76:79]
    v_mfma_f32_16x16x32_bf16 v[84:87], a[136:139], v[36:39], v[84:87]
    v_mfma_f32_16x16x32_bf16 v[92:95], a[192:195], v[36:39], v[92:95]
    v_mfma_f32_16x16x32_bf16 v[100:103], v[144:147], v[36:39], v[100:103]
    s_waitcnt lgkmcnt(3)
    v_mfma_f32_16x16x32_bf16 v[64:67], a[28:31], v[40:43], v[64:67]
    ds_read_b128 v[32:35], v5 offset:18432
    v_mfma_f32_16x16x32_bf16 v[72:75], a[84:87], v[40:43], v[72:75]
    v_mfma_f32_16x16x32_bf16 v[80:83], a[140:143], v[40:43], v[80:83]
    v_mfma_f32_16x16x32_bf16 v[88:91], a[196:199], v[40:43], v[88:91]
    v_mfma_f32_16x16x32_bf16 v[96:99], v[148:151], v[40:43], v[96:99]
    s_waitcnt lgkmcnt(3)
    v_mfma_f32_16x16x32_bf16 v[68:71], a[28:31], v[44:47], v[68:71]
    ds_read_b128 v[36:39], v5 offset:19456
    v_mfma_f32_16x16x32_bf16 v[76:79], a[84:87], v[44:47], v[76:79]
    v_mfma_f32_16x16x32_bf16 v[84:87], a[140:143], v[44:47], v[84:87]
    v_mfma_f32_16x16x32_bf16 v[92:95], a[196:199], v[44:47], v[92:95]
    v_mfma_f32_16x16x32_bf16 v[100:103], v[148:151], v[44:47], v[100:103]
    s_waitcnt lgkmcnt(3)
    v_mfma_f32_16x16x32_bf16 v[64:67], a[32:35], v[48:51], v[64:67]
    ds_read_b128 v[40:43], v5 offset:20480
    v_mfma_f32_16x16x32_bf16 v[72:75], a[88:91], v[48:51], v[72:75]
    v_mfma_f32_16x16x32_bf16 v[80:83], a[144:147], v[48:51], v[80:83]
    v_mfma_f32_16x16x32_bf16 v[88:91], a[200:203], v[48:51], v[88:91]
    v_mfma_f32_16x16x32_bf16 v[96:99], v[152:155], v[48:51], v[96:99]
    s_waitcnt lgkmcnt(3)
    v_mfma_f32_16x16x32_bf16 v[68:71], a[32:35], v[52:55], v[68:71]
    ds_read_b128 v[44:47], v5 offset:21504
    v_mfma_f32_16x16x32_bf16 v[76:79], a[88:91], v[52:55], v[76:79]
    v_mfma_f32_16x16x32_bf16 v[84:87], a[144:147], v[52:55], v[84:87]
    v_mfma_f32_16x16x32_bf16 v[92:95], a[200:203], v[52:55], v[92:95]
    v_mfma_f32_16x16x32_bf16 v[100:103], v[152:155], v[52:55], v[100:103]
    s_waitcnt lgkmcnt(3)
    v_mfma_f32_16x16x32_bf16 v[64:67], a[36:39], v[32:35], v[64:67]
    ds_read_b128 v[48:51], v5 offset:22528
    v_mfma_f32_16x16x32_bf16 v[72:75], a[92:95], v[32:35], v[72:75]
    v_mfma_f32_16x16x32_bf16 v[80:83], a[148:151], v[32:35], v[80:83]
    v_mfma_f32_16x16x32_bf16 v[88:91], a[204:207], v[32:35], v[88:91]
    v_mfma_f32_16x16x32_bf16 v[96:99], v[156:159], v[32:35], v[96:99]
    s_waitcnt lgkmcnt(3)
    v_mfma_f32_16x16x32_bf16 v[68:71], a[36:39], v[36:39], v[68:71]
    ds_read_b128 v[52:55], v5 offset:23552
    v_mfma_f32_16x16x32_bf16 v[76:79], a[92:95], v[36:39], v[76:79]
    v_mfma_f32_16x16x32_bf16 v[84:87], a[148:151], v[36:39], v[84:87]
    v_mfma_f32_16x16x32_bf16 v[92:95], a[204:207], v[36:39], v[92:95]
    v_mfma_f32_16x16x32_bf16 v[100:103], v[156:159], v[36:39], v[100:103]
    s_waitcnt lgkmcnt(3)
    v_mfma_f32_16x16x32_bf16 v[64:67], a[40:43], v[40:43], v[64:67]
    ds_read_b128 v[32:35], v5 offset:24576
    v_mfma_f32_16x16x32_bf16 v[72:75], a[96:99], v[40:43], v[72:75]
    v_mfma_f32_16x16x32_bf16 v[80:83], a[152:155], v[40:43], v[80:83]
    v_mfma_f32_16x16x32_bf16 v[88:91], a[208:211], v[40:43], v[88:91]
    v_mfma_f32_16x16x32_bf16 v[96:99], v[160:163], v[40:43], v[96:99]
    s_waitcnt lgkmcnt(3)
    v_mfma_f32_16x16x32_bf16 v[68:71], a[40:43], v[44:47], v[68:71]
    ds_read_b128 v[36:39], v5 offset:25600
    v_mfma_f32_16x16x32_bf16 v[76:79], a[96:99], v[44:47], v[76:79]
    v_mfma_f32_16x16x32_bf16 v[84:87], a[152:155], v[44:47], v[84:87]
    v_mfma_f32_16x16x32_bf16 v[92:95], a[208:211], v[44:47], v[92:95]
    v_mfma_f32_16x16x32_bf16 v[100:103], v[160:163], v[44:47], v[100:103]
    s_waitcnt lgkmcnt(3)
    v_mfma_f32_16x16x32_bf16 v[64:67], a[44:47], v[48:51], v[64:67]
    ds_read_b128 v[40:43], v5 offset:26624
    v_mfma_f32_16x16x32_bf16 v[72:75], a[100:103], v[48:51], v[72:75]
    v_mfma_f32_16x16x32_bf16 v[80:83], a[156:159], v[48:51], v[80:83]
    v_mfma_f32_16x16x32_bf16 v[88:91], a[212:215], v[48:51], v[88:91]
    v_mfma_f32_16x16x32_bf16 v[96:99], v[164:167], v[48:51], v[96:99]
    s_waitcnt lgkmcnt(3)
    v_mfma_f32_16x16x32_bf16 v[68:71], a[44:47], v[52:55], v[68:71]
    ds_read_b128 v[44:47], v5 offset:27648
    v_mfma_f32_16x16x32_bf16 v[76:79], a[100:103], v[52:55], v[76:79]
    v_mfma_f32_16x16x32_bf16 v[84:87], a[156:159], v[52:55], v[84:87]
    v_mfma_f32_16x16x32_bf16 v[92:95], a[212:215], v[52:55], v[92:95]
    v_mfma_f32_16x16x32_bf16 v[100:103], v[164:167], v[52:55], v[100:103]
    s_waitcnt lgkmcnt(3)
    v_mfma_f32_16x16x32_bf16 v[64:67], a[48:51], v[32:35], v[64:67]
    v_mfma_f32_16x16x32_bf16 v[72:75], a[104:107], v[32:35], v[72:75]
    v_mfma_f32_16x16x32_bf16 v[80:83], a[160:163], v[32:35], v[80:83]
    v_mfma_f32_16x16x32_bf16 v[88:91], a[216:219], v[32:35], v[88:91]
    v_mfma_f32_16x16x32_bf16 v[96:99], v[168:171], v[32:35], v[96:99]
    s_waitcnt lgkmcnt(2)
    v_mfma_f32_16x16x32_bf16 v[68:71], a[48:51], v[36:39], v[68:71]
    v_mfma_f32_16x16x32_bf16 v[76:79], a[104:107], v[36:39], v[76:79]
    v_mfma_f32_16x16x32_bf16 v[84:87], a[160:163], v[36:39], v[84:87]
    v_mfma_f32_16x16x32_bf16 v[92:95], a[216:219], v[36:39], v[92:95]
    v_mfma_f32_16x16x32_bf16 v[100:103], v[168:171], v[36:39], v[100:103]
    s_waitcnt lgkmcnt(1)
    v_mfma_f32_16x16x32_bf16 v[64:67], a[52:55], v[40:43], v[64:67]
    v_mfma_f32_16x16x32_bf16 v[72:75], a[108:111], v[40:43], v[72:75]
    v_mfma_f32_16x16x32_bf16 v[80:83], a[164:167], v[40:43], v[80:83]
    v_mfma_f32_16x16x32_bf16 v[88:91], a[220:223], v[40:43], v[88:91]
    v_mfma_f32_16x16x32_bf16 v[96:99], v[172:175], v[40:43], v[96:99]
    s_waitcnt lgkmcnt(0)
    v_mfma_f32_16x16x32_bf16 v[68:71], a[52:55], v[44:47], v[68:71]
    v_mfma_f32_16x16x32_bf16 v[76:79], a[108:111], v[44:47], v[76:79]
    v_mfma_f32_16x16x32_bf16 v[84:87], a[164:167], v[44:47], v[84:87]
    v_mfma_f32_16x16x32_bf16 v[92:95], a[220:223], v[44:47], v[92:95]
    v_mfma_f32_16x16x32_bf16 v[100:103], v[172:175], v[44:47], v[100:103]
    v_xor_b32 v5, 0x8000, v5
    v_mul_f32 v56, 0xbfb8aa3b, v96
    v_exp_f32 v56, v56
    s_nop 0
    v_add_f32 v56, 1.0, v56
    v_rcp_f32 v56, v56
    s_nop 0
    v_mul_f32 v57, 0xbfb8aa3b, v100
    v_exp_f32 v57, v57
    s_nop 0
    v_add_f32 v57, 1.0, v57
    v_rcp_f32 v57, v57
    s_or_b32 s40, s3, s4
    s_cbranch_scc1 L_f1_nog
    global_store_dword v4, v56, s[18:19] sc1
    global_store_dword v4, v57, s[18:19] offset:64 sc1
L_f1_nog:
    v_sub_f32 v56, 1.0, v56
    v_sub_f32 v57, 1.0, v57
    v_mul_f32 v8, 0xbfb8aa3b, v64
    v_mul_f32 v9, 0xbfb8aa3b, v65
    v_mul_f32 v10, 0xbfb8aa3b, v66
    v_mul_f32 v11, 0xbfb8aa3b, v67
    v_mul_f32 v12, 0xbfb8aa3b, v72
    v_mul_f32 v13, 0xbfb8aa3b, v73
    v_mul_f32 v14, 0xbfb8aa3b, v74
    v_mul_f32 v15, 0xbfb8aa3b, v75
    v_exp_f32 v8, v8
    v_exp_f32 v9, v9
    v_exp_f32 v10, v10
    v_exp_f32 v11, v11
    v_exp_f32 v12, v12
    v_exp_f32 v13, v13
    v_exp_f32 v14, v14
    v_exp_f32 v15, v15
    v_add_f32 v8, 1.0, v8
    v_add_f32 v9, 1.0, v9
    v_add_f32 v10, 1.0, v10
    v_add_f32 v11, 1.0, v11
    v_add_f32 v12, 1.0, v12
    v_add_f32 v13, 1.0, v13
    v_add_f32 v14, 1.0, v14
    v_add_f32 v15, 1.0, v15
    v_rcp_f32 v8, v8
    v_rcp_f32 v9, v9
    v_rcp_f32 v10, v10
    v_rcp_f32 v11, v11
    v_rcp_f32 v12, v12
    v_rcp_f32 v13, v13
    v_rcp_f32 v14, v14
    v_rcp_f32 v15, v15
    v_mul_f32 v64, v64, v56
    v_mul_f32 v65, v65, v56
    v_mul_f32 v66, v66, v56
    v_mul_f32 v67, v67, v56
    v_mul_f32 v72, v72, v56
    v_mul_f32 v73, v73, v56
    v_mul_f32 v74, v74, v56
    v_mul_f32 v75, v75, v56
    v_mul_f32 v8, v8, v64
    v_mul_f32 v9, v9, v65
    v_mul_f32 v10, v10, v66
    v_mul_f32 v11, v11, v67
    v_mul_f32 v12, v12, v72
    v_mul_f32 v13, v13, v73
    v_mul_f32 v14, v14, v74
    v_mul_f32 v15, v15, v75
    v_cvt_pk_bf16_f32 v16, v8, v9
    v_cvt_pk_bf16_f32 v17, v10, v11
    v_cvt_pk_bf16_f32 v18, v12, v13
    v_cvt_pk_bf16_f32 v19, v14, v15
    global_store_dwordx4 v3, v[16:19], s[14:15] offset:0 sc1
    v_mul_f32 v8, 0xbfb8aa3b, v68
    v_mul_f32 v9, 0xbfb8aa3b, v69
    v_mul_f32 v10, 0xbfb8aa3b, v70
    v_mul_f32 v11, 0xbfb8aa3b, v71
    v_mul_f32 v12, 0xbfb8aa3b, v76
    v_mul_f32 v13, 0xbfb8aa3b, v77
    v_mul_f32 v14, 0xbfb8aa3b, v78
    v_mul_f32 v15, 0xbfb8aa3b, v79
    v_exp_f32 v8, v8
    v_exp_f32 v9, v9
    v_exp_f32 v10, v10
    v_exp_f32 v11, v11
    v_exp_f32 v12, v12
    v_exp_f32 v13, v13
    v_exp_f32 v14, v14
    v_exp_f32 v15, v15
    v_add_f32 v8, 1.0, v8
    v_add_f32 v9, 1.0, v9
    v_add_f32 v10, 1.0, v10
    v_add_f32 v11, 1.0, v11
    v_add_f32 v12, 1.0, v12
    v_add_f32 v13, 1.0, v13
    v_add_f32 v14, 1.0, v14
    v_add_f32 v15, 1.0, v15
    v_rcp_f32 v8, v8
    v_rcp_f32 v9, v9
    v_rcp_f32 v10, v10
    v_rcp_f32 v11, v11
    v_rcp_f32 v12, v12
    v_rcp_f32 v13, v13
    v_rcp_f32 v14, v14
    v_rcp_f32 v15, v15
    v_mul_f32 v68, v68, v57
    v_mul_f32 v69, v69, v57
    v_mul_f32 v70, v70, v57
    v_mul_f32 v71, v71, v57
    v_mul_f32 v76, v76, v57
    v_mul_f32 v77, v77, v57
    v_mul_f32 v78, v78, v57
    v_mul_f32 v79, v79, v57
    v_mul_f32 v8, v8, v68
    v_mul_f32 v9, v9, v69
    v_mul_f32 v10, v10, v70
    v_mul_f32 v11, v11, v71
    v_mul_f32 v12, v12, v76
    v_mul_f32 v13, v13, v77
    v_mul_f32 v14, v14, v78
    v_mul_f32 v15, v15, v79
    v_cvt_pk_bf16_f32 v20, v8, v9
    v_cvt_pk_bf16_f32 v21, v10, v11
    v_cvt_pk_bf16_f32 v22, v12, v13
    v_cvt_pk_bf16_f32 v23, v14, v15
    global_store_dwordx4 v3, v[20:23], s[14:15] offset:1024 sc1
    v_mul_f32 v8, 0xbfb8aa3b, v80
    v_mul_f32 v9, 0xbfb8aa3b, v81
    v_mul_f32 v10, 0xbfb8aa3b, v82
    v_mul_f32 v11, 0xbfb8aa3b, v83
    v_mul_f32 v12, 0xbfb8aa3b, v88
    v_mul_f32 v13, 0xbfb8aa3b, v89
    v_mul_f32 v14, 0xbfb8aa3b, v90
    v_mul_f32 v15, 0xbfb8aa3b, v91
    v_exp_f32 v8, v8
    v_exp_f32 v9, v9
    v_exp_f32 v10, v10
    v_exp_f32 v11, v11
    v_exp_f32 v12, v12
    v_exp_f32 v13, v13
    v_exp_f32 v14, v14
    v_exp_f32 v15, v15
    v_add_f32 v8, 1.0, v8
    v_add_f32 v9, 1.0, v9
    v_add_f32 v10, 1.0, v10
    v_add_f32 v11, 1.0, v11
    v_add_f32 v12, 1.0, v12
    v_add_f32 v13, 1.0, v13
    v_add_f32 v14, 1.0, v14
    v_add_f32 v15, 1.0, v15
    v_rcp_f32 v8, v8
    v_rcp_f32 v9, v9
    v_rcp_f32 v10, v10
    v_rcp_f32 v11, v11
    v_rcp_f32 v12, v12
    v_rcp_f32 v13, v13
    v_rcp_f32 v14, v14
    v_rcp_f32 v15, v15
    v_mul_f32 v80, v80, v56
    v_mul_f32 v81, v81, v56
    v_mul_f32 v82, v82, v56
    v_mul_f32 v83, v83, v56
    v_mul_f32 v88, v88, v56
    v_mul_f32 v89, v89, v56
    v_mul_f32 v90, v90, v56
    v_mul_f32 v91, v91, v56
    v_mul_f32 v8, v8, v80
    v_mul_f32 v9, v9, v81
    v_mul_f32 v10, v10, v82
    v_mul_f32 v11, v11, v83
    v_mul_f32 v12, v12, v88
    v_mul_f32 v13, v13, v89
    v_mul_f32 v14, v14, v90
    v_mul_f32 v15, v15, v91
    v_cvt_pk_bf16_f32 v24, v8, v9
    v_cvt_pk_bf16_f32 v25, v10, v11
    v_cvt_pk_bf16_f32 v26, v12, v13
    v_cvt_pk_bf16_f32 v27, v14, v15
    global_store_dwordx4 v3, v[24:27], s[14:15] offset:2048 sc1
    v_mul_f32 v8, 0xbfb8aa3b, v84
    v_mul_f32 v9, 0xbfb8aa3b, v85
    v_mul_f32 v10, 0xbfb8aa3b, v86
    v_mul_f32 v11, 0xbfb8aa3b, v87
    v_mul_f32 v12, 0xbfb8aa3b, v92
    v_mul_f32 v13, 0xbfb8aa3b, v93
    v_mul_f32 v14, 0xbfb8aa3b, v94
    v_mul_f32 v15, 0xbfb8aa3b, v95
    v_exp_f32 v8, v8
    v_exp_f32 v9, v9
    v_exp_f32 v10, v10
    v_exp_f32 v11, v11
    v_exp_f32 v12, v12
    v_exp_f32 v13, v13
    v_exp_f32 v14, v14
    v_exp_f32 v15, v15
    v_add_f32 v8, 1.0, v8
    v_add_f32 v9, 1.0, v9
    v_add_f32 v10, 1.0, v10
    v_add_f32 v11, 1.0, v11
    v_add_f32 v12, 1.0, v12
    v_add_f32 v13, 1.0, v13
    v_add_f32 v14, 1.0, v14
    v_add_f32 v15, 1.0, v15
    v_rcp_f32 v8, v8
    v_rcp_f32 v9, v9
    v_rcp_f32 v10, v10
    v_rcp_f32 v11, v11
    v_rcp_f32 v12, v12
    v_rcp_f32 v13, v13
    v_rcp_f32 v14, v14
    v_rcp_f32 v15, v15
    v_mul_f32 v84, v84, v57
    v_mul_f32 v85, v85, v57
    v_mul_f32 v86, v86, v57
    v_mul_f32 v87, v87, v57
    v_mul_f32 v92, v92, v57
    v_mul_f32 v93, v93, v57
    v_mul_f32 v94, v94, v57
    v_mul_f32 v95, v95, v57
    v_mul_f32 v8, v8, v84
    v_mul_f32 v9, v9, v85
    v_mul_f32 v10, v10, v86
    v_mul_f32 v11, v11, v87
    v_mul_f32 v12, v12, v92
    v_mul_f32 v13, v13, v93
    v_mul_f32 v14, v14, v94
    v_mul_f32 v15, v15, v95
    v_cvt_pk_bf16_f32 v28, v8, v9
    v_cvt_pk_bf16_f32 v29, v10, v11
    v_cvt_pk_bf16_f32 v30, v12, v13
    v_cvt_pk_bf16_f32 v31, v14, v15
    global_store_dwordx4 v3, v[28:31], s[14:15] offset:3072 sc1
    s_add_u32 s14, s14, 229376
    s_addc_u32 s15, s15, 0
    s_add_u32 s18, s18, 256
    s_addc_u32 s19, s19, 0
    s_add_u32 s5, s5, 2
    s_branch L_f1_item
L_f1_end:
    s_endpgm
L_outs:
    s_load_dwordx2 s[10:11], s[0:1], 72
    s_load_dwordx2 s[30:31], s[0:1], 88
    v_lshlrev_b32 v3, 4, v0
    s_mov_b32 s6, 0
    s_mov_b32 s7, 4290772927
    s_mul_i32 s40, s4, 401408
    s_lshl_b32 s41, s3, 7
    s_add_u32 s40, s40, s41
    s_waitcnt lgkmcnt(0)
    s_add_u32 s10, s10, s40
    s_addc_u32 s11, s11, 0
    s_cmp_lg_u32 s4, 0
    s_cbranch_scc1 L_oua_rb
    s_add_u32 s40, s8, 43982848
    s_addc_u32 s41, s9, 0
    v_lshrrev_b32 v8, 1, v0
    v_and_b32 v9, 1, v0
    v_lshlrev_b32 v9, 4, v9
    v_lshl_add_u32 v8, v8, 7, v9
    s_mov_b32 s42, 0
L_oua_rp:
    global_load_dwordx4 v[10:13], v8, s[40:41] sc1
    s_add_u32 s42, s42, 1
    s_cmp_gt_u32 s42, 1048576
    s_cbranch_scc1 L_bail
    s_waitcnt vmcnt(0)
    v_min_u32 v10, v10, v11
    v_min_u32 v10, v10, v12
    v_min_u32 v10, v10, v13
    v_cmp_eq_u32 vcc, 0, v10
    s_cbranch_vccz L_oua_rb
    s_sleep 8
    s_branch L_oua_rp
L_oua_rb:
    s_barrier
    s_mul_i32 s42, s4, 28672
    v_lshrrev_b32 v10, 3, v0
    v_and_b32 v11, 7, v0
    v_lshrrev_b32 v12, 4, v0
    v_lshlrev_b32 v12, 1, v12
    v_xor_b32 v11, v11, v12
    v_mul_u32_u24 v10, 896, v10
    v_lshl_add_u32 v8, v11, 4, v10
    v_xor_b32 v11, 0, v11
    v_lshl_add_u32 v9, v11, 4, v10
    v_bfe_u32 v10, v0, 2, 2
    v_lshl_add_u32 v11, v2, 2, v10
    v_lshlrev_b32 v11, 7, v11
    v_and_b32 v12, 1, v0
    v_lshl_add_u32 v11, v12, 3, v11
    v_add_u32 v11, s42, v11
    v_and_b32 v10, 2, v10
    v_and_b32 v12, 1, v2
    v_lshl_add_u32 v10, v12, 2, v10
    v_bfe_u32 v12, v0, 1, 1
    v_xor_b32 v10, v10, v12
    v_xor_b32 v12, 0, v10
    v_lshl_add_u32 v13, v12, 4, v11
    v_xor_b32 v12, 2, v10
    v_lshl_add_u32 v14, v12, 4, v11
    v_xor_b32 v12, 4, v10
    v_lshl_add_u32 v15, v12, 4, v11
    v_xor_b32 v12, 6, v10
    v_lshl_add_u32 v16, v12, 4, v11
    s_add_u32 m0, s42, 0
    s_nop 0
    global_load_lds_dwordx4 v8, s[10:11]
    s_add_u32 s10, s10, 7168
    s_addc_u32 s11, s11, 0
    s_add_u32 m0, s42, 1024
    s_nop 0
    global_load_lds_dwordx4 v9, s[10:11]
    s_add_u32 s10, s10, 7168
    s_addc_u32 s11, s11, 0
    s_add_u32 m0, s42, 2048
    s_nop 0
    global_load_lds_dwordx4 v8, s[10:11]
    s_add_u32 s10, s10, 7168
    s_addc_u32 s11, s11, 0
    s_add_u32 m0, s42, 3072
    s_nop 0
    global_load_lds_dwordx4 v9, s[10:11]
    s_add_u32 s10, s10, 7168
    s_addc_u32 s11, s11, 0
    s_add_u32 m0, s42, 4096
    s_nop 0
    global_load_lds_dwordx4 v8, s[10:11]
    s_add_u32 s10, s10, 7168
    s_addc_u32 s11, s11, 0
    s_add_u32 m0, s42, 5120
    s_nop 0
    global_load_lds_dwordx4 v9, s[10:11]
    s_add_u32 s10, s10, 7168
    s_addc_u32 s11, s11, 0
    s_add_u32 m0, s42, 6144
    s_nop 0
    global_load_lds_dwordx4 v8, s[10:11]
    s_add_u32 s10, s10, 7168
    s_addc_u32 s11, s11, 0
    s_add_u32 m0, s42, 7168
    s_nop 0
    global_load_lds_dwordx4 v9, s[10:11]
    s_add_u32 s10, s10, 7168
    s_addc_u32 s11, s11, 0
    s_add_u32 m0, s42, 8192
    s_nop 0
    global_load_lds_dwordx4 v8, s[10:11]
    s_add_u32 s10, s10, 7168
    s_addc_u32 s11, s11, 0
    s_add_u32 m0, s42, 9216
    s_nop 0
    global_load_lds_dwordx4 v9, s[10:11]
    s_add_u32 s10, s10, 7168
    s_addc_u32 s11, s11, 0
    s_add_u32 m0, s42, 10240
    s_nop 0
    global_load_lds_dwordx4 v8, s[10:11]
    s_add_u32 s10, s10, 7168
    s_addc_u32 s11, s11, 0
    s_add_u32 m0, s42, 11264
    s_nop 0
    global_load_lds_dwordx4 v9, s[10:11]
    s_add_u32 s10, s10, 7168
    s_addc_u32 s11, s11, 0
    s_add_u32 m0, s42, 12288
    s_nop 0
    global_load_lds_dwordx4 v8, s[10:11]
    s_add_u32 s10, s10, 7168
    s_addc_u32 s11, s11, 0
    s_add_u32 m0, s42, 13312
    s_nop 0
    global_load_lds_dwordx4 v9, s[10:11]
    s_add_u32 s10, s10, 7168
    s_addc_u32 s11, s11, 0
    s_add_u32 m0, s42, 14336
    s_nop 0
    global_load_lds_dwordx4 v8, s[10:11]
    s_add_u32 s10, s10, 7168
    s_addc_u32 s11, s11, 0
    s_add_u32 m0, s42, 15360
    s_nop 0
    global_load_lds_dwordx4 v9, s[10:11]
    s_add_u32 s10, s10, 7168
    s_addc_u32 s11, s11, 0
    s_add_u32 m0, s42, 16384
    s_nop 0
    global_load_lds_dwordx4 v8, s[10:11]
    s_add_u32 s10, s10, 7168
    s_addc_u32 s11, s11, 0
    s_add_u32 m0, s42, 17408
    s_nop 0
    global_load_lds_dwordx4 v9, s[10:11]
    s_add_u32 s10, s10, 7168
    s_addc_u32 s11, s11, 0
    s_add_u32 m0, s42, 18432
    s_nop 0
    global_load_lds_dwordx4 v8, s[10:11]
    s_add_u32 s10, s10, 7168
    s_addc_u32 s11, s11, 0
    s_add_u32 m0, s42, 19456
    s_nop 0
    global_load_lds_dwordx4 v9, s[10:11]
    s_add_u32 s10, s10, 7168
    s_addc_u32 s11, s11, 0
    s_add_u32 m0, s42, 20480
    s_nop 0
    global_load_lds_dwordx4 v8, s[10:11]
    s_add_u32 s10, s10, 7168
    s_addc_u32 s11, s11, 0
    s_add_u32 m0, s42, 21504
    s_nop 0
    global_load_lds_dwordx4 v9, s[10:11]
    s_add_u32 s10, s10, 7168
    s_addc_u32 s11, s11, 0
    s_add_u32 m0, s42, 22528
    s_nop 0
    global_load_lds_dwordx4 v8, s[10:11]
    s_add_u32 s10, s10, 7168
    s_addc_u32 s11, s11, 0
    s_add_u32 m0, s42, 23552
    s_nop 0
    global_load_lds_dwordx4 v9, s[10:11]
    s_add_u32 s10, s10, 7168
    s_addc_u32 s11, s11, 0
    s_add_u32 m0, s42, 24576
    s_nop 0
    global_load_lds_dwordx4 v8, s[10:11]
    s_add_u32 s10, s10, 7168
    s_addc_u32 s11, s11, 0
    s_add_u32 m0, s42, 25600
    s_nop 0
    global_load_lds_dwordx4 v9, s[10:11]
    s_add_u32 s10, s10, 7168
    s_addc_u32 s11, s11, 0
    s_add_u32 m0, s42, 26624
    s_nop 0
    global_load_lds_dwordx4 v8, s[10:11]
    s_add_u32 s10, s10, 7168
    s_addc_u32 s11, s11, 0
    s_add_u32 m0, s42, 27648
    s_nop 0
    global_load_lds_dwordx4 v9, s[10:11]
    s_add_u32 s10, s10, 7168
    s_addc_u32 s11, s11, 0
    s_waitcnt vmcnt(0)
    ds_read_b64_tr_b16 a[0:1], v13 offset:0
    ds_read_b64_tr_b16 a[2:3], v13 offset:2048
    ds_read_b64_tr_b16 a[56:57], v14 offset:0
    ds_read_b64_tr_b16 a[58:59], v14 offset:2048
    ds_read_b64_tr_b16 a[112:113], v15 offset:0
    ds_read_b64_tr_b16 a[114:115], v15 offset:2048
    ds_read_b64_tr_b16 a[168:169], v16 offset:0
    ds_read_b64_tr_b16 a[170:171], v16 offset:2048
    s_waitcnt lgkmcnt(0)
    ds_read_b64_tr_b16 a[4:5], v13 offset:4096
    ds_read_b64_tr_b16 a[6:7], v13 offset:6144
    ds_read_b64_tr_b16 a[60:61], v14 offset:4096
    ds_read_b64_tr_b16 a[62:63], v14 offset:6144
    ds_read_b64_tr_b16 a[116:117], v15 offset:4096
    ds_read_b64_tr_b16 a[118:119], v15 offset:6144
    ds_read_b64_tr_b16 a[172:173], v16 offset:4096
    ds_read_b64_tr_b16 a[174:175], v16 offset:6144
    s_waitcnt lgkmcnt(0)
    ds_read_b64_tr_b16 a[8:9], v13 offset:8192
    ds_read_b64_tr_b16 a[10:11], v13 offset:10240
    ds_read_b64_tr_b16 a[64:65], v14 offset:8192
    ds_read_b64_tr_b16 a[66:67], v14 offset:10240
    ds_read_b64_tr_b16 a[120:121], v15 offset:8192
    ds_read_b64_tr_b16 a[122:123], v15 offset:10240
    ds_read_b64_tr_b16 a[176:177], v16 offset:8192
    ds_read_b64_tr_b16 a[178:179], v16 offset:10240
    s_waitcnt lgkmcnt(0)
    ds_read_b64_tr_b16 a[12:13], v13 offset:12288
    ds_read_b64_tr_b16 a[14:15], v13 offset:14336
    ds_read_b64_tr_b16 a[68:69], v14 offset:12288
    ds_read_b64_tr_b16 a[70:71], v14 offset:14336
    ds_read_b64_tr_b16 a[124:125], v15 offset:12288
    ds_read_b64_tr_b16 a[126:127], v15 offset:14336
    ds_read_b64_tr_b16 a[180:181], v16 offset:12288
    ds_read_b64_tr_b16 a[182:183], v16 offset:14336
    s_waitcnt lgkmcnt(0)
    ds_read_b64_tr_b16 a[16:17], v13 offset:16384
    ds_read_b64_tr_b16 a[18:19], v13 offset:18432
    ds_read_b64_tr_b16 a[72:73], v14 offset:16384
    ds_read_b64_tr_b16 a[74:75], v14 offset:18432
    ds_read_b64_tr_b16 a[128:129], v15 offset:16384
    ds_read_b64_tr_b16 a[130:131], v15 offset:18432
    ds_read_b64_tr_b16 a[184:185], v16 offset:16384
    ds_read_b64_tr_b16 a[186:187], v16 offset:18432
    s_waitcnt lgkmcnt(0)
    ds_read_b64_tr_b16 a[20:21], v13 offset:20480
    ds_read_b64_tr_b16 a[22:23], v13 offset:22528
    ds_read_b64_tr_b16 a[76:77], v14 offset:20480
    ds_read_b64_tr_b16 a[78:79], v14 offset:22528
    ds_read_b64_tr_b16 a[132:133], v15 offset:20480
    ds_read_b64_tr_b16 a[134:135], v15 offset:22528
    ds_read_b64_tr_b16 a[188:189], v16 offset:20480
    ds_read_b64_tr_b16 a[190:191], v16 offset:22528
    s_waitcnt lgkmcnt(0)
    ds_read_b64_tr_b16 a[24:25], v13 offset:24576
    ds_read_b64_tr_b16 a[26:27], v13 offset:26624
    ds_read_b64_tr_b16 a[80:81], v14 offset:24576
    ds_read_b64_tr_b16 a[82:83], v14 offset:26624
    ds_read_b64_tr_b16 a[136:137], v15 offset:24576
    ds_read_b64_tr_b16 a[138:139], v15 offset:26624
    ds_read_b64_tr_b16 a[192:193], v16 offset:24576
    ds_read_b64_tr_b16 a[194:195], v16 offset:26624
    s_waitcnt lgkmcnt(0)
    s_add_u32 m0, s42, 0
    s_nop 0
    global_load_lds_dwordx4 v8, s[10:11]
    s_add_u32 s10, s10, 7168
    s_addc_u32 s11, s11, 0
    s_add_u32 m0, s42, 1024
    s_nop 0
    global_load_lds_dwordx4 v9, s[10:11]
    s_add_u32 s10, s10, 7168
    s_addc_u32 s11, s11, 0
    s_add_u32 m0, s42, 2048
    s_nop 0
    global_load_lds_dwordx4 v8, s[10:11]
    s_add_u32 s10, s10, 7168
    s_addc_u32 s11, s11, 0
    s_add_u32 m0, s42, 3072
    s_nop 0
    global_load_lds_dwordx4 v9, s[10:11]
    s_add_u32 s10, s10, 7168
    s_addc_u32 s11, s11, 0
    s_add_u32 m0, s42, 4096
    s_nop 0
    global_load_lds_dwordx4 v8, s[10:11]
    s_add_u32 s10, s10, 7168
    s_addc_u32 s11, s11, 0
    s_add_u32 m0, s42, 5120
    s_nop 0
    global_load_lds_dwordx4 v9, s[10:11]
    s_add_u32 s10, s10, 7168
    s_addc_u32 s11, s11, 0
    s_add_u32 m0, s42, 6144
    s_nop 0
    global_load_lds_dwordx4 v8, s[10:11]
    s_add_u32 s10, s10, 7168
    s_addc_u32 s11, s11, 0
    s_add_u32 m0, s42, 7168
    s_nop 0
    global_load_lds_dwordx4 v9, s[10:11]
    s_add_u32 s10, s10, 7168
    s_addc_u32 s11, s11, 0
    s_add_u32 m0, s42, 8192
    s_nop 0
    global_load_lds_dwordx4 v8, s[10:11]
    s_add_u32 s10, s10, 7168
    s_addc_u32 s11, s11, 0
    s_add_u32 m0, s42, 9216
    s_nop 0
    global_load_lds_dwordx4 v9, s[10:11]
    s_add_u32 s10, s10, 7168
    s_addc_u32 s11, s11, 0
    s_add_u32 m0, s42, 10240
    s_nop 0
    global_load_lds_dwordx4 v8, s[10:11]
    s_add_u32 s10, s10, 7168
    s_addc_u32 s11, s11, 0
    s_add_u32 m0, s42, 11264
    s_nop 0
    global_load_lds_dwordx4 v9, s[10:11]
    s_add_u32 s10, s10, 7168
    s_addc_u32 s11, s11, 0
    s_add_u32 m0, s42, 12288
    s_nop 0
    global_load_lds_dwordx4 v8, s[10:11]
    s_add_u32 s10, s10, 7168
    s_addc_u32 s11, s11, 0
    s_add_u32 m0, s42, 13312
    s_nop 0
    global_load_lds_dwordx4 v9, s[10:11]
    s_add_u32 s10, s10, 7168
    s_addc_u32 s11, s11, 0
    s_add_u32 m0, s42, 14336
    s_nop 0
    global_load_lds_dwordx4 v8, s[10:11]
    s_add_u32 s10, s10, 7168
    s_addc_u32 s11, s11, 0
    s_add_u32 m0, s42, 15360
    s_nop 0
    global_load_lds_dwordx4 v9, s[10:11]
    s_add_u32 s10, s10, 7168
    s_addc_u32 s11, s11, 0
    s_add_u32 m0, s42, 16384
    s_nop 0
    global_load_lds_dwordx4 v8, s[10:11]
    s_add_u32 s10, s10, 7168
    s_addc_u32 s11, s11, 0
    s_add_u32 m0, s42, 17408
    s_nop 0
    global_load_lds_dwordx4 v9, s[10:11]
    s_add_u32 s10, s10, 7168
    s_addc_u32 s11, s11, 0
    s_add_u32 m0, s42, 18432
    s_nop 0
    global_load_lds_dwordx4 v8, s[10:11]
    s_add_u32 s10, s10, 7168
    s_addc_u32 s11, s11, 0
    s_add_u32 m0, s42, 19456
    s_nop 0
    global_load_lds_dwordx4 v9, s[10:11]
    s_add_u32 s10, s10, 7168
    s_addc_u32 s11, s11, 0
    s_add_u32 m0, s42, 20480
    s_nop 0
    global_load_lds_dwordx4 v8, s[10:11]
    s_add_u32 s10, s10, 7168
    s_addc_u32 s11, s11, 0
    s_add_u32 m0, s42, 21504
    s_nop 0
    global_load_lds_dwordx4 v9, s[10:11]
    s_add_u32 s10, s10, 7168
    s_addc_u32 s11, s11, 0
    s_add_u32 m0, s42, 22528
    s_nop 0
    global_load_lds_dwordx4 v8, s[10:11]
    s_add_u32 s10, s10, 7168
    s_addc_u32 s11, s11, 0
    s_add_u32 m0, s42, 23552
    s_nop 0
    global_load_lds_dwordx4 v9, s[10:11]
    s_add_u32 s10, s10, 7168
    s_addc_u32 s11, s11, 0
    s_add_u32 m0, s42, 24576
    s_nop 0
    global_load_lds_dwordx4 v8, s[10:11]
    s_add_u32 s10, s10, 7168
    s_addc_u32 s11, s11, 0
    s_add_u32 m0, s42, 25600
    s_nop 0
    global_load_lds_dwordx4 v9, s[10:11]
    s_add_u32 s10, s10, 7168
    s_addc_u32 s11, s11, 0
    s_add_u32 m0, s42, 26624
    s_nop 0
    global_load_lds_dwordx4 v8, s[10:11]
    s_add_u32 s10, s10, 7168
    s_addc_u32 s11, s11, 0
    s_add_u32 m0, s42, 27648
    s_nop 0
    global_load_lds_dwordx4 v9, s[10:11]
    s_add_u32 s10, s10, 7168
    s_addc_u32 s11, s11, 0
    s_waitcnt vmcnt(0)
    ds_read_b64_tr_b16 a[28:29], v13 offset:0
    ds_read_b64_tr_b16 a[30:31], v13 offset:2048
    ds_read_b64_tr_b16 a[84:85], v14 offset:0
    ds_read_b64_tr_b16 a[86:87], v14 offset:2048
    ds_read_b64_tr_b16 a[140:141], v15 offset:0
    ds_read_b64_tr_b16 a[142:143], v15 offset:2048
    ds_read_b64_tr_b16 a[196:197], v16 offset:0
    ds_read_b64_tr_b16 a[198:199], v16 offset:2048
    s_waitcnt lgkmcnt(0)
    ds_read_b64_tr_b16 a[32:33], v13 offset:4096
    ds_read_b64_tr_b16 a[34:35], v13 offset:6144
    ds_read_b64_tr_b16 a[88:89], v14 offset:4096
    ds_read_b64_tr_b16 a[90:91], v14 offset:6144
    ds_read_b64_tr_b16 a[144:145], v15 offset:4096
    ds_read_b64_tr_b16 a[146:147], v15 offset:6144
    ds_read_b64_tr_b16 a[200:201], v16 offset:4096
    ds_read_b64_tr_b16 a[202:203], v16 offset:6144
    s_waitcnt lgkmcnt(0)
    ds_read_b64_tr_b16 a[36:37], v13 offset:8192
    ds_read_b64_tr_b16 a[38:39], v13 offset:10240
    ds_read_b64_tr_b16 a[92:93], v14 offset:8192
    ds_read_b64_tr_b16 a[94:95], v14 offset:10240
    ds_read_b64_tr_b16 a[148:149], v15 offset:8192
    ds_read_b64_tr_b16 a[150:151], v15 offset:10240
    ds_read_b64_tr_b16 a[204:205], v16 offset:8192
    ds_read_b64_tr_b16 a[206:207], v16 offset:10240
    s_waitcnt lgkmcnt(0)
    ds_read_b64_tr_b16 a[40:41], v13 offset:12288
    ds_read_b64_tr_b16 a[42:43], v13 offset:14336
    ds_read_b64_tr_b16 a[96:97], v14 offset:12288
    ds_read_b64_tr_b16 a[98:99], v14 offset:14336
    ds_read_b64_tr_b16 a[152:153], v15 offset:12288
    ds_read_b64_tr_b16 a[154:155], v15 offset:14336
    ds_read_b64_tr_b16 a[208:209], v16 offset:12288
    ds_read_b64_tr_b16 a[210:211], v16 offset:14336
    s_waitcnt lgkmcnt(0)
    ds_read_b64_tr_b16 a[44:45], v13 offset:16384
    ds_read_b64_tr_b16 a[46:47], v13 offset:18432
    ds_read_b64_tr_b16 a[100:101], v14 offset:16384
    ds_read_b64_tr_b16 a[102:103], v14 offset:18432
    ds_read_b64_tr_b16 a[156:157], v15 offset:16384
    ds_read_b64_tr_b16 a[158:159], v15 offset:18432
    ds_read_b64_tr_b16 a[212:213], v16 offset:16384
    ds_read_b64_tr_b16 a[214:215], v16 offset:18432
    s_waitcnt lgkmcnt(0)
    ds_read_b64_tr_b16 a[48:49], v13 offset:20480
    ds_read_b64_tr_b16 a[50:51], v13 offset:22528
    ds_read_b64_tr_b16 a[104:105], v14 offset:20480
    ds_read_b64_tr_b16 a[106:107], v14 offset:22528
    ds_read_b64_tr_b16 a[160:161], v15 offset:20480
    ds_read_b64_tr_b16 a[162:163], v15 offset:22528
    ds_read_b64_tr_b16 a[216:217], v16 offset:20480
    ds_read_b64_tr_b16 a[218:219], v16 offset:22528
    s_waitcnt lgkmcnt(0)
    ds_read_b64_tr_b16 a[52:53], v13 offset:24576
    ds_read_b64_tr_b16 a[54:55], v13 offset:26624
    ds_read_b64_tr_b16 a[108:109], v14 offset:24576
    ds_read_b64_tr_b16 a[110:111], v14 offset:26624
    ds_read_b64_tr_b16 a[164:165], v15 offset:24576
    ds_read_b64_tr_b16 a[166:167], v15 offset:26624
    ds_read_b64_tr_b16 a[220:221], v16 offset:24576
    ds_read_b64_tr_b16 a[222:223], v16 offset:26624
    s_waitcnt lgkmcnt(0)
    s_barrier
    v_lshlrev_b32 v226, 2, v1
    s_mov_b32 s5, s22
    v_lshlrev_b32 v5, 2, v0
    v_add_u32 v225, 4096, v3
    s_mov_b32 s26, 0x0000ffff
    s_mov_b32 s27, 0x007f0000
    s_mov_b64 s[28:29], -1
    v_bfe_u32 v10, v0, 2, 3
    v_and_b32 v11, 3, v0
    v_lshlrev_b32 v11, 2, v11
    v_lshl_add_u32 v227, v10, 7, v11
    s_mul_i32 s42, s4, 8704
    v_mul_u32_u24 v6, 272, v1
    v_lshl_add_u32 v6, v2, 4, v6
    v_add_u32 v6, s42, v6
    v_lshrrev_b32 v10, 3, v0
    v_lshl_add_u32 v10, s4, 3, v10
    v_and_b32 v11, 7, v0
    v_mul_u32_u24 v7, 272, v10
    v_lshl_add_u32 v7, v11, 5, v7
    v_mul_u32_u24 v224, 896, v10
    v_lshl_add_u32 v224, v11, 4, v224
    s_mul_i32 s42, s22, 28672
    s_lshl_b32 s43, s3, 7
    s_add_u32 s42, s42, s43
    s_add_u32 s30, s30, s42
    s_addc_u32 s31, s31, 0
    s_mul_i32 s42, s22, 114688
    s_mul_i32 s43, s4, 28672
    s_add_u32 s42, s42, s43
    s_add_u32 s12, s8, 44052480
    s_addc_u32 s13, s9, 0
    s_add_u32 s12, s12, s42
    s_addc_u32 s13, s13, 0
    s_mul_i32 s42, s22, 458752
    s_lshl_b32 s43, s3, 16
    s_add_u32 s42, s42, s43
    s_lshl_b32 s43, s4, 13
    s_add_u32 s42, s42, s43
    s_add_u32 s14, s8, 12845056
    s_addc_u32 s15, s9, 0
    s_add_u32 s14, s14, s42
    s_addc_u32 s15, s15, 0
    s_mul_i32 s42, s22, 114688
    s_mul_i32 s43, s4, 28672
    s_add_u32 s42, s42, s43
    s_lshl_b32 s43, s3, 12
    s_add_u32 s42, s42, s43
    s_add_u32 s16, s8, 54013952
    s_addc_u32 s17, s9, 0
    s_add_u32 s16, s16, s42
    s_addc_u32 s17, s17, 0
    s_mul_i32 s42, s22, 40960
    s_mul_i32 s43, s4, 10240
    s_add_u32 s42, s42, s43
    s_add_u32 s18, s8, 51392512
    s_addc_u32 s19, s9, 0
    s_add_u32 s18, s18, s42
    s_addc_u32 s19, s19, 0
    s_lshl_b32 s42, s22, 8
    s_add_u32 s20, s8, 43962368
    s_addc_u32 s21, s9, 0
    s_add_u32 s20, s20, s42
    s_addc_u32 s21, s21, 0
    s_lshl_b32 s42, s22, 7
    s_add_u32 s32, s8, 43954176
    s_addc_u32 s33, s9, 0
    s_add_u32 s32, s32, s42
    s_addc_u32 s33, s33, 0
    s_lshl_b32 s42, s22, 10
    s_add_u32 s34, s8, 43986944
    s_addc_u32 s35, s9, 0
    s_add_u32 s34, s34, s42
    s_addc_u32 s35, s35, 0
L_ou_item:
    s_cmp_lg_u32 s4, 0
    s_cbranch_scc1 L_ou_f1_ok
L_ou_f1:
    global_load_dword v4, v5, s[20:21] sc1
    s_add_u32 s6, s6, 1
    s_cmp_gt_u32 s6, 1048576
    s_cbranch_scc1 L_bail
    s_waitcnt vmcnt(0)
    v_cmp_ne_u32 vcc, 0x01010101, v4
    s_and_b64 vcc, vcc, s[26:27]
    s_cbranch_vccz L_ou_f1_ok
    s_sleep 2
    s_branch L_ou_f1
L_ou_f1_ok:
    s_waitcnt vmcnt(0)
    s_barrier
    global_load_dword v228, v226, s[32:33] sc1
    global_load_dword v229, v226, s[32:33] offset:64 sc1
    s_mov_b64 s[40:41], s[12:13]
    global_load_dwordx4 v[160:163], v3, s[40:41] offset:0 sc1
    global_load_dwordx4 v[164:167], v3, s[40:41] offset:1024 sc1
    global_load_dwordx4 v[168:171], v3, s[40:41] offset:2048 sc1
    global_load_dwordx4 v[172:175], v3, s[40:41] offset:3072 sc1
    s_add_u32 s40, s40, 4096
    s_addc_u32 s41, s41, 0
    global_load_dwordx4 v[176:179], v3, s[40:41] offset:0 sc1
    global_load_dwordx4 v[180:183], v3, s[40:41] offset:1024 sc1
    global_load_dwordx4 v[184:187], v3, s[40:41] offset:2048 sc1
    global_load_dwordx4 v[188:191], v3, s[40:41] offset:3072 sc1
    s_add_u32 s40, s40, 4096
    s_addc_u32 s41, s41, 0
    global_load_dwordx4 v[192:195], v3, s[40:41] offset:0 sc1
    global_load_dwordx4 v[196:199], v3, s[40:41] offset:1024 sc1
    global_load_dwordx4 v[200:203], v3, s[40:41] offset:2048 sc1
    global_load_dwordx4 v[204:207], v3, s[40:41] offset:3072 sc1
    s_add_u32 s40, s40, 4096
    s_addc_u32 s41, s41, 0
    global_load_dwordx4 v[208:211], v3, s[40:41] offset:0 sc1
    global_load_dwordx4 v[212:215], v3, s[40:41] offset:1024 sc1
    global_load_dwordx4 v[216:219], v3, s[40:41] offset:2048 sc1
    global_load_dwordx4 v[220:223], v3, s[40:41] offset:3072 sc1
    s_add_u32 s40, s40, 4096
    s_addc_u32 s41, s41, 0
    s_add_u32 s42, s14, 32768
    s_addc_u32 s43, s15, 0
    s_waitcnt vmcnt(15)
    v_mfma_f32_16x16x32_bf16 v[8:11], a[0:3], v[160:163], 0
    v_mfma_f32_16x16x32_bf16 v[16:19], a[56:59], v[160:163], 0
    v_mfma_f32_16x16x32_bf16 v[24:27], a[112:115], v[160:163], 0
    v_mfma_f32_16x16x32_bf16 v[32:35], a[168:171], v[160:163], 0
    global_load_dwordx4 v[160:163], v3, s[40:41] offset:0 sc1
    s_waitcnt vmcnt(15)
    v_mfma_f32_16x16x32_bf16 v[12:15], a[0:3], v[164:167], 0
    v_mfma_f32_16x16x32_bf16 v[20:23], a[56:59], v[164:167], 0
    v_mfma_f32_16x16x32_bf16 v[28:31], a[112:115], v[164:167], 0
    v_mfma_f32_16x16x32_bf16 v[36:39], a[168:171], v[164:167], 0
    global_load_dwordx4 v[164:167], v3, s[40:41] offset:1024 sc1
    s_waitcnt vmcnt(15)
    v_mfma_f32_16x16x32_bf16 v[8:11], a[4:7], v[168:171], v[8:11]
    v_mfma_f32_16x16x32_bf16 v[16:19], a[60:63], v[168:171], v[16:19]
    v_mfma_f32_16x16x32_bf16 v[24:27], a[116:119], v[168:171], v[24:27]
    v_mfma_f32_16x16x32_bf16 v[32:35], a[172:175], v[168:171], v[32:35]
    global_load_dwordx4 v[168:171], v3, s[40:41] offset:2048 sc1
    s_waitcnt vmcnt(15)
    v_mfma_f32_16x16x32_bf16 v[12:15], a[4:7], v[172:175], v[12:15]
    v_mfma_f32_16x16x32_bf16 v[20:23], a[60:63], v[172:175], v[20:23]
    v_mfma_f32_16x16x32_bf16 v[28:31], a[116:119], v[172:175], v[28:31]
    v_mfma_f32_16x16x32_bf16 v[36:39], a[172:175], v[172:175], v[36:39]
    global_load_dwordx4 v[172:175], v3, s[40:41] offset:3072 sc1
    s_add_u32 s40, s40, 4096
    s_addc_u32 s41, s41, 0
    s_waitcnt vmcnt(15)
    v_mfma_f32_16x16x32_bf16 v[8:11], a[8:11], v[176:179], v[8:11]
    v_mfma_f32_16x16x32_bf16 v[16:19], a[64:67], v[176:179], v[16:19]
    v_mfma_f32_16x16x32_bf16 v[24:27], a[120:123], v[176:179], v[24:27]
    v_mfma_f32_16x16x32_bf16 v[32:35], a[176:179], v[176:179], v[32:35]
    global_load_dwordx4 v[176:179], v3, s[40:41] offset:0 sc1
    s_waitcnt vmcnt(15)
    v_mfma_f32_16x16x32_bf16 v[12:15], a[8:11], v[180:183], v[12:15]
    v_mfma_f32_16x16x32_bf16 v[20:23], a[64:67], v[180:183], v[20:23]
    v_mfma_f32_16x16x32_bf16 v[28:31], a[120:123], v[180:183], v[28:31]
    v_mfma_f32_16x16x32_bf16 v[36:39], a[176:179], v[180:183], v[36:39]
    global_load_dwordx4 v[180:183], v3, s[40:41] offset:1024 sc1
    s_waitcnt vmcnt(15)
    v_mfma_f32_16x16x32_bf16 v[8:11], a[12:15], v[184:187], v[8:11]
    v_mfma_f32_16x16x32_bf16 v[16:19], a[68:71], v[184:187], v[16:19]
    v_mfma_f32_16x16x32_bf16 v[24:27], a[124:127], v[184:187], v[24:27]
    v_mfma_f32_16x16x32_bf16 v[32:35], a[180:183], v[184:187], v[32:35]
    global_load_dwordx4 v[184:187], v3, s[40:41] offset:2048 sc1
    s_waitcnt vmcnt(15)
    v_mfma_f32_16x16x32_bf16 v[12:15], a[12:15], v[188:191], v[12:15]
    v_mfma_f32_16x16x32_bf16 v[20:23], a[68:71], v[188:191], v[20:23]
    v_mfma_f32_16x16x32_bf16 v[28:31], a[124:127], v[188:191], v[28:31]
    v_mfma_f32_16x16x32_bf16 v[36:39], a[180:183], v[188:191], v[36:39]
    global_load_dwordx4 v[188:191], v3, s[40:41] offset:3072 sc1
    s_add_u32 s40, s40, 4096
    s_addc_u32 s41, s41, 0
    s_waitcnt vmcnt(15)
    v_mfma_f32_16x16x32_bf16 v[8:11], a[16:19], v[192:195], v[8:11]
    v_mfma_f32_16x16x32_bf16 v[16:19], a[72:75], v[192:195], v[16:19]
    v_mfma_f32_16x16x32_bf16 v[24:27], a[128:131], v[192:195], v[24:27]
    v_mfma_f32_16x16x32_bf16 v[32:35], a[184:187], v[192:195], v[32:35]
    global_load_dwordx4 v[192:195], v3, s[40:41] offset:0 sc1
    s_waitcnt vmcnt(15)
    v_mfma_f32_16x16x32_bf16 v[12:15], a[16:19], v[196:199], v[12:15]
    v_mfma_f32_16x16x32_bf16 v[20:23], a[72:75], v[196:199], v[20:23]
    v_mfma_f32_16x16x32_bf16 v[28:31], a[128:131], v[196:199], v[28:31]
    v_mfma_f32_16x16x32_bf16 v[36:39], a[184:187], v[196:199], v[36:39]
    global_load_dwordx4 v[196:199], v3, s[40:41] offset:1024 sc1
    s_waitcnt vmcnt(15)
    v_mfma_f32_16x16x32_bf16 v[8:11], a[20:23], v[200:203], v[8:11]
    v_mfma_f32_16x16x32_bf16 v[16:19], a[76:79], v[200:203], v[16:19]
    v_mfma_f32_16x16x32_bf16 v[24:27], a[132:135], v[200:203], v[24:27]
    v_mfma_f32_16x16x32_bf16 v[32:35], a[188:191], v[200:203], v[32:35]
    global_load_dwordx4 v[200:203], v3, s[40:41] offset:2048 sc1
    s_waitcnt vmcnt(15)
    v_mfma_f32_16x16x32_bf16 v[12:15], a[20:23], v[204:207], v[12:15]
    v_mfma_f32_16x16x32_bf16 v[20:23], a[76:79], v[204:207], v[20:23]
    v_mfma_f32_16x16x32_bf16 v[28:31], a[132:135], v[204:207], v[28:31]
    v_mfma_f32_16x16x32_bf16 v[36:39], a[188:191], v[204:207], v[36:39]
    global_load_dwordx4 v[204:207], v3, s[40:41] offset:3072 sc1
    s_add_u32 s40, s40, 4096
    s_addc_u32 s41, s41, 0
    s_waitcnt vmcnt(15)
    v_mfma_f32_16x16x32_bf16 v[8:11], a[24:27], v[208:211], v[8:11]
    v_mfma_f32_16x16x32_bf16 v[16:19], a[80:83], v[208:211], v[16:19]
    v_mfma_f32_16x16x32_bf16 v[24:27], a[136:139], v[208:211], v[24:27]
    v_mfma_f32_16x16x32_bf16 v[32:35], a[192:195], v[208:211], v[32:35]
    global_load_dwordx4 v[40:43], v3, s[14:15] offset:0 sc1
    s_waitcnt vmcnt(15)
    v_mfma_f32_16x16x32_bf16 v[12:15], a[24:27], v[212:215], v[12:15]
    v_mfma_f32_16x16x32_bf16 v[20:23], a[80:83], v[212:215], v[20:23]
    v_mfma_f32_16x16x32_bf16 v[28:31], a[136:139], v[212:215], v[28:31]
    v_mfma_f32_16x16x32_bf16 v[36:39], a[192:195], v[212:215], v[36:39]
    global_load_dwordx4 v[44:47], v3, s[14:15] offset:1024 sc1
    s_waitcnt vmcnt(15)
    v_mfma_f32_16x16x32_bf16 v[8:11], a[28:31], v[216:219], v[8:11]
    v_mfma_f32_16x16x32_bf16 v[16:19], a[84:87], v[216:219], v[16:19]
    v_mfma_f32_16x16x32_bf16 v[24:27], a[140:143], v[216:219], v[24:27]
    v_mfma_f32_16x16x32_bf16 v[32:35], a[196:199], v[216:219], v[32:35]
    global_load_dwordx4 v[48:51], v3, s[42:43] offset:0 sc1
    s_waitcnt vmcnt(15)
    v_mfma_f32_16x16x32_bf16 v[12:15], a[28:31], v[220:223], v[12:15]
    v_mfma_f32_16x16x32_bf16 v[20:23], a[84:87], v[220:223], v[20:23]
    v_mfma_f32_16x16x32_bf16 v[28:31], a[140:143], v[220:223], v[28:31]
    v_mfma_f32_16x16x32_bf16 v[36:39], a[196:199], v[220:223], v[36:39]
    global_load_dwordx4 v[52:55], v3, s[42:43] offset:1024 sc1
    s_waitcnt vmcnt(15)
    v_mfma_f32_16x16x32_bf16 v[8:11], a[32:35], v[160:163], v[8:11]
    v_mfma_f32_16x16x32_bf16 v[16:19], a[88:91], v[160:163], v[16:19]
    v_mfma_f32_16x16x32_bf16 v[24:27], a[144:147], v[160:163], v[24:27]
    v_mfma_f32_16x16x32_bf16 v[32:35], a[200:203], v[160:163], v[32:35]
    global_load_dwordx4 v[56:59], v3, s[14:15] offset:2048 sc1
    s_waitcnt vmcnt(15)
    v_mfma_f32_16x16x32_bf16 v[12:15], a[32:35], v[164:167], v[12:15]
    v_mfma_f32_16x16x32_bf16 v[20:23], a[88:91], v[164:167], v[20:23]
    v_mfma_f32_16x16x32_bf16 v[28:31], a[144:147], v[164:167], v[28:31]
    v_mfma_f32_16x16x32_bf16 v[36:39], a[200:203], v[164:167], v[36:39]
    global_load_dwordx4 v[60:63], v3, s[14:15] offset:3072 sc1
    s_waitcnt vmcnt(15)
    v_mfma_f32_16x16x32_bf16 v[8:11], a[36:39], v[168:171], v[8:11]
    v_mfma_f32_16x16x32_bf16 v[16:19], a[92:95], v[168:171], v[16:19]
    v_mfma_f32_16x16x32_bf16 v[24:27], a[148:151], v[168:171], v[24:27]
    v_mfma_f32_16x16x32_bf16 v[32:35], a[204:207], v[168:171], v[32:35]
    global_load_dwordx4 v[64:67], v3, s[42:43] offset:2048 sc1
    s_waitcnt vmcnt(15)
    v_mfma_f32_16x16x32_bf16 v[12:15], a[36:39], v[172:175], v[12:15]
    v_mfma_f32_16x16x32_bf16 v[20:23], a[92:95], v[172:175], v[20:23]
    v_mfma_f32_16x16x32_bf16 v[28:31], a[148:151], v[172:175], v[28:31]
    v_mfma_f32_16x16x32_bf16 v[36:39], a[204:207], v[172:175], v[36:39]
    global_load_dwordx4 v[68:71], v3, s[42:43] offset:3072 sc1
    s_waitcnt vmcnt(15)
    v_mfma_f32_16x16x32_bf16 v[8:11], a[40:43], v[176:179], v[8:11]
    v_mfma_f32_16x16x32_bf16 v[16:19], a[96:99], v[176:179], v[16:19]
    v_mfma_f32_16x16x32_bf16 v[24:27], a[152:155], v[176:179], v[24:27]
    v_mfma_f32_16x16x32_bf16 v[32:35], a[208:211], v[176:179], v[32:35]
    global_load_dwordx4 v[72:75], v225, s[14:15] offset:0 sc1
    s_waitcnt vmcnt(15)
    v_mfma_f32_16x16x32_bf16 v[12:15], a[40:43], v[180:183], v[12:15]
    v_mfma_f32_16x16x32_bf16 v[20:23], a[96:99], v[180:183], v[20:23]
    v_mfma_f32_16x16x32_bf16 v[28:31], a[152:155], v[180:183], v[28:31]
    v_mfma_f32_16x16x32_bf16 v[36:39], a[208:211], v[180:183], v[36:39]
    global_load_dwordx4 v[76:79], v225, s[14:15] offset:1024 sc1
    s_waitcnt vmcnt(15)
    v_mfma_f32_16x16x32_bf16 v[8:11], a[44:47], v[184:187], v[8:11]
    v_mfma_f32_16x16x32_bf16 v[16:19], a[100:103], v[184:187], v[16:19]
    v_mfma_f32_16x16x32_bf16 v[24:27], a[156:159], v[184:187], v[24:27]
    v_mfma_f32_16x16x32_bf16 v[32:35], a[212:215], v[184:187], v[32:35]
    global_load_dwordx4 v[80:83], v225, s[42:43] offset:0 sc1
    s_waitcnt vmcnt(15)
    v_mfma_f32_16x16x32_bf16 v[12:15], a[44:47], v[188:191], v[12:15]
    v_mfma_f32_16x16x32_bf16 v[20:23], a[100:103], v[188:191], v[20:23]
    v_mfma_f32_16x16x32_bf16 v[28:31], a[156:159], v[188:191], v[28:31]
    v_mfma_f32_16x16x32_bf16 v[36:39], a[212:215], v[188:191], v[36:39]
    global_load_dwordx4 v[84:87], v225, s[42:43] offset:1024 sc1
    s_waitcnt vmcnt(15)
    v_mfma_f32_16x16x32_bf16 v[8:11], a[48:51], v[192:195], v[8:11]
    v_mfma_f32_16x16x32_bf16 v[16:19], a[104:107], v[192:195], v[16:19]
    v_mfma_f32_16x16x32_bf16 v[24:27], a[160:163], v[192:195], v[24:27]
    v_mfma_f32_16x16x32_bf16 v[32:35], a[216:219], v[192:195], v[32:35]
    global_load_dwordx4 v[88:91], v225, s[14:15] offset:2048 sc1
    s_waitcnt vmcnt(15)
    v_mfma_f32_16x16x32_bf16 v[12:15], a[48:51], v[196:199], v[12:15]
    v_mfma_f32_16x16x32_bf16 v[20:23], a[104:107], v[196:199], v[20:23]
    v_mfma_f32_16x16x32_bf16 v[28:31], a[160:163], v[196:199], v[28:31]
    v_mfma_f32_16x16x32_bf16 v[36:39], a[216:219], v[196:199], v[36:39]
    global_load_dwordx4 v[92:95], v225, s[14:15] offset:3072 sc1
    s_waitcnt vmcnt(15)
    v_mfma_f32_16x16x32_bf16 v[8:11], a[52:55], v[200:203], v[8:11]
    v_mfma_f32_16x16x32_bf16 v[16:19], a[108:111], v[200:203], v[16:19]
    v_mfma_f32_16x16x32_bf16 v[24:27], a[164:167], v[200:203], v[24:27]
    v_mfma_f32_16x16x32_bf16 v[32:35], a[220:223], v[200:203], v[32:35]
    global_load_dwordx4 v[96:99], v225, s[42:43] offset:2048 sc1
    s_waitcnt vmcnt(15)
    v_mfma_f32_16x16x32_bf16 v[12:15], a[52:55], v[204:207], v[12:15]
    v_mfma_f32_16x16x32_bf16 v[20:23], a[108:111], v[204:207], v[20:23]
    v_mfma_f32_16x16x32_bf16 v[28:31], a[164:167], v[204:207], v[28:31]
    v_mfma_f32_16x16x32_bf16 v[36:39], a[220:223], v[204:207], v[36:39]
    global_load_dwordx4 v[100:103], v225, s[42:43] offset:3072 sc1
    s_cmp_eq_u32 s5, 63
    s_cbranch_scc1 L_ou_red
    s_cmp_lg_u32 s4, 0
    s_cbranch_scc1 L_ou_f2_ok
L_ou_f2:
    global_load_dword v4, v227, s[34:35] sc1
    s_add_u32 s6, s6, 1
    s_cmp_gt_u32 s6, 1048576
    s_cbranch_scc1 L_bail
    s_waitcnt vmcnt(0)
    v_cmp_ne_u32 vcc, 0x01010101, v4
    s_and_b64 vcc, vcc, s[28:29]
    s_cbranch_vccz L_ou_f2_ok
    s_sleep 2
    s_branch L_ou_f2
L_ou_f2_ok:
    s_waitcnt vmcnt(0)
    s_barrier
    s_add_u32 s40, s18, 4096
    s_addc_u32 s41, s19, 0
    s_add_u32 s42, s18, 8192
    s_addc_u32 s43, s19, 0
    global_load_dwordx4 v[120:123], v3, s[18:19] offset:0 sc1
    global_load_dwordx4 v[124:127], v3, s[18:19] offset:1024 sc1
    global_load_dwordx4 v[128:131], v3, s[18:19] offset:2048 sc1
    global_load_dwordx4 v[132:135], v3, s[18:19] offset:3072 sc1
    global_load_dwordx4 v[104:107], v3, s[16:17] offset:0 sc1
    global_load_dwordx4 v[108:111], v3, s[16:17] offset:1024 sc1
    global_load_dwordx4 v[112:115], v3, s[16:17] offset:2048 sc1
    global_load_dwordx4 v[116:119], v3, s[16:17] offset:3072 sc1
    global_load_dwordx4 v[136:139], v3, s[40:41] offset:0 sc1
    global_load_dwordx4 v[140:143], v3, s[40:41] offset:1024 sc1
    global_load_dwordx4 v[144:147], v3, s[40:41] offset:2048 sc1
    global_load_dwordx4 v[148:151], v3, s[40:41] offset:3072 sc1
    global_load_dwordx4 v[152:155], v3, s[42:43] offset:0 sc1
    global_load_dwordx4 v[156:159], v3, s[42:43] offset:1024 sc1
    s_waitcnt vmcnt(13)
    v_mfma_f32_16x16x32_bf16 v[160:163], v[40:43], v[120:123], 0
    v_mfma_f32_16x16x32_bf16 v[168:171], v[44:47], v[120:123], 0
    v_mfma_f32_16x16x32_bf16 v[176:179], v[48:51], v[120:123], 0
    v_mfma_f32_16x16x32_bf16 v[184:187], v[52:55], v[120:123], 0
    s_waitcnt vmcnt(12)
    v_mfma_f32_16x16x32_bf16 v[164:167], v[40:43], v[124:127], 0
    v_mfma_f32_16x16x32_bf16 v[172:175], v[44:47], v[124:127], 0
    v_mfma_f32_16x16x32_bf16 v[180:183], v[48:51], v[124:127], 0
    v_mfma_f32_16x16x32_bf16 v[188:191], v[52:55], v[124:127], 0
    s_waitcnt vmcnt(11)
    v_mfma_f32_16x16x32_bf16 v[160:163], v[56:59], v[128:131], v[160:163]
    v_mfma_f32_16x16x32_bf16 v[168:171], v[60:63], v[128:131], v[168:171]
    v_mfma_f32_16x16x32_bf16 v[176:179], v[64:67], v[128:131], v[176:179]
    v_mfma_f32_16x16x32_bf16 v[184:187], v[68:71], v[128:131], v[184:187]
    s_waitcnt vmcnt(10)
    v_mfma_f32_16x16x32_bf16 v[164:167], v[56:59], v[132:135], v[164:167]
    v_mfma_f32_16x16x32_bf16 v[172:175], v[60:63], v[132:135], v[172:175]
    v_mfma_f32_16x16x32_bf16 v[180:183], v[64:67], v[132:135], v[180:183]
    v_mfma_f32_16x16x32_bf16 v[188:191], v[68:71], v[132:135], v[188:191]
    s_waitcnt vmcnt(5)
    v_mfma_f32_16x16x32_bf16 v[160:163], v[72:75], v[136:139], v[160:163]
    v_mfma_f32_16x16x32_bf16 v[168:171], v[76:79], v[136:139], v[168:171]
    v_mfma_f32_16x16x32_bf16 v[176:179], v[80:83], v[136:139], v[176:179]
    v_mfma_f32_16x16x32_bf16 v[184:187], v[84:87], v[136:139], v[184:187]
    s_waitcnt vmcnt(4)
    v_mfma_f32_16x16x32_bf16 v[164:167], v[72:75], v[140:143], v[164:167]
    v_mfma_f32_16x16x32_bf16 v[172:175], v[76:79], v[140:143], v[172:175]
    v_mfma_f32_16x16x32_bf16 v[180:183], v[80:83], v[140:143], v[180:183]
    v_mfma_f32_16x16x32_bf16 v[188:191], v[84:87], v[140:143], v[188:191]
    s_waitcnt vmcnt(3)
    v_mfma_f32_16x16x32_bf16 v[160:163], v[88:91], v[144:147], v[160:163]
    v_mfma_f32_16x16x32_bf16 v[168:171], v[92:95], v[144:147], v[168:171]
    v_mfma_f32_16x16x32_bf16 v[176:179], v[96:99], v[144:147], v[176:179]
    v_mfma_f32_16x16x32_bf16 v[184:187], v[100:103], v[144:147], v[184:187]
    s_waitcnt vmcnt(2)
    v_mfma_f32_16x16x32_bf16 v[164:167], v[88:91], v[148:151], v[164:167]
    v_mfma_f32_16x16x32_bf16 v[172:175], v[92:95], v[148:151], v[172:175]
    v_mfma_f32_16x16x32_bf16 v[180:183], v[96:99], v[148:151], v[180:183]
    v_mfma_f32_16x16x32_bf16 v[188:191], v[100:103], v[148:151], v[188:191]
    s_waitcnt vmcnt(1)
    v_mfma_f32_16x16x32_bf16 v[160:163], v[104:107], v[152:155], v[160:163]
    v_mfma_f32_16x16x32_bf16 v[168:171], v[108:111], v[152:155], v[168:171]
    v_mfma_f32_16x16x32_bf16 v[176:179], v[112:115], v[152:155], v[176:179]
    v_mfma_f32_16x16x32_bf16 v[184:187], v[116:119], v[152:155], v[184:187]
    s_waitcnt vmcnt(0)
    v_mfma_f32_16x16x32_bf16 v[164:167], v[104:107], v[156:159], v[164:167]
    v_mfma_f32_16x16x32_bf16 v[172:175], v[108:111], v[156:159], v[172:175]
    v_mfma_f32_16x16x32_bf16 v[180:183], v[112:115], v[156:159], v[180:183]
    v_mfma_f32_16x16x32_bf16 v[188:191], v[116:119], v[156:159], v[188:191]
    v_fmac_f32 v8, v228, v160
    v_fmac_f32 v9, v228, v161
    v_fmac_f32 v10, v228, v162
    v_fmac_f32 v11, v228, v163
    v_fmac_f32 v16, v228, v168
    v_fmac_f32 v17, v228, v169
    v_fmac_f32 v18, v228, v170
    v_fmac_f32 v19, v228, v171
    v_fmac_f32 v24, v228, v176
    v_fmac_f32 v25, v228, v177
    v_fmac_f32 v26, v228, v178
    v_fmac_f32 v27, v228, v179
    v_fmac_f32 v32, v228, v184
    v_fmac_f32 v33, v228, v185
    v_fmac_f32 v34, v228, v186
    v_fmac_f32 v35, v228, v187
    v_fmac_f32 v12, v229, v164
    v_fmac_f32 v13, v229, v165
    v_fmac_f32 v14, v229, v166
    v_fmac_f32 v15, v229, v167
    v_fmac_f32 v20, v229, v172
    v_fmac_f32 v21, v229, v173
    v_fmac_f32 v22, v229, v174
    v_fmac_f32 v23, v229, v175
    v_fmac_f32 v28, v229, v180
    v_fmac_f32 v29, v229, v181
    v_fmac_f32 v30, v229, v182
    v_fmac_f32 v31, v229, v183
    v_fmac_f32 v36, v229, v188
    v_fmac_f32 v37, v229, v189
    v_fmac_f32 v38, v229, v190
    v_fmac_f32 v39, v229, v191
L_ou_red:
    s_waitcnt vmcnt(0)
    s_nop 7
    s_barrier
    ds_write_b128 v6, v[8:11] offset:0
    ds_write_b128 v6, v[16:19] offset:64
    ds_write_b128 v6, v[24:27] offset:128
    ds_write_b128 v6, v[32:35] offset:192
    ds_write_b128 v6, v[12:15] offset:4352
    ds_write_b128 v6, v[20:23] offset:4416
    ds_write_b128 v6, v[28:31] offset:4480
    ds_write_b128 v6, v[36:39] offset:4544
    s_waitcnt lgkmcnt(0)
    s_barrier
    ds_read_b128 v[40:43], v7 offset:0
    ds_read_b128 v[44:47], v7 offset:16
    ds_read_b128 v[48:51], v7 offset:8704
    ds_read_b128 v[52:55], v7 offset:8720
    ds_read_b128 v[56:59], v7 offset:17408
    ds_read_b128 v[60:63], v7 offset:17424
    ds_read_b128 v[64:67], v7 offset:26112
    ds_read_b128 v[68:71], v7 offset:26128
    s_waitcnt lgkmcnt(0)
    v_pk_add_f32 v[40:41], v[40:41], v[48:49]
    v_pk_add_f32 v[42:43], v[42:43], v[50:51]
    v_pk_add_f32 v[44:45], v[44:45], v[52:53]
    v_pk_add_f32 v[46:47], v[46:47], v[54:55]
    v_pk_add_f32 v[56:57], v[56:57], v[64:65]
    v_pk_add_f32 v[58:59], v[58:59], v[66:67]
    v_pk_add_f32 v[60:61], v[60:61], v[68:69]
    v_pk_add_f32 v[62:63], v[62:63], v[70:71]
    v_pk_add_f32 v[40:41], v[40:41], v[56:57]
    v_pk_add_f32 v[42:43], v[42:43], v[58:59]
    v_pk_add_f32 v[44:45], v[44:45], v[60:61]
    v_pk_add_f32 v[46:47], v[46:47], v[62:63]
    s_cmp_eq_u32 s5, 63
    s_cbranch_scc1 L_ou_exp
    v_cvt_pk_bf16_f32 v48, v40, v41
    v_cvt_pk_bf16_f32 v49, v42, v43
    v_cvt_pk_bf16_f32 v50, v44, v45
    v_cvt_pk_bf16_f32 v51, v46, v47
    global_store_dwordx4 v224, v[48:51], s[30:31] nt
    s_add_u32 s30, s30, 200704
    s_addc_u32 s31, s31, 0
    s_add_u32 s12, s12, 802816
    s_addc_u32 s13, s13, 0
    s_add_u32 s14, s14, 3211264
    s_addc_u32 s15, s15, 0
    s_add_u32 s16, s16, 802816
    s_addc_u32 s17, s17, 0
    s_add_u32 s18, s18, 286720
    s_addc_u32 s19, s19, 0
    s_add_u32 s20, s20, 1792
    s_addc_u32 s21, s21, 0
    s_add_u32 s32, s32, 896
    s_addc_u32 s33, s33, 0
    s_add_u32 s34, s34, 7168
    s_addc_u32 s35, s35, 0
    s_add_u32 s5, s5, 7
    s_cmp_lt_u32 s5, 64
    s_cbranch_scc1 L_ou_item
    s_waitcnt vmcnt(0)
    s_endpgm
L_ou_exp:
    s_lshl_b32 s42, s3, 8
    v_lshlrev_b32 v224, 1, v224
    s_add_u32 s40, s8, 62009344
    s_addc_u32 s41, s9, 0
    s_add_u32 s40, s40, s42
    s_addc_u32 s41, s41, 0
    global_store_dwordx4 v224, v[40:43], s[40:41] sc1
    global_store_dwordx4 v224, v[44:47], s[40:41] offset:16 sc1
    s_lshl_b32 s42, s3, 2
    s_add_u32 s42, s42, 128
    v_mov_b32 v8, s42
    v_mov_b32 v9, 0x01010101
    s_waitcnt vmcnt(0)
    s_barrier
    s_cmp_lg_u32 s4, 0
    s_cbranch_scc1 L_fs6
    global_store_dword v8, v9, s[20:21] sc1
L_fs6:
    s_endpgm
L_code_end:

.section .rodata,"a"
.p2align 6
.amdhsa_kernel gated_mix__memory_aug_recurrent_mem_tr__dense_activation_silu__prompt_kernel
  .amdhsa_next_free_vgpr 512
  .amdhsa_next_free_sgpr 102
  .amdhsa_accum_offset 256
  .amdhsa_group_segment_fixed_size 0
  .amdhsa_kernarg_size 112
  .amdhsa_user_sgpr_count 2
  .amdhsa_user_sgpr_kernarg_segment_ptr 1
  .amdhsa_system_sgpr_workgroup_id_x 1
  .amdhsa_float_denorm_mode_32 3
.end_amdhsa_kernel
```
